```python
import torch

def _softmax(x, axis=-1):
    return torch.softmax(x, dim=axis)
def _gelu(x):
    return torch.nn.functional.gelu(x, approximate="tanh")
def _silu(x):
    return torch.nn.functional.silu(x)
def _sigmoid(x):
    return torch.sigmoid(x)
def _layernorm(x, axis=-1, eps=1e-5):
    m = x.mean(dim=axis, keepdim=True)
    v = x.var(dim=axis, keepdim=True, unbiased=False)
    return (x - m) / torch.sqrt(v + eps)
def _scatter_add(tgt, idx, src, axis=0):
    return tgt.clone().index_add_(axis, idx, src)
def _segment_sum(src, seg, n):
    out = torch.zeros((n,) + src.shape[1:], dtype=src.dtype)
    return out.index_add_(0, seg, src)
def _pad(x, pw):
    flat = tuple(v for pair in reversed(pw) for v in pair)
    return torch.nn.functional.pad(x, flat)

kernel_name = 'sequential_preLN__sliding_local_dilated__dense_activation_silu__prompt'

def setup_inputs():

    _w = (lambda a: (lambda t: t.to(torch.bfloat16) if t.is_floating_point() else t)(torch.as_tensor(a)))
    def _A_setup():
        B, S, D = 1, 2048, 640
        return {
            "x": _w((lambda *s: torch.randn(*s, dtype=torch.bfloat16) * 0.05)(B, S, D)),
            "wqkv": _w((lambda *s: torch.randn(*s, dtype=torch.bfloat16) * 0.05)(D, 3 * D)),
            "wo": _w((lambda *s: torch.randn(*s, dtype=torch.bfloat16) * 0.05)(D, D)),
        }
    _A_in = _A_setup()

    def _B_setup():
        B, S, D, F = 1, 2048, 640, 1728
        return {
            "x": _w((lambda *s: torch.randn(*s, dtype=torch.bfloat16) * 0.05)(B, S, D)),
            "w1": _w((lambda *s: torch.randn(*s, dtype=torch.bfloat16) * 3.2)(D, F) * (D ** -0.5)),
            "w2": _w((lambda *s: torch.randn(*s, dtype=torch.bfloat16) * 0.4)(F, D) * (F ** -0.5)),
        }
    _B_in = _B_setup()

    return {
        "A_x": _A_in["x"],
        "A_wqkv": _A_in["wqkv"],
        "A_wo": _A_in["wo"],
        "B_x": _B_in["x"],
        "B_w1": _B_in["w1"],
        "B_w2": _B_in["w2"],
    }

def reference(A_x, A_wqkv, A_wo, B_x, B_w1, B_w2):
    def _A_ref(x, wqkv, wo):
        B, S, D = x.shape
        H = 32; Dh = D // H
        W, dil = 8, 2
        qkv = (lambda x, *d: x.permute(*d))((x @ wqkv).reshape(B, S, 3, H, Dh), 2, 0, 3, 1, 4)
        q, k, v = qkv[0], qkv[1], qkv[2]
        scale = Dh ** -0.5
        pos = torch.arange(S)
        off = torch.arange(W) * dil
        idx = pos[:, None] - off[None, :]
        mask = idx >= 0
        idx_c = torch.where(mask, idx, 0).reshape(-1)
        kg = k[:, :, idx_c, :].reshape(B, H, S, W, Dh)
        vg = v[:, :, idx_c, :].reshape(B, H, S, W, Dh)
        logits = torch.einsum("bhsd,bhswd->bhsw", q, kg) * scale
        logits = torch.where(mask[None, None, :, :], logits, -1e9)
        attn = _softmax(logits, axis=-1)
        o = torch.einsum("bhsw,bhswd->bhsd", attn, vg)
        return (lambda x, *d: x.permute(*d))(o, 0, 2, 1, 3).reshape(B, S, D) @ wo

    def _B_ref(x, w1, w2):
        h = torch.einsum("bsd,df->bsf", x, w1)
        h = _silu(h)
        out = torch.einsum("bsf,fd->bsd", h, w2)
        return out

    x = A_x
    h = x + _A_ref(_layernorm(x, axis=-1), A_wqkv, A_wo)
    h2 = h + _B_ref(_layernorm(h, axis=-1), B_w1, B_w2)
    return h2
```

```asm
; @launch grid=(256,1,1) block=(512,1,1) lds=163840
.amdgcn_target "amdgcn-amd-amdhsa--gfx950"
.text
.globl sequential_preLN__sliding_local_dilated__dense_activation_silu__prompt_kernel
.p2align 8
.type sequential_preLN__sliding_local_dilated__dense_activation_silu__prompt_kernel,@function
sequential_preLN__sliding_local_dilated__dense_activation_silu__prompt_kernel:
    s_load_dwordx16 s[4:19], s[0:1], 0
    s_load_dwordx2 s[20:21], s[0:1], 64
    s_cmp_ge_u32 s2, 256
    s_cbranch_scc1 Lend
    v_and_b32 v1, 63, v0
    v_lshrrev_b32 v2, 6, v0
    s_nop 0
    v_readfirstlane_b32 s22, v2
    s_and_b32 s56, s2, 7
    s_lshr_b32 s57, s2, 3
    s_and_b32 s23, s22, 3
    s_and_b32 s58, s57, 7
    s_lshl_b32 s59, s56, 2
    s_lshr_b32 s3, s57, 3
    s_add_u32 s59, s59, s3
    s_cmp_lg_u32 s22, 1
    s_cbranch_scc1 cpx_2
    s_getpc_b64 s[96:97]
cp_1:
    s_sub_u32 s96, s96, cp_1-sequential_preLN__sliding_local_dilated__dense_activation_silu__prompt_kernel
    s_subb_u32 s97, s97, 0
    s_mov_b32 s98, Lend-sequential_preLN__sliding_local_dilated__dense_activation_silu__prompt_kernel
    s_mov_b32 s99, 0x00020000
    s_and_b32 s3, s57, 7
    s_mul_i32 s3, s3, 48
    v_add_u32 v2, s3, v1
    v_lshlrev_b32 v2, 7, v2
    s_mov_b32 exec_hi, 0xffff
    buffer_load_dword v96, v2, s[96:99], 0 offen
    s_mov_b64 exec, -1
cpx_2:
    s_cmp_ge_u32 s22, 4
    s_cbranch_scc0 Lcomp
    s_lshl_b32 s60, s59, 6
    s_sub_u32 s60, s60, 16
    s_mul_i32 s3, s23, 20
    v_lshrrev_b32 v14, 3, v1
    v_add_u32 v14, s3, v14
    v_and_b32 v13, 7, v1
    v_add_u32 v2, 0, v14
    v_lshrrev_b32 v3, 1, v2
    v_and_b32 v3, 7, v3
    v_xor_b32 v3, v3, v13
    v_add_u32 v2, s60, v2
    v_max_i32 v2, 0, v2
    v_mul_u32_u24 v2, 1280, v2
    v_lshl_add_u32 v15, v3, 4, v2
    v_add_u32 v2, 8, v14
    v_lshrrev_b32 v3, 1, v2
    v_and_b32 v3, 7, v3
    v_xor_b32 v3, v3, v13
    v_add_u32 v2, s60, v2
    v_max_i32 v2, 0, v2
    v_mul_u32_u24 v2, 1280, v2
    v_lshl_add_u32 v16, v3, 4, v2
    v_add_u32 v2, 16, v14
    v_lshrrev_b32 v3, 1, v2
    v_and_b32 v3, 7, v3
    v_xor_b32 v3, v3, v13
    v_add_u32 v2, s60, v2
    v_max_i32 v2, 0, v2
    v_mul_u32_u24 v2, 1280, v2
    v_lshl_add_u32 v17, v3, 4, v2
    v_cmp_le_u32 vcc, 30, v1
    s_nop 1
    v_cndmask_b32 v2, 0, 1, vcc
    v_mul_u32_u24 v3, 30, v2
    v_sub_u32 v3, v1, v3
    v_mul_u32_u24 v4, 26, v3
    v_lshrrev_b32 v4, 8, v4
    v_mul_u32_u24 v5, 10, v4
    v_sub_u32 v5, v3, v5
    v_mul_u32_u24 v18, 3840, v2
    v_mul_u32_u24 v4, 1280, v4
    v_add_u32 v18, v18, v4
    v_lshl_add_u32 v18, v5, 4, v18
    s_and_b32 s3, s23, 1
    s_lshl_b32 s3, s3, 4
    s_lshr_b32 s61, s23, 1
    s_lshl_b32 s61, s61, 2
    s_add_u32 s3, s3, s61
    s_mul_i32 s3, s3, 3840
    s_mul_i32 s61, s58, 160
    s_add_u32 s3, s3, s61
    v_add_u32 v18, s3, v18
    s_mul_i32 s64, s23, 3840
    s_mul_i32 s65, s23, 2560
    s_cmp_eq_u32 s23, 0
    s_cselect_b32 s78, 0xffffff00, -1
    s_and_b32 s3, s57, 3
    s_bfe_u32 s61, s57, 0x10003
    s_lshl_b32 s61, s61, 2
    s_add_u32 s3, s3, s61
    s_lshl_b32 s3, s3, 2
    s_lshr_b32 s3, 1983132688, s3
    s_and_b32 s3, s3, 15
    s_bfe_u32 s61, s57, 0x10002
    s_mul_i32 s61, s61, 5
    s_add_u32 s3, s3, s61
    s_lshr_b32 s61, s57, 4
    s_mul_i32 s61, s61, 0
    s_add_u32 s3, s3, s61
    s_bfe_u32 s62, s57, 0x10003
    s_mul_i32 s61, s62, 0
    s_add_u32 s3, s3, s61
    s_sub_u32 s61, s3, 10
    s_cmp_ge_u32 s3, 10
    s_cselect_b32 s3, s61, s3
    s_lshl_b32 s61, s56, 2
    s_lshr_b32 s61, 2271556112, s61
    s_and_b32 s61, s61, 15
    s_add_u32 s3, s3, s61
    s_sub_u32 s61, s3, 10
    s_cmp_ge_u32 s3, 10
    s_cselect_b32 s3, s61, s3
    s_lshl_b32 s75, s3, 7
    s_lshl_b32 s3, s3, 1
    s_add_u32 s3, s3, s62
    s_mul_i32 s76, s3, 122880
    s_cmp_eq_u32 s62, 0
    s_cselect_b32 s96, 1, -1
    s_mul_i32 s96, s96, 128
    s_cselect_b32 s97, 1280, s96
    s_cselect_b32 s98, 0, 1152
    s_mul_i32 s99, s96, 960
    s_cselect_b32 s100, 2457600, s99
    s_cselect_b32 s101, 0, 2334720
    s_waitcnt lgkmcnt(0)
    s_mov_b32 s24, s4
    s_mov_b32 s25, s5
    s_mov_b32 s26, 2621440
    s_mov_b32 s27, 0x00020000
    s_mov_b32 s28, s6
    s_mov_b32 s29, s7
    s_mov_b32 s30, 2457600
    s_mov_b32 s31, 0x00020000
    s_add_u32 m0, s65, 0
    s_mov_b32 exec_lo, s78
    buffer_load_dwordx4 v15, s[24:27], s75 offen lds
    s_add_u32 m0, s65, 1024
    s_mov_b32 exec_lo, -1
    buffer_load_dwordx4 v16, s[24:27], s75 offen lds
    s_add_u32 m0, s65, 2048
    s_mov_b32 exec_hi, 0
    buffer_load_dwordx4 v17, s[24:27], s75 offen lds
    s_mov_b32 exec_hi, -1
    s_add_u32 s75, s75, s96
    s_cmp_eq_u32 s75, s97
    s_cselect_b32 s75, s98, s75
    s_mov_b32 exec_hi, 0x0fffffff
    s_add_u32 m0, s64, 10240
    s_add_u32 s61, s76, 0
    buffer_load_dwordx4 v18, s[28:31], s61 offen lds
    s_add_u32 m0, s64, 11200
    s_add_u32 s61, s76, 7680
    buffer_load_dwordx4 v18, s[28:31], s61 offen lds
    s_add_u32 m0, s64, 12160
    s_add_u32 s61, s76, 30720
    buffer_load_dwordx4 v18, s[28:31], s61 offen lds
    s_add_u32 m0, s64, 13120
    s_add_u32 s61, s76, 38400
    buffer_load_dwordx4 v18, s[28:31], s61 offen lds
    s_mov_b32 exec_hi, -1
    s_add_u32 s76, s76, s99
    s_cmp_eq_u32 s76, s100
    s_cselect_b32 s76, s101, s76
    s_mov_b32 exec_hi, 0x0fffffff
    s_add_u32 m0, s64, 25600
    s_add_u32 s61, s76, 0
    buffer_load_dwordx4 v18, s[28:31], s61 offen lds
    s_add_u32 m0, s64, 26560
    s_add_u32 s61, s76, 7680
    buffer_load_dwordx4 v18, s[28:31], s61 offen lds
    s_add_u32 m0, s64, 27520
    s_add_u32 s61, s76, 30720
    buffer_load_dwordx4 v18, s[28:31], s61 offen lds
    s_add_u32 m0, s64, 28480
    s_add_u32 s61, s76, 38400
    buffer_load_dwordx4 v18, s[28:31], s61 offen lds
    s_mov_b32 exec_hi, -1
    s_add_u32 s76, s76, s99
    s_cmp_eq_u32 s76, s100
    s_cselect_b32 s76, s101, s76
    s_waitcnt lgkmcnt(0)
    s_lshl_b32 s3, s56, 21
    s_add_u32 s52, s20, s3
    s_addc_u32 s53, s21, 0
    s_mov_b32 s54, 2097152
    s_mov_b32 s55, 0x00020000
    s_mov_b32 s32, s8
    s_mov_b32 s33, s9
    s_mov_b32 s34, 819200
    s_mov_b32 s35, 0x00020000
    s_mov_b32 s36, s12
    s_mov_b32 s37, s13
    s_mov_b32 s38, 2211840
    s_mov_b32 s39, 0x00020000
    s_mov_b32 s40, s14
    s_mov_b32 s41, s15
    s_mov_b32 s42, 2211840
    s_mov_b32 s43, 0x00020000
    v_mov_b32 v20, 0
    v_mov_b32 v21, 0
    v_mov_b32 v22, 0
    v_mov_b32 v23, 0
    v_mov_b32 v24, 0
    v_mov_b32 v25, 0
    v_lshlrev_b32 v26, 4, v1
    v_add_u32 v26, s65, v26
    v_mov_b32 v12, 0x3f803f80
    v_add_u32 v27, 0x10000, v26
    v_add_u32 v28, 0x20000, v26
    s_mul_i32 s66, s57, 26
    s_lshr_b32 s66, s66, 8
    s_mul_i32 s3, s66, 10
    s_sub_u32 s67, s57, s3
    s_lshl_b32 s68, s56, 8
    s_mul_i32 s63, s66, 88
    s_add_u32 s68, s68, s63
    s_cmp_eq_u32 s66, 2
    s_cselect_b32 s69, 0, 8
    s_add_u32 s69, s69, 80
    v_lshrrev_b32 v2, 3, v1
    v_and_b32 v3, 3, v2
    v_lshrrev_b32 v4, 2, v2
    v_mul_u32_u24 v4, 8, v4
    v_add_u32 v3, v3, v4
    v_mul_u32_u24 v44, 1280, v3
    v_lshrrev_b32 v2, 4, v1
    v_lshlrev_b32 v2, 1, v2
    v_and_b32 v3, 7, v1
    v_xor_b32 v3, v3, v2
    v_lshl_add_u32 v44, v3, 4, v44
    s_lshl_b32 s3, s67, 7
    v_add_u32 v44, s3, v44
    v_lshrrev_b32 v2, 3, v1
    v_and_b32 v3, 3, v2
    v_lshrrev_b32 v4, 2, v2
    v_mul_u32_u24 v4, 40, v4
    v_add_u32 v3, v3, v4
    v_mul_u32_u24 v45, 1280, v3
    v_lshrrev_b32 v2, 4, v1
    v_lshlrev_b32 v2, 1, v2
    v_and_b32 v3, 7, v1
    v_xor_b32 v3, v3, v2
    v_lshl_add_u32 v45, v3, 4, v45
    s_lshl_b32 s3, s67, 7
    v_add_u32 v45, s3, v45
    s_sub_u32 s60, s57, 30
    s_lshl_b32 s60, s60, 3
    s_add_u32 s60, s60, s56
    v_lshrrev_b32 v2, 4, v1
    v_and_b32 v3, 15, v1
    v_mul_u32_u24 v46, 3456, v2
    v_lshl_add_u32 v46, v3, 4, v46
    s_mul_i32 s91, s22, 276480
    s_lshl_b32 s3, s60, 8
    s_add_u32 s91, s91, s3
    s_cmp_ge_u32 s60, 14
    s_cselect_b32 s3, 2147483648, 0
    v_or_b32 v46, s3, v46
    s_mul_i32 s89, s23, 204800
    s_mul_i32 s79, s23, 5
    s_lshl_b32 s3, s67, 1
    s_add_u32 s79, s79, 20
    s_sub_u32 s79, s79, s3
    s_sub_u32 s3, s79, 20
    s_cmp_ge_u32 s79, 20
    s_cselect_b32 s79, s3, s79
    s_lshl_b32 s79, s79, 12
    s_waitcnt vmcnt(4)
    s_barrier
    s_add_u32 m0, s65, 40960
    s_mov_b32 exec_lo, s78
    buffer_load_dwordx4 v15, s[24:27], s75 offen lds
    s_add_u32 m0, s65, 41984
    s_mov_b32 exec_lo, -1
    buffer_load_dwordx4 v16, s[24:27], s75 offen lds
    s_add_u32 m0, s65, 43008
    s_mov_b32 exec_hi, 0
    buffer_load_dwordx4 v17, s[24:27], s75 offen lds
    s_mov_b32 exec_hi, -1
    s_add_u32 s75, s75, s96
    s_cmp_eq_u32 s75, s97
    s_cselect_b32 s75, s98, s75
    s_mov_b32 exec_hi, 0x0fffffff
    s_add_u32 m0, s64, 51200
    s_add_u32 s61, s76, 0
    buffer_load_dwordx4 v18, s[28:31], s61 offen lds
    s_add_u32 m0, s64, 52160
    s_add_u32 s61, s76, 7680
    buffer_load_dwordx4 v18, s[28:31], s61 offen lds
    s_add_u32 m0, s64, 53120
    s_add_u32 s61, s76, 30720
    buffer_load_dwordx4 v18, s[28:31], s61 offen lds
    s_add_u32 m0, s64, 54080
    s_add_u32 s61, s76, 38400
    buffer_load_dwordx4 v18, s[28:31], s61 offen lds
    s_mov_b32 exec_hi, -1
    s_add_u32 s76, s76, s99
    s_cmp_eq_u32 s76, s100
    s_cselect_b32 s76, s101, s76
    s_mov_b32 exec_hi, 0x0fffffff
    s_add_u32 m0, s64, 66560
    s_add_u32 s61, s76, 0
    buffer_load_dwordx4 v18, s[28:31], s61 offen lds
    s_add_u32 m0, s64, 67520
    s_add_u32 s61, s76, 7680
    buffer_load_dwordx4 v18, s[28:31], s61 offen lds
    s_add_u32 m0, s64, 68480
    s_add_u32 s61, s76, 30720
    buffer_load_dwordx4 v18, s[28:31], s61 offen lds
    s_add_u32 m0, s64, 69440
    s_add_u32 s61, s76, 38400
    buffer_load_dwordx4 v18, s[28:31], s61 offen lds
    s_mov_b32 exec_hi, -1
    s_add_u32 s76, s76, s99
    s_cmp_eq_u32 s76, s100
    s_cselect_b32 s76, s101, s76
    ds_read_b128 v[32:35], v26 offset:0
    ds_read_b128 v[36:39], v26 offset:1024
    ds_read_b128 v[40:43], v26 offset:2048
    s_waitcnt lgkmcnt(0)
    v_dot2c_f32_bf16 v20, v32, v12
    v_dot2c_f32_bf16 v21, v32, v32
    v_dot2c_f32_bf16 v22, v36, v12
    v_dot2c_f32_bf16 v23, v36, v36
    v_dot2c_f32_bf16 v24, v40, v12
    v_dot2c_f32_bf16 v25, v40, v40
    v_dot2c_f32_bf16 v20, v33, v12
    v_dot2c_f32_bf16 v21, v33, v33
    v_dot2c_f32_bf16 v22, v37, v12
    v_dot2c_f32_bf16 v23, v37, v37
    v_dot2c_f32_bf16 v24, v41, v12
    v_dot2c_f32_bf16 v25, v41, v41
    v_dot2c_f32_bf16 v20, v34, v12
    v_dot2c_f32_bf16 v21, v34, v34
    v_dot2c_f32_bf16 v22, v38, v12
    v_dot2c_f32_bf16 v23, v38, v38
    v_dot2c_f32_bf16 v24, v42, v12
    v_dot2c_f32_bf16 v25, v42, v42
    v_dot2c_f32_bf16 v20, v35, v12
    v_dot2c_f32_bf16 v21, v35, v35
    v_dot2c_f32_bf16 v22, v39, v12
    v_dot2c_f32_bf16 v23, v39, v39
    v_dot2c_f32_bf16 v24, v43, v12
    v_dot2c_f32_bf16 v25, v43, v43
    s_waitcnt vmcnt(11)
    s_barrier
    s_add_u32 m0, s65, 81920
    s_mov_b32 exec_lo, s78
    buffer_load_dwordx4 v15, s[24:27], s75 offen lds
    s_add_u32 m0, s65, 82944
    s_mov_b32 exec_lo, -1
    buffer_load_dwordx4 v16, s[24:27], s75 offen lds
    s_add_u32 m0, s65, 83968
    s_mov_b32 exec_hi, 0
    buffer_load_dwordx4 v17, s[24:27], s75 offen lds
    s_mov_b32 exec_hi, -1
    s_add_u32 s75, s75, s96
    s_cmp_eq_u32 s75, s97
    s_cselect_b32 s75, s98, s75
    s_mov_b32 exec_hi, 0x0fffffff
    s_add_u32 m0, s64, 92160
    s_add_u32 s61, s76, 0
    buffer_load_dwordx4 v18, s[28:31], s61 offen lds
    s_add_u32 m0, s64, 93120
    s_add_u32 s61, s76, 7680
    buffer_load_dwordx4 v18, s[28:31], s61 offen lds
    s_add_u32 m0, s64, 94080
    s_add_u32 s61, s76, 30720
    buffer_load_dwordx4 v18, s[28:31], s61 offen lds
    s_add_u32 m0, s64, 95040
    s_add_u32 s61, s76, 38400
    buffer_load_dwordx4 v18, s[28:31], s61 offen lds
    s_mov_b32 exec_hi, -1
    s_add_u32 s76, s76, s99
    s_cmp_eq_u32 s76, s100
    s_cselect_b32 s76, s101, s76
    s_waitcnt vmcnt(11)
    s_barrier
    s_mov_b32 exec_hi, 0x0fffffff
    s_add_u32 m0, s64, 107520
    s_add_u32 s61, s76, 0
    buffer_load_dwordx4 v18, s[28:31], s61 offen lds
    s_add_u32 m0, s64, 108480
    s_add_u32 s61, s76, 7680
    buffer_load_dwordx4 v18, s[28:31], s61 offen lds
    s_add_u32 m0, s64, 109440
    s_add_u32 s61, s76, 30720
    buffer_load_dwordx4 v18, s[28:31], s61 offen lds
    s_add_u32 m0, s64, 110400
    s_add_u32 s61, s76, 38400
    buffer_load_dwordx4 v18, s[28:31], s61 offen lds
    s_mov_b32 exec_hi, -1
    s_add_u32 s76, s76, s99
    s_cmp_eq_u32 s76, s100
    s_cselect_b32 s76, s101, s76
    ds_read_b128 v[32:35], v26 offset:40960
    ds_read_b128 v[36:39], v26 offset:41984
    ds_read_b128 v[40:43], v26 offset:43008
    s_waitcnt lgkmcnt(0)
    v_dot2c_f32_bf16 v20, v32, v12
    v_dot2c_f32_bf16 v21, v32, v32
    v_dot2c_f32_bf16 v22, v36, v12
    v_dot2c_f32_bf16 v23, v36, v36
    v_dot2c_f32_bf16 v24, v40, v12
    v_dot2c_f32_bf16 v25, v40, v40
    v_dot2c_f32_bf16 v20, v33, v12
    v_dot2c_f32_bf16 v21, v33, v33
    v_dot2c_f32_bf16 v22, v37, v12
    v_dot2c_f32_bf16 v23, v37, v37
    v_dot2c_f32_bf16 v24, v41, v12
    v_dot2c_f32_bf16 v25, v41, v41
    v_dot2c_f32_bf16 v20, v34, v12
    v_dot2c_f32_bf16 v21, v34, v34
    v_dot2c_f32_bf16 v22, v38, v12
    v_dot2c_f32_bf16 v23, v38, v38
    v_dot2c_f32_bf16 v24, v42, v12
    v_dot2c_f32_bf16 v25, v42, v42
    v_dot2c_f32_bf16 v20, v35, v12
    v_dot2c_f32_bf16 v21, v35, v35
    v_dot2c_f32_bf16 v22, v39, v12
    v_dot2c_f32_bf16 v23, v39, v39
    v_dot2c_f32_bf16 v24, v43, v12
    v_dot2c_f32_bf16 v25, v43, v43
    s_waitcnt vmcnt(11)
    s_barrier
    s_add_u32 m0, s65, 122880
    s_mov_b32 exec_lo, s78
    buffer_load_dwordx4 v15, s[24:27], s75 offen lds
    s_add_u32 m0, s65, 123904
    s_mov_b32 exec_lo, -1
    buffer_load_dwordx4 v16, s[24:27], s75 offen lds
    s_add_u32 m0, s65, 124928
    s_mov_b32 exec_hi, 0
    buffer_load_dwordx4 v17, s[24:27], s75 offen lds
    s_mov_b32 exec_hi, -1
    s_add_u32 s75, s75, s96
    s_cmp_eq_u32 s75, s97
    s_cselect_b32 s75, s98, s75
    s_mov_b32 exec_hi, 0x0fffffff
    s_add_u32 m0, s64, 133120
    s_add_u32 s61, s76, 0
    buffer_load_dwordx4 v18, s[28:31], s61 offen lds
    s_add_u32 m0, s64, 134080
    s_add_u32 s61, s76, 7680
    buffer_load_dwordx4 v18, s[28:31], s61 offen lds
    s_add_u32 m0, s64, 135040
    s_add_u32 s61, s76, 30720
    buffer_load_dwordx4 v18, s[28:31], s61 offen lds
    s_add_u32 m0, s64, 136000
    s_add_u32 s61, s76, 38400
    buffer_load_dwordx4 v18, s[28:31], s61 offen lds
    s_mov_b32 exec_hi, -1
    s_add_u32 s76, s76, s99
    s_cmp_eq_u32 s76, s100
    s_cselect_b32 s76, s101, s76
    s_waitcnt vmcnt(11)
    s_barrier
    s_mov_b32 exec_hi, 0x0fffffff
    s_add_u32 m0, s64, 148480
    s_add_u32 s61, s76, 0
    buffer_load_dwordx4 v18, s[28:31], s61 offen lds
    s_add_u32 m0, s64, 149440
    s_add_u32 s61, s76, 7680
    buffer_load_dwordx4 v18, s[28:31], s61 offen lds
    s_add_u32 m0, s64, 150400
    s_add_u32 s61, s76, 30720
    buffer_load_dwordx4 v18, s[28:31], s61 offen lds
    s_add_u32 m0, s64, 151360
    s_add_u32 s61, s76, 38400
    buffer_load_dwordx4 v18, s[28:31], s61 offen lds
    s_mov_b32 exec_hi, -1
    s_add_u32 s76, s76, s99
    s_cmp_eq_u32 s76, s100
    s_cselect_b32 s76, s101, s76
    ds_read_b128 v[32:35], v27 offset:16384
    ds_read_b128 v[36:39], v27 offset:17408
    ds_read_b128 v[40:43], v27 offset:18432
    s_waitcnt lgkmcnt(0)
    v_dot2c_f32_bf16 v20, v32, v12
    v_dot2c_f32_bf16 v21, v32, v32
    v_dot2c_f32_bf16 v22, v36, v12
    v_dot2c_f32_bf16 v23, v36, v36
    v_dot2c_f32_bf16 v24, v40, v12
    v_dot2c_f32_bf16 v25, v40, v40
    v_dot2c_f32_bf16 v20, v33, v12
    v_dot2c_f32_bf16 v21, v33, v33
    v_dot2c_f32_bf16 v22, v37, v12
    v_dot2c_f32_bf16 v23, v37, v37
    v_dot2c_f32_bf16 v24, v41, v12
    v_dot2c_f32_bf16 v25, v41, v41
    v_dot2c_f32_bf16 v20, v34, v12
    v_dot2c_f32_bf16 v21, v34, v34
    v_dot2c_f32_bf16 v22, v38, v12
    v_dot2c_f32_bf16 v23, v38, v38
    v_dot2c_f32_bf16 v24, v42, v12
    v_dot2c_f32_bf16 v25, v42, v42
    v_dot2c_f32_bf16 v20, v35, v12
    v_dot2c_f32_bf16 v21, v35, v35
    v_dot2c_f32_bf16 v22, v39, v12
    v_dot2c_f32_bf16 v23, v39, v39
    v_dot2c_f32_bf16 v24, v43, v12
    v_dot2c_f32_bf16 v25, v43, v43
    s_waitcnt vmcnt(11)
    s_barrier
    s_add_u32 m0, s65, 0
    s_mov_b32 exec_lo, s78
    buffer_load_dwordx4 v15, s[24:27], s75 offen lds
    s_add_u32 m0, s65, 1024
    s_mov_b32 exec_lo, -1
    buffer_load_dwordx4 v16, s[24:27], s75 offen lds
    s_add_u32 m0, s65, 2048
    s_mov_b32 exec_hi, 0
    buffer_load_dwordx4 v17, s[24:27], s75 offen lds
    s_mov_b32 exec_hi, -1
    s_add_u32 s75, s75, s96
    s_cmp_eq_u32 s75, s97
    s_cselect_b32 s75, s98, s75
    s_mov_b32 exec_hi, 0x0fffffff
    s_add_u32 m0, s64, 10240
    s_add_u32 s61, s76, 0
    buffer_load_dwordx4 v18, s[28:31], s61 offen lds
    s_add_u32 m0, s64, 11200
    s_add_u32 s61, s76, 7680
    buffer_load_dwordx4 v18, s[28:31], s61 offen lds
    s_add_u32 m0, s64, 12160
    s_add_u32 s61, s76, 30720
    buffer_load_dwordx4 v18, s[28:31], s61 offen lds
    s_add_u32 m0, s64, 13120
    s_add_u32 s61, s76, 38400
    buffer_load_dwordx4 v18, s[28:31], s61 offen lds
    s_mov_b32 exec_hi, -1
    s_add_u32 s76, s76, s99
    s_cmp_eq_u32 s76, s100
    s_cselect_b32 s76, s101, s76
    s_waitcnt vmcnt(11)
    s_barrier
    s_mov_b32 exec_hi, 0x0fffffff
    s_add_u32 m0, s64, 25600
    s_add_u32 s61, s76, 0
    buffer_load_dwordx4 v18, s[28:31], s61 offen lds
    s_add_u32 m0, s64, 26560
    s_add_u32 s61, s76, 7680
    buffer_load_dwordx4 v18, s[28:31], s61 offen lds
    s_add_u32 m0, s64, 27520
    s_add_u32 s61, s76, 30720
    buffer_load_dwordx4 v18, s[28:31], s61 offen lds
    s_add_u32 m0, s64, 28480
    s_add_u32 s61, s76, 38400
    buffer_load_dwordx4 v18, s[28:31], s61 offen lds
    s_mov_b32 exec_hi, -1
    s_add_u32 s76, s76, s99
    s_cmp_eq_u32 s76, s100
    s_cselect_b32 s76, s101, s76
    ds_read_b128 v[32:35], v27 offset:57344
    ds_read_b128 v[36:39], v27 offset:58368
    ds_read_b128 v[40:43], v27 offset:59392
    s_waitcnt lgkmcnt(0)
    v_dot2c_f32_bf16 v20, v32, v12
    v_dot2c_f32_bf16 v21, v32, v32
    v_dot2c_f32_bf16 v22, v36, v12
    v_dot2c_f32_bf16 v23, v36, v36
    v_dot2c_f32_bf16 v24, v40, v12
    v_dot2c_f32_bf16 v25, v40, v40
    v_dot2c_f32_bf16 v20, v33, v12
    v_dot2c_f32_bf16 v21, v33, v33
    v_dot2c_f32_bf16 v22, v37, v12
    v_dot2c_f32_bf16 v23, v37, v37
    v_dot2c_f32_bf16 v24, v41, v12
    v_dot2c_f32_bf16 v25, v41, v41
    v_dot2c_f32_bf16 v20, v34, v12
    v_dot2c_f32_bf16 v21, v34, v34
    v_dot2c_f32_bf16 v22, v38, v12
    v_dot2c_f32_bf16 v23, v38, v38
    v_dot2c_f32_bf16 v24, v42, v12
    v_dot2c_f32_bf16 v25, v42, v42
    v_dot2c_f32_bf16 v20, v35, v12
    v_dot2c_f32_bf16 v21, v35, v35
    v_dot2c_f32_bf16 v22, v39, v12
    v_dot2c_f32_bf16 v23, v39, v39
    v_dot2c_f32_bf16 v24, v43, v12
    v_dot2c_f32_bf16 v25, v43, v43
    s_waitcnt vmcnt(11)
    s_barrier
    s_add_u32 m0, s65, 40960
    s_mov_b32 exec_lo, s78
    buffer_load_dwordx4 v15, s[24:27], s75 offen lds
    s_add_u32 m0, s65, 41984
    s_mov_b32 exec_lo, -1
    buffer_load_dwordx4 v16, s[24:27], s75 offen lds
    s_add_u32 m0, s65, 43008
    s_mov_b32 exec_hi, 0
    buffer_load_dwordx4 v17, s[24:27], s75 offen lds
    s_mov_b32 exec_hi, -1
    s_add_u32 s75, s75, s96
    s_cmp_eq_u32 s75, s97
    s_cselect_b32 s75, s98, s75
    s_mov_b32 exec_hi, 0x0fffffff
    s_add_u32 m0, s64, 51200
    s_add_u32 s61, s76, 0
    buffer_load_dwordx4 v18, s[28:31], s61 offen lds
    s_add_u32 m0, s64, 52160
    s_add_u32 s61, s76, 7680
    buffer_load_dwordx4 v18, s[28:31], s61 offen lds
    s_add_u32 m0, s64, 53120
    s_add_u32 s61, s76, 30720
    buffer_load_dwordx4 v18, s[28:31], s61 offen lds
    s_add_u32 m0, s64, 54080
    s_add_u32 s61, s76, 38400
    buffer_load_dwordx4 v18, s[28:31], s61 offen lds
    s_mov_b32 exec_hi, -1
    s_add_u32 s76, s76, s99
    s_cmp_eq_u32 s76, s100
    s_cselect_b32 s76, s101, s76
    s_waitcnt vmcnt(11)
    s_barrier
    s_mov_b32 exec_hi, 0x0fffffff
    s_add_u32 m0, s64, 66560
    s_add_u32 s61, s76, 0
    buffer_load_dwordx4 v18, s[28:31], s61 offen lds
    s_add_u32 m0, s64, 67520
    s_add_u32 s61, s76, 7680
    buffer_load_dwordx4 v18, s[28:31], s61 offen lds
    s_add_u32 m0, s64, 68480
    s_add_u32 s61, s76, 30720
    buffer_load_dwordx4 v18, s[28:31], s61 offen lds
    s_add_u32 m0, s64, 69440
    s_add_u32 s61, s76, 38400
    buffer_load_dwordx4 v18, s[28:31], s61 offen lds
    s_mov_b32 exec_hi, -1
    s_add_u32 s76, s76, s99
    s_cmp_eq_u32 s76, s100
    s_cselect_b32 s76, s101, s76
    ds_read_b128 v[32:35], v26 offset:0
    ds_read_b128 v[36:39], v26 offset:1024
    ds_read_b128 v[40:43], v26 offset:2048
    s_waitcnt lgkmcnt(0)
    v_dot2c_f32_bf16 v20, v32, v12
    v_dot2c_f32_bf16 v21, v32, v32
    v_dot2c_f32_bf16 v22, v36, v12
    v_dot2c_f32_bf16 v23, v36, v36
    v_dot2c_f32_bf16 v24, v40, v12
    v_dot2c_f32_bf16 v25, v40, v40
    v_dot2c_f32_bf16 v20, v33, v12
    v_dot2c_f32_bf16 v21, v33, v33
    v_dot2c_f32_bf16 v22, v37, v12
    v_dot2c_f32_bf16 v23, v37, v37
    v_dot2c_f32_bf16 v24, v41, v12
    v_dot2c_f32_bf16 v25, v41, v41
    v_dot2c_f32_bf16 v20, v34, v12
    v_dot2c_f32_bf16 v21, v34, v34
    v_dot2c_f32_bf16 v22, v38, v12
    v_dot2c_f32_bf16 v23, v38, v38
    v_dot2c_f32_bf16 v24, v42, v12
    v_dot2c_f32_bf16 v25, v42, v42
    v_dot2c_f32_bf16 v20, v35, v12
    v_dot2c_f32_bf16 v21, v35, v35
    v_dot2c_f32_bf16 v22, v39, v12
    v_dot2c_f32_bf16 v23, v39, v39
    v_dot2c_f32_bf16 v24, v43, v12
    v_dot2c_f32_bf16 v25, v43, v43
    s_waitcnt vmcnt(11)
    s_barrier
    s_add_u32 m0, s65, 81920
    s_mov_b32 exec_lo, s78
    buffer_load_dwordx4 v15, s[24:27], s75 offen lds
    s_add_u32 m0, s65, 82944
    s_mov_b32 exec_lo, -1
    buffer_load_dwordx4 v16, s[24:27], s75 offen lds
    s_add_u32 m0, s65, 83968
    s_mov_b32 exec_hi, 0
    buffer_load_dwordx4 v17, s[24:27], s75 offen lds
    s_mov_b32 exec_hi, -1
    s_add_u32 s75, s75, s96
    s_cmp_eq_u32 s75, s97
    s_cselect_b32 s75, s98, s75
    s_mov_b32 exec_hi, 0x0fffffff
    s_add_u32 m0, s64, 92160
    s_add_u32 s61, s76, 0
    buffer_load_dwordx4 v18, s[28:31], s61 offen lds
    s_add_u32 m0, s64, 93120
    s_add_u32 s61, s76, 7680
    buffer_load_dwordx4 v18, s[28:31], s61 offen lds
    s_add_u32 m0, s64, 94080
    s_add_u32 s61, s76, 30720
    buffer_load_dwordx4 v18, s[28:31], s61 offen lds
    s_add_u32 m0, s64, 95040
    s_add_u32 s61, s76, 38400
    buffer_load_dwordx4 v18, s[28:31], s61 offen lds
    s_mov_b32 exec_hi, -1
    s_add_u32 s76, s76, s99
    s_cmp_eq_u32 s76, s100
    s_cselect_b32 s76, s101, s76
    s_waitcnt vmcnt(11)
    s_barrier
    s_mov_b32 exec_hi, 0x0fffffff
    s_add_u32 m0, s64, 107520
    s_add_u32 s61, s76, 0
    buffer_load_dwordx4 v18, s[28:31], s61 offen lds
    s_add_u32 m0, s64, 108480
    s_add_u32 s61, s76, 7680
    buffer_load_dwordx4 v18, s[28:31], s61 offen lds
    s_add_u32 m0, s64, 109440
    s_add_u32 s61, s76, 30720
    buffer_load_dwordx4 v18, s[28:31], s61 offen lds
    s_add_u32 m0, s64, 110400
    s_add_u32 s61, s76, 38400
    buffer_load_dwordx4 v18, s[28:31], s61 offen lds
    s_mov_b32 exec_hi, -1
    s_add_u32 s76, s76, s99
    s_cmp_eq_u32 s76, s100
    s_cselect_b32 s76, s101, s76
    ds_read_b128 v[32:35], v26 offset:40960
    ds_read_b128 v[36:39], v26 offset:41984
    ds_read_b128 v[40:43], v26 offset:43008
    s_waitcnt lgkmcnt(0)
    v_dot2c_f32_bf16 v20, v32, v12
    v_dot2c_f32_bf16 v21, v32, v32
    v_dot2c_f32_bf16 v22, v36, v12
    v_dot2c_f32_bf16 v23, v36, v36
    v_dot2c_f32_bf16 v24, v40, v12
    v_dot2c_f32_bf16 v25, v40, v40
    v_dot2c_f32_bf16 v20, v33, v12
    v_dot2c_f32_bf16 v21, v33, v33
    v_dot2c_f32_bf16 v22, v37, v12
    v_dot2c_f32_bf16 v23, v37, v37
    v_dot2c_f32_bf16 v24, v41, v12
    v_dot2c_f32_bf16 v25, v41, v41
    v_dot2c_f32_bf16 v20, v34, v12
    v_dot2c_f32_bf16 v21, v34, v34
    v_dot2c_f32_bf16 v22, v38, v12
    v_dot2c_f32_bf16 v23, v38, v38
    v_dot2c_f32_bf16 v24, v42, v12
    v_dot2c_f32_bf16 v25, v42, v42
    v_dot2c_f32_bf16 v20, v35, v12
    v_dot2c_f32_bf16 v21, v35, v35
    v_dot2c_f32_bf16 v22, v39, v12
    v_dot2c_f32_bf16 v23, v39, v39
    v_dot2c_f32_bf16 v24, v43, v12
    v_dot2c_f32_bf16 v25, v43, v43
    s_waitcnt vmcnt(11)
    s_barrier
    s_add_u32 m0, s65, 122880
    s_mov_b32 exec_lo, s78
    buffer_load_dwordx4 v15, s[24:27], s75 offen lds
    s_add_u32 m0, s65, 123904
    s_mov_b32 exec_lo, -1
    buffer_load_dwordx4 v16, s[24:27], s75 offen lds
    s_add_u32 m0, s65, 124928
    s_mov_b32 exec_hi, 0
    buffer_load_dwordx4 v17, s[24:27], s75 offen lds
    s_mov_b32 exec_hi, -1
    s_add_u32 s75, s75, s96
    s_cmp_eq_u32 s75, s97
    s_cselect_b32 s75, s98, s75
    s_mov_b32 exec_hi, 0x0fffffff
    s_add_u32 m0, s64, 133120
    s_add_u32 s61, s76, 0
    buffer_load_dwordx4 v18, s[28:31], s61 offen lds
    s_add_u32 m0, s64, 134080
    s_add_u32 s61, s76, 7680
    buffer_load_dwordx4 v18, s[28:31], s61 offen lds
    s_add_u32 m0, s64, 135040
    s_add_u32 s61, s76, 30720
    buffer_load_dwordx4 v18, s[28:31], s61 offen lds
    s_add_u32 m0, s64, 136000
    s_add_u32 s61, s76, 38400
    buffer_load_dwordx4 v18, s[28:31], s61 offen lds
    s_mov_b32 exec_hi, -1
    s_add_u32 s76, s76, s99
    s_cmp_eq_u32 s76, s100
    s_cselect_b32 s76, s101, s76
    s_waitcnt vmcnt(11)
    s_barrier
    s_mov_b32 exec_hi, 0x0fffffff
    s_add_u32 m0, s64, 148480
    s_add_u32 s61, s76, 0
    buffer_load_dwordx4 v18, s[28:31], s61 offen lds
    s_add_u32 m0, s64, 149440
    s_add_u32 s61, s76, 7680
    buffer_load_dwordx4 v18, s[28:31], s61 offen lds
    s_add_u32 m0, s64, 150400
    s_add_u32 s61, s76, 30720
    buffer_load_dwordx4 v18, s[28:31], s61 offen lds
    s_add_u32 m0, s64, 151360
    s_add_u32 s61, s76, 38400
    buffer_load_dwordx4 v18, s[28:31], s61 offen lds
    s_mov_b32 exec_hi, -1
    s_add_u32 s76, s76, s99
    s_cmp_eq_u32 s76, s100
    s_cselect_b32 s76, s101, s76
    ds_read_b128 v[32:35], v27 offset:16384
    ds_read_b128 v[36:39], v27 offset:17408
    ds_read_b128 v[40:43], v27 offset:18432
    s_waitcnt lgkmcnt(0)
    v_dot2c_f32_bf16 v20, v32, v12
    v_dot2c_f32_bf16 v21, v32, v32
    v_dot2c_f32_bf16 v22, v36, v12
    v_dot2c_f32_bf16 v23, v36, v36
    v_dot2c_f32_bf16 v24, v40, v12
    v_dot2c_f32_bf16 v25, v40, v40
    v_dot2c_f32_bf16 v20, v33, v12
    v_dot2c_f32_bf16 v21, v33, v33
    v_dot2c_f32_bf16 v22, v37, v12
    v_dot2c_f32_bf16 v23, v37, v37
    v_dot2c_f32_bf16 v24, v41, v12
    v_dot2c_f32_bf16 v25, v41, v41
    v_dot2c_f32_bf16 v20, v34, v12
    v_dot2c_f32_bf16 v21, v34, v34
    v_dot2c_f32_bf16 v22, v38, v12
    v_dot2c_f32_bf16 v23, v38, v38
    v_dot2c_f32_bf16 v24, v42, v12
    v_dot2c_f32_bf16 v25, v42, v42
    v_dot2c_f32_bf16 v20, v35, v12
    v_dot2c_f32_bf16 v21, v35, v35
    v_dot2c_f32_bf16 v22, v39, v12
    v_dot2c_f32_bf16 v23, v39, v39
    v_dot2c_f32_bf16 v24, v43, v12
    v_dot2c_f32_bf16 v25, v43, v43
    s_waitcnt vmcnt(11)
    s_barrier
    s_add_u32 m0, s65, 0
    s_mov_b32 exec_lo, s78
    buffer_load_dwordx4 v15, s[24:27], s75 offen lds
    s_add_u32 m0, s65, 1024
    s_mov_b32 exec_lo, -1
    buffer_load_dwordx4 v16, s[24:27], s75 offen lds
    s_add_u32 m0, s65, 2048
    s_mov_b32 exec_hi, 0
    buffer_load_dwordx4 v17, s[24:27], s75 offen lds
    s_mov_b32 exec_hi, -1
    s_add_u32 s75, s75, s96
    s_cmp_eq_u32 s75, s97
    s_cselect_b32 s75, s98, s75
    s_mov_b32 exec_hi, 0x0fffffff
    s_add_u32 m0, s64, 10240
    s_add_u32 s61, s76, 0
    buffer_load_dwordx4 v18, s[28:31], s61 offen lds
    s_add_u32 m0, s64, 11200
    s_add_u32 s61, s76, 7680
    buffer_load_dwordx4 v18, s[28:31], s61 offen lds
    s_add_u32 m0, s64, 12160
    s_add_u32 s61, s76, 30720
    buffer_load_dwordx4 v18, s[28:31], s61 offen lds
    s_add_u32 m0, s64, 13120
    s_add_u32 s61, s76, 38400
    buffer_load_dwordx4 v18, s[28:31], s61 offen lds
    s_mov_b32 exec_hi, -1
    s_add_u32 s76, s76, s99
    s_cmp_eq_u32 s76, s100
    s_cselect_b32 s76, s101, s76
    s_waitcnt vmcnt(11)
    s_barrier
    s_mov_b32 exec_hi, 0x0fffffff
    s_add_u32 m0, s64, 25600
    s_add_u32 s61, s76, 0
    buffer_load_dwordx4 v18, s[28:31], s61 offen lds
    s_add_u32 m0, s64, 26560
    s_add_u32 s61, s76, 7680
    buffer_load_dwordx4 v18, s[28:31], s61 offen lds
    s_add_u32 m0, s64, 27520
    s_add_u32 s61, s76, 30720
    buffer_load_dwordx4 v18, s[28:31], s61 offen lds
    s_add_u32 m0, s64, 28480
    s_add_u32 s61, s76, 38400
    buffer_load_dwordx4 v18, s[28:31], s61 offen lds
    s_mov_b32 exec_hi, -1
    s_add_u32 s76, s76, s99
    s_cmp_eq_u32 s76, s100
    s_cselect_b32 s76, s101, s76
    ds_read_b128 v[32:35], v27 offset:57344
    ds_read_b128 v[36:39], v27 offset:58368
    ds_read_b128 v[40:43], v27 offset:59392
    s_waitcnt lgkmcnt(0)
    v_dot2c_f32_bf16 v20, v32, v12
    v_dot2c_f32_bf16 v21, v32, v32
    v_dot2c_f32_bf16 v22, v36, v12
    v_dot2c_f32_bf16 v23, v36, v36
    v_dot2c_f32_bf16 v24, v40, v12
    v_dot2c_f32_bf16 v25, v40, v40
    v_dot2c_f32_bf16 v20, v33, v12
    v_dot2c_f32_bf16 v21, v33, v33
    v_dot2c_f32_bf16 v22, v37, v12
    v_dot2c_f32_bf16 v23, v37, v37
    v_dot2c_f32_bf16 v24, v41, v12
    v_dot2c_f32_bf16 v25, v41, v41
    v_dot2c_f32_bf16 v20, v34, v12
    v_dot2c_f32_bf16 v21, v34, v34
    v_dot2c_f32_bf16 v22, v38, v12
    v_dot2c_f32_bf16 v23, v38, v38
    v_dot2c_f32_bf16 v24, v42, v12
    v_dot2c_f32_bf16 v25, v42, v42
    v_dot2c_f32_bf16 v20, v35, v12
    v_dot2c_f32_bf16 v21, v35, v35
    v_dot2c_f32_bf16 v22, v39, v12
    v_dot2c_f32_bf16 v23, v39, v39
    v_dot2c_f32_bf16 v24, v43, v12
    v_dot2c_f32_bf16 v25, v43, v43
    s_waitcnt vmcnt(11)
    s_barrier
    s_add_u32 m0, s65, 40960
    s_mov_b32 exec_lo, s78
    buffer_load_dwordx4 v15, s[24:27], s75 offen lds
    s_add_u32 m0, s65, 41984
    s_mov_b32 exec_lo, -1
    buffer_load_dwordx4 v16, s[24:27], s75 offen lds
    s_add_u32 m0, s65, 43008
    s_mov_b32 exec_hi, 0
    buffer_load_dwordx4 v17, s[24:27], s75 offen lds
    s_mov_b32 exec_hi, -1
    s_add_u32 s75, s75, s96
    s_cmp_eq_u32 s75, s97
    s_cselect_b32 s75, s98, s75
    s_mov_b32 exec_hi, 0x0fffffff
    s_add_u32 m0, s64, 51200
    s_add_u32 s61, s76, 0
    buffer_load_dwordx4 v18, s[28:31], s61 offen lds
    s_add_u32 m0, s64, 52160
    s_add_u32 s61, s76, 7680
    buffer_load_dwordx4 v18, s[28:31], s61 offen lds
    s_add_u32 m0, s64, 53120
    s_add_u32 s61, s76, 30720
    buffer_load_dwordx4 v18, s[28:31], s61 offen lds
    s_add_u32 m0, s64, 54080
    s_add_u32 s61, s76, 38400
    buffer_load_dwordx4 v18, s[28:31], s61 offen lds
    s_mov_b32 exec_hi, -1
    s_add_u32 s76, s76, s99
    s_cmp_eq_u32 s76, s100
    s_cselect_b32 s76, s101, s76
    s_waitcnt vmcnt(11)
    s_barrier
    s_mov_b32 exec_hi, 0x0fffffff
    s_add_u32 m0, s64, 66560
    s_add_u32 s61, s76, 0
    buffer_load_dwordx4 v18, s[28:31], s61 offen lds
    s_add_u32 m0, s64, 67520
    s_add_u32 s61, s76, 7680
    buffer_load_dwordx4 v18, s[28:31], s61 offen lds
    s_add_u32 m0, s64, 68480
    s_add_u32 s61, s76, 30720
    buffer_load_dwordx4 v18, s[28:31], s61 offen lds
    s_add_u32 m0, s64, 69440
    s_add_u32 s61, s76, 38400
    buffer_load_dwordx4 v18, s[28:31], s61 offen lds
    s_mov_b32 exec_hi, -1
    s_add_u32 s76, s76, s99
    s_cmp_eq_u32 s76, s100
    s_cselect_b32 s76, s101, s76
    ds_read_b128 v[32:35], v26 offset:0
    ds_read_b128 v[36:39], v26 offset:1024
    ds_read_b128 v[40:43], v26 offset:2048
    s_waitcnt lgkmcnt(0)
    v_dot2c_f32_bf16 v20, v32, v12
    v_dot2c_f32_bf16 v21, v32, v32
    v_dot2c_f32_bf16 v22, v36, v12
    v_dot2c_f32_bf16 v23, v36, v36
    v_dot2c_f32_bf16 v24, v40, v12
    v_dot2c_f32_bf16 v25, v40, v40
    v_dot2c_f32_bf16 v20, v33, v12
    v_dot2c_f32_bf16 v21, v33, v33
    v_dot2c_f32_bf16 v22, v37, v12
    v_dot2c_f32_bf16 v23, v37, v37
    v_dot2c_f32_bf16 v24, v41, v12
    v_dot2c_f32_bf16 v25, v41, v41
    v_dot2c_f32_bf16 v20, v34, v12
    v_dot2c_f32_bf16 v21, v34, v34
    v_dot2c_f32_bf16 v22, v38, v12
    v_dot2c_f32_bf16 v23, v38, v38
    v_dot2c_f32_bf16 v24, v42, v12
    v_dot2c_f32_bf16 v25, v42, v42
    v_dot2c_f32_bf16 v20, v35, v12
    v_dot2c_f32_bf16 v21, v35, v35
    v_dot2c_f32_bf16 v22, v39, v12
    v_dot2c_f32_bf16 v23, v39, v39
    v_dot2c_f32_bf16 v24, v43, v12
    v_dot2c_f32_bf16 v25, v43, v43
    s_waitcnt vmcnt(11)
    s_barrier
    s_cmp_ge_u32 s57, 30
    s_cbranch_scc1 csl_3
    s_add_u32 m0, s79, 81920
    s_add_u32 s61, s89, 0
    buffer_load_dwordx4 v44, s[32:35], s61 offen lds
    s_add_u32 m0, s79, 82944
    s_add_u32 s61, s89, 25600
    buffer_load_dwordx4 v44, s[32:35], s61 offen lds
    s_add_u32 m0, s79, 83968
    s_add_u32 s61, s89, 5120
    buffer_load_dwordx4 v44, s[32:35], s61 offen lds
    s_add_u32 m0, s79, 84992
    s_add_u32 s61, s89, 30720
    buffer_load_dwordx4 v44, s[32:35], s61 offen lds
    s_add_u32 s79, s79, 4096
    s_cmp_eq_u32 s79, 81920
    s_cselect_b32 s79, 0, s79
csb_4:
    s_waitcnt vmcnt(8)
    s_barrier
    s_cmp_ge_u32 s57, 30
    s_cbranch_scc1 csl_5
    s_add_u32 m0, s79, 81920
    s_add_u32 s61, s89, 51200
    buffer_load_dwordx4 v44, s[32:35], s61 offen lds
    s_add_u32 m0, s79, 82944
    s_add_u32 s61, s89, 76800
    buffer_load_dwordx4 v44, s[32:35], s61 offen lds
    s_add_u32 m0, s79, 83968
    s_add_u32 s61, s89, 56320
    buffer_load_dwordx4 v44, s[32:35], s61 offen lds
    s_add_u32 m0, s79, 84992
    s_add_u32 s61, s89, 81920
    buffer_load_dwordx4 v44, s[32:35], s61 offen lds
    s_add_u32 s79, s79, 4096
    s_cmp_eq_u32 s79, 81920
    s_cselect_b32 s79, 0, s79
csb_6:
    ds_read_b128 v[32:35], v26 offset:40960
    ds_read_b128 v[36:39], v26 offset:41984
    ds_read_b128 v[40:43], v26 offset:43008
    s_waitcnt lgkmcnt(0)
    v_dot2c_f32_bf16 v20, v32, v12
    v_dot2c_f32_bf16 v21, v32, v32
    v_dot2c_f32_bf16 v22, v36, v12
    v_dot2c_f32_bf16 v23, v36, v36
    v_dot2c_f32_bf16 v24, v40, v12
    v_dot2c_f32_bf16 v25, v40, v40
    v_dot2c_f32_bf16 v20, v33, v12
    v_dot2c_f32_bf16 v21, v33, v33
    v_dot2c_f32_bf16 v22, v37, v12
    v_dot2c_f32_bf16 v23, v37, v37
    v_dot2c_f32_bf16 v24, v41, v12
    v_dot2c_f32_bf16 v25, v41, v41
    v_dot2c_f32_bf16 v20, v34, v12
    v_dot2c_f32_bf16 v21, v34, v34
    v_dot2c_f32_bf16 v22, v38, v12
    v_dot2c_f32_bf16 v23, v38, v38
    v_dot2c_f32_bf16 v24, v42, v12
    v_dot2c_f32_bf16 v25, v42, v42
    v_dot2c_f32_bf16 v20, v35, v12
    v_dot2c_f32_bf16 v21, v35, v35
    v_dot2c_f32_bf16 v22, v39, v12
    v_dot2c_f32_bf16 v23, v39, v39
    v_dot2c_f32_bf16 v24, v43, v12
    v_dot2c_f32_bf16 v25, v43, v43
    s_waitcnt vmcnt(8)
    s_barrier
    v_add_f32_dpp v20, v20, v20 quad_perm:[1,0,3,2] row_mask:0xf bank_mask:0xf
    v_add_f32_dpp v21, v21, v21 quad_perm:[1,0,3,2] row_mask:0xf bank_mask:0xf
    v_add_f32_dpp v22, v22, v22 quad_perm:[1,0,3,2] row_mask:0xf bank_mask:0xf
    v_add_f32_dpp v23, v23, v23 quad_perm:[1,0,3,2] row_mask:0xf bank_mask:0xf
    v_add_f32_dpp v24, v24, v24 quad_perm:[1,0,3,2] row_mask:0xf bank_mask:0xf
    v_add_f32_dpp v25, v25, v25 quad_perm:[1,0,3,2] row_mask:0xf bank_mask:0xf
    v_add_f32_dpp v20, v20, v20 quad_perm:[2,3,0,1] row_mask:0xf bank_mask:0xf
    v_add_f32_dpp v21, v21, v21 quad_perm:[2,3,0,1] row_mask:0xf bank_mask:0xf
    v_add_f32_dpp v22, v22, v22 quad_perm:[2,3,0,1] row_mask:0xf bank_mask:0xf
    v_add_f32_dpp v23, v23, v23 quad_perm:[2,3,0,1] row_mask:0xf bank_mask:0xf
    v_add_f32_dpp v24, v24, v24 quad_perm:[2,3,0,1] row_mask:0xf bank_mask:0xf
    v_add_f32_dpp v25, v25, v25 quad_perm:[2,3,0,1] row_mask:0xf bank_mask:0xf
    v_add_f32_dpp v20, v20, v20 row_half_mirror row_mask:0xf bank_mask:0xf
    v_add_f32_dpp v21, v21, v21 row_half_mirror row_mask:0xf bank_mask:0xf
    v_add_f32_dpp v22, v22, v22 row_half_mirror row_mask:0xf bank_mask:0xf
    v_add_f32_dpp v23, v23, v23 row_half_mirror row_mask:0xf bank_mask:0xf
    v_add_f32_dpp v24, v24, v24 row_half_mirror row_mask:0xf bank_mask:0xf
    v_add_f32_dpp v25, v25, v25 row_half_mirror row_mask:0xf bank_mask:0xf
    v_mul_f32 v33, 0.0015625, v20
    v_mul_f32 v21, 0.0015625, v21
    v_fma_f32 v21, -v33, v33, v21
    v_max_f32 v21, 0, v21
    v_add_f32 v21, 1e-5, v21
    v_rsq_f32 v32, v21
    v_mul_f32 v35, 0.0015625, v22
    v_mul_f32 v23, 0.0015625, v23
    v_fma_f32 v23, -v35, v35, v23
    v_max_f32 v23, 0, v23
    v_add_f32 v23, 1e-5, v23
    v_rsq_f32 v34, v23
    v_mul_f32 v37, 0.0015625, v24
    v_mul_f32 v25, 0.0015625, v25
    v_fma_f32 v25, -v37, v37, v25
    v_max_f32 v25, 0, v25
    v_add_f32 v25, 1e-5, v25
    v_rsq_f32 v36, v25
    v_lshlrev_b32 v2, 2, v14
    ds_write2_b32 v2, v32, v33 offset1:80
    ds_write2_b32 v2, v34, v35 offset0:8 offset1:88
    s_mov_b32 exec_hi, 0
    ds_write2_b32 v2, v36, v37 offset0:16 offset1:96
    s_mov_b32 exec_hi, -1
    s_cmp_ge_u32 s57, 30
    s_cbranch_scc1 csl_7
    s_add_u32 m0, s79, 81920
    s_add_u32 s61, s89, 20480
    buffer_load_dwordx4 v45, s[32:35], s61 offen lds
    s_add_u32 m0, s79, 82944
    s_add_u32 s61, s89, 102400
    buffer_load_dwordx4 v44, s[32:35], s61 offen lds
    s_add_u32 m0, s79, 83968
    s_add_u32 s61, s89, 46080
    buffer_load_dwordx4 v45, s[32:35], s61 offen lds
    s_add_u32 m0, s79, 84992
    s_add_u32 s61, s89, 107520
    buffer_load_dwordx4 v44, s[32:35], s61 offen lds
    s_add_u32 s79, s79, 4096
    s_cmp_eq_u32 s79, 81920
    s_cselect_b32 s79, 0, s79
csb_8:
    s_waitcnt lgkmcnt(0)
    s_barrier
    s_cmp_ge_u32 s57, 30
    s_cbranch_scc1 csl_9
    s_add_u32 m0, s79, 81920
    s_add_u32 s61, s89, 128000
    buffer_load_dwordx4 v44, s[32:35], s61 offen lds
    s_add_u32 m0, s79, 82944
    s_add_u32 s61, s89, 153600
    buffer_load_dwordx4 v44, s[32:35], s61 offen lds
    s_add_u32 m0, s79, 83968
    s_add_u32 s61, s89, 133120
    buffer_load_dwordx4 v44, s[32:35], s61 offen lds
    s_add_u32 m0, s79, 84992
    s_add_u32 s61, s89, 158720
    buffer_load_dwordx4 v44, s[32:35], s61 offen lds
    s_add_u32 s79, s79, 4096
    s_cmp_eq_u32 s79, 81920
    s_cselect_b32 s79, 0, s79
csb_10:
    s_cmp_ge_u32 s57, 30
    s_cbranch_scc1 csl_11
    s_add_u32 m0, s79, 81920
    s_add_u32 s61, s89, 179200
    buffer_load_dwordx4 v44, s[32:35], s61 offen lds
    s_add_u32 m0, s79, 82944
    s_add_u32 s61, s89, 122880
    buffer_load_dwordx4 v45, s[32:35], s61 offen lds
    s_add_u32 m0, s79, 83968
    s_add_u32 s61, s89, 184320
    buffer_load_dwordx4 v44, s[32:35], s61 offen lds
    s_add_u32 m0, s79, 84992
    s_add_u32 s61, s89, 148480
    buffer_load_dwordx4 v45, s[32:35], s61 offen lds
    s_add_u32 s79, s79, 4096
    s_cmp_eq_u32 s79, 81920
    s_cselect_b32 s79, 0, s79
csb_12:
    s_cmp_ge_u32 s57, 30
    s_cbranch_scc1 Lcsum2
    s_cmp_ge_u32 s57, 14
    s_cselect_b32 s3, 1, 0
    s_cselect_b32 s73, 14, 0
    s_sub_u32 s73, s57, s73
    s_lshl_b32 s72, s3, 7
    v_lshrrev_b32 v2, 4, v1
    v_lshlrev_b32 v3, 2, v2
    v_and_b32 v4, 15, v1
    v_xor_b32 v4, v4, v3
    v_mul_u32_u24 v16, 3456, v2
    v_lshl_add_u32 v16, v4, 4, v16
    s_lshl_b32 s3, s73, 8
    s_mul_i32 s61, s23, 55296
    s_add_u32 s3, s3, s61
    s_cmp_ge_u32 s57, 28
    s_cselect_b32 s3, 2147483648, s3
    v_add_u32 v16, s3, v16
    s_lshl_b32 s64, s23, 12
    s_mul_i32 s77, s73, 183
    s_lshr_b32 s77, s77, 8
    s_cmp_ge_u32 s57, 14
    s_cselect_b32 s3, 1, 0
    s_add_u32 s77, s77, s3
    s_sub_u32 s3, s77, 10
    s_cmp_ge_u32 s77, 10
    s_cselect_b32 s77, s3, s77
    s_mul_i32 s76, s77, 221184
    s_add_u32 s61, s76, 0
    buffer_load_dwordx4 v[152:155], v16, s[36:39], s61 offen
    s_add_u32 s61, s76, 13824
    buffer_load_dwordx4 v[156:159], v16, s[36:39], s61 offen
    s_add_u32 s61, s76, 27648
    buffer_load_dwordx4 v[160:163], v16, s[36:39], s61 offen
    s_add_u32 s61, s76, 41472
    buffer_load_dwordx4 v[164:167], v16, s[36:39], s61 offen
    s_add_u32 s76, s76, 221184
    s_cmp_eq_u32 s76, 2211840
    s_cselect_b32 s76, 0, s76
    s_add_u32 s61, s76, 0
    buffer_load_dwordx4 v[168:171], v16, s[36:39], s61 offen
    s_add_u32 s61, s76, 13824
    buffer_load_dwordx4 v[172:175], v16, s[36:39], s61 offen
    s_add_u32 s61, s76, 27648
    buffer_load_dwordx4 v[176:179], v16, s[36:39], s61 offen
    s_add_u32 s61, s76, 41472
    buffer_load_dwordx4 v[180:183], v16, s[36:39], s61 offen
    s_add_u32 s76, s76, 221184
    s_cmp_eq_u32 s76, 2211840
    s_cselect_b32 s76, 0, s76
    v_lshrrev_b32 v2, 3, v1
    v_and_b32 v3, 3, v2
    v_lshrrev_b32 v4, 2, v2
    v_mul_u32_u24 v4, 8, v4
    v_add_u32 v3, v3, v4
    v_mul_u32_u24 v17, 1280, v3
    v_lshrrev_b32 v2, 4, v1
    v_lshlrev_b32 v2, 1, v2
    v_and_b32 v3, 7, v1
    v_xor_b32 v3, v3, v2
    v_lshl_add_u32 v17, v3, 4, v17
    s_lshl_b32 s3, s67, 7
    v_add_u32 v17, s3, v17
    s_and_b32 s3, s23, 1
    s_lshl_b32 s3, s3, 4
    s_lshr_b32 s61, s23, 1
    s_lshl_b32 s61, s61, 2
    s_add_u32 s3, s3, s61
    s_mul_i32 s3, s3, 1280
    s_cmp_ge_u32 s57, 30
    s_cselect_b32 s3, 2147483648, s3
    v_add_u32 v17, s3, v17
    s_mov_b32 s82, 0
    s_mul_i32 s83, s82, 81920
    v_add_u32 v2, 0, v1
    v_cmp_le_u32 vcc, 96, v2
    s_nop 1
    v_cndmask_b32 v3, 0, 1, vcc
    v_mul_u32_u24 v4, 96, v3
    v_sub_u32 v2, v2, v4
    s_lshl_b32 s3, s23, 1
    v_add_u32 v3, s3, v3
    v_mul_u32_u24 v3, 4096, v3
    v_add_u32 v4, s63, v2
    v_lshl_add_u32 v3, v4, 4, v3
    v_cmp_gt_u32 vcc, s69, v2
    v_mov_b32 v4, 2147483648
    s_nop 0
    v_cndmask_b32 v11, v4, v3, vcc
    v_add_u32 v2, 64, v1
    v_cmp_le_u32 vcc, 96, v2
    s_nop 1
    v_cndmask_b32 v3, 0, 1, vcc
    v_mul_u32_u24 v4, 96, v3
    v_sub_u32 v2, v2, v4
    s_lshl_b32 s3, s23, 1
    v_add_u32 v3, s3, v3
    v_mul_u32_u24 v3, 4096, v3
    v_add_u32 v4, s63, v2
    v_lshl_add_u32 v3, v4, 4, v3
    v_cmp_gt_u32 vcc, s69, v2
    v_mov_b32 v4, 2147483648
    s_nop 0
    v_cndmask_b32 v12, v4, v3, vcc
    v_add_u32 v2, 128, v1
    v_cmp_le_u32 vcc, 96, v2
    s_nop 1
    v_cndmask_b32 v3, 0, 1, vcc
    v_mul_u32_u24 v4, 96, v3
    v_sub_u32 v2, v2, v4
    s_lshl_b32 s3, s23, 1
    v_add_u32 v3, s3, v3
    v_mul_u32_u24 v3, 4096, v3
    v_add_u32 v4, s63, v2
    v_lshl_add_u32 v3, v4, 4, v3
    v_cmp_gt_u32 vcc, s69, v2
    v_mov_b32 v4, 2147483648
    s_nop 0
    v_cndmask_b32 v13, v4, v3, vcc
    s_mul_i32 s65, s23, 3072
    s_mul_i32 s75, s67, 32768
    v_lshlrev_b32 v14, 4, v1
    v_add_u32 v14, s64, v14
    v_add_u32 v15, 0x10000, v14
    s_lshl_b32 s79, s23, 10
    v_lshl_add_u32 v19, v1, 4, s79
    v_add_u32 v9, 0x10000, v19
    s_lshl_b32 s61, s66, 3
    s_mov_b32 s60, 16
    s_mul_i32 s61, s61, 64
    s_add_u32 s61, s61, 1638400
    v_mul_u32_u24 v2, 64, v1
    s_bfm_b64 exec, s60, 0
    s_mov_b32 s60, 0x100000
poll_13:
    buffer_load_dwordx4 v[4:7], v2, s[52:55], s61 offen sc1
    s_sub_u32 s60, s60, 1
    s_cbranch_scc1 pollx_14
    s_waitcnt vmcnt(0)
    v_and_b32 v4, v4, v5
    v_and_b32 v6, v6, v7
    v_and_b32 v4, v4, v6
    v_cmp_ne_u32 vcc, 1, v4
    s_cbranch_vccnz poll_13
pollx_14:
    s_waitcnt vmcnt(0)
    s_mov_b64 exec, -1
    s_add_u32 s61, s75, 0
    s_add_u32 m0, s65, 12288
    s_nop 0
    buffer_load_dwordx4 v11, s[52:55], s61 offen sc1 lds
    s_add_u32 m0, s65, 13312
    s_nop 0
    buffer_load_dwordx4 v12, s[52:55], s61 offen sc1 lds
    s_add_u32 m0, s65, 14336
    s_nop 0
    buffer_load_dwordx4 v13, s[52:55], s61 offen sc1 lds
    s_add_u32 s75, s75, 32768
    s_cmp_eq_u32 s75, 327680
    s_cselect_b32 s75, 0, s75
    s_add_u32 s61, s75, 0
    s_add_u32 m0, s65, 24576
    s_nop 0
    buffer_load_dwordx4 v11, s[52:55], s61 offen sc1 lds
    s_add_u32 m0, s65, 25600
    s_nop 0
    buffer_load_dwordx4 v12, s[52:55], s61 offen sc1 lds
    s_add_u32 m0, s65, 26624
    s_nop 0
    buffer_load_dwordx4 v13, s[52:55], s61 offen sc1 lds
    s_add_u32 s75, s75, 32768
    s_cmp_eq_u32 s75, 327680
    s_cselect_b32 s75, 0, s75
    s_add_u32 s61, s75, 0
    s_add_u32 m0, s65, 36864
    s_nop 0
    buffer_load_dwordx4 v11, s[52:55], s61 offen sc1 lds
    s_add_u32 m0, s65, 37888
    s_nop 0
    buffer_load_dwordx4 v12, s[52:55], s61 offen sc1 lds
    s_add_u32 m0, s65, 38912
    s_nop 0
    buffer_load_dwordx4 v13, s[52:55], s61 offen sc1 lds
    s_add_u32 s75, s75, 32768
    s_cmp_eq_u32 s75, 327680
    s_cselect_b32 s75, 0, s75
    s_waitcnt vmcnt(6)
    s_barrier
    s_add_u32 s61, s75, 0
    s_add_u32 m0, s65, 49152
    s_nop 0
    buffer_load_dwordx4 v11, s[52:55], s61 offen sc1 lds
    s_add_u32 m0, s65, 50176
    s_nop 0
    buffer_load_dwordx4 v12, s[52:55], s61 offen sc1 lds
    s_add_u32 m0, s65, 51200
    s_nop 0
    buffer_load_dwordx4 v13, s[52:55], s61 offen sc1 lds
    s_add_u32 s75, s75, 32768
    s_cmp_eq_u32 s75, 327680
    s_cselect_b32 s75, 0, s75
    s_add_u32 s61, s75, 0
    s_add_u32 m0, s65, 61440
    s_nop 0
    buffer_load_dwordx4 v11, s[52:55], s61 offen sc1 lds
    s_add_u32 m0, s65, 62464
    s_nop 0
    buffer_load_dwordx4 v12, s[52:55], s61 offen sc1 lds
    s_add_u32 m0, s65, 63488
    s_nop 0
    buffer_load_dwordx4 v13, s[52:55], s61 offen sc1 lds
    s_add_u32 s75, s75, 32768
    s_cmp_eq_u32 s75, 327680
    s_cselect_b32 s75, 0, s75
    s_waitcnt vmcnt(9)
    s_barrier
    s_add_u32 s61, s75, 0
    s_add_u32 m0, s65, 0
    s_nop 0
    buffer_load_dwordx4 v11, s[52:55], s61 offen sc1 lds
    s_add_u32 m0, s65, 1024
    s_nop 0
    buffer_load_dwordx4 v12, s[52:55], s61 offen sc1 lds
    s_add_u32 m0, s65, 2048
    s_nop 0
    buffer_load_dwordx4 v13, s[52:55], s61 offen sc1 lds
    s_add_u32 s75, s75, 32768
    s_cmp_eq_u32 s75, 327680
    s_cselect_b32 s75, 0, s75
    s_waitcnt vmcnt(9)
    s_barrier
    s_add_u32 s61, s75, 0
    s_add_u32 m0, s65, 12288
    s_nop 0
    buffer_load_dwordx4 v11, s[52:55], s61 offen sc1 lds
    s_add_u32 m0, s65, 13312
    s_nop 0
    buffer_load_dwordx4 v12, s[52:55], s61 offen sc1 lds
    s_add_u32 m0, s65, 14336
    s_nop 0
    buffer_load_dwordx4 v13, s[52:55], s61 offen sc1 lds
    s_add_u32 s75, s75, 32768
    s_cmp_eq_u32 s75, 327680
    s_cselect_b32 s75, 0, s75
    s_waitcnt vmcnt(9)
    s_barrier
    s_add_u32 s61, s75, 0
    s_add_u32 m0, s65, 24576
    s_nop 0
    buffer_load_dwordx4 v11, s[52:55], s61 offen sc1 lds
    s_add_u32 m0, s65, 25600
    s_nop 0
    buffer_load_dwordx4 v12, s[52:55], s61 offen sc1 lds
    s_add_u32 m0, s65, 26624
    s_nop 0
    buffer_load_dwordx4 v13, s[52:55], s61 offen sc1 lds
    s_add_u32 s75, s75, 32768
    s_cmp_eq_u32 s75, 327680
    s_cselect_b32 s75, 0, s75
    s_waitcnt vmcnt(9)
    s_barrier
    s_add_u32 s61, s75, 0
    s_add_u32 m0, s65, 36864
    s_nop 0
    buffer_load_dwordx4 v11, s[52:55], s61 offen sc1 lds
    s_add_u32 m0, s65, 37888
    s_nop 0
    buffer_load_dwordx4 v12, s[52:55], s61 offen sc1 lds
    s_add_u32 m0, s65, 38912
    s_nop 0
    buffer_load_dwordx4 v13, s[52:55], s61 offen sc1 lds
    s_add_u32 s75, s75, 32768
    s_cmp_eq_u32 s75, 327680
    s_cselect_b32 s75, 0, s75
    s_add_u32 s61, s76, 0
    buffer_load_dwordx4 v[184:187], v16, s[36:39], s61 offen
    s_add_u32 s61, s76, 13824
    buffer_load_dwordx4 v[188:191], v16, s[36:39], s61 offen
    s_waitcnt vmcnt(11)
    s_barrier
    s_add_u32 s61, s75, 0
    s_add_u32 m0, s65, 49152
    s_nop 0
    buffer_load_dwordx4 v11, s[52:55], s61 offen sc1 lds
    s_add_u32 m0, s65, 50176
    s_nop 0
    buffer_load_dwordx4 v12, s[52:55], s61 offen sc1 lds
    s_add_u32 m0, s65, 51200
    s_nop 0
    buffer_load_dwordx4 v13, s[52:55], s61 offen sc1 lds
    s_add_u32 s75, s75, 32768
    s_cmp_eq_u32 s75, 327680
    s_cselect_b32 s75, 0, s75
    s_add_u32 s61, s76, 27648
    buffer_load_dwordx4 v[192:195], v16, s[36:39], s61 offen
    s_add_u32 s61, s76, 41472
    buffer_load_dwordx4 v[196:199], v16, s[36:39], s61 offen
    s_add_u32 s76, s76, 221184
    s_cmp_eq_u32 s76, 2211840
    s_cselect_b32 s76, 0, s76
    s_waitcnt vmcnt(13)
    s_barrier
    s_add_u32 s61, s76, 0
    buffer_load_dwordx4 v[200:203], v16, s[36:39], s61 offen
    s_add_u32 s61, s76, 13824
    buffer_load_dwordx4 v[204:207], v16, s[36:39], s61 offen
    s_waitcnt vmcnt(12)
    s_barrier
    s_add_u32 s61, s76, 27648
    buffer_load_dwordx4 v[208:211], v16, s[36:39], s61 offen
    s_add_u32 s61, s76, 41472
    buffer_load_dwordx4 v[212:215], v16, s[36:39], s61 offen
    s_add_u32 s76, s76, 221184
    s_cmp_eq_u32 s76, 2211840
    s_cselect_b32 s76, 0, s76
    s_waitcnt vmcnt(11)
    s_barrier
    s_add_u32 s61, s76, 0
    buffer_load_dwordx4 v[216:219], v16, s[36:39], s61 offen
    s_add_u32 s61, s76, 13824
    buffer_load_dwordx4 v[220:223], v16, s[36:39], s61 offen
    s_waitcnt vmcnt(8)
    s_barrier
    s_add_u32 s61, s76, 27648
    buffer_load_dwordx4 v[224:227], v16, s[36:39], s61 offen
    s_add_u32 s61, s76, 41472
    buffer_load_dwordx4 v[228:231], v16, s[36:39], s61 offen
    s_add_u32 s76, s76, 221184
    s_cmp_eq_u32 s76, 2211840
    s_cselect_b32 s76, 0, s76
    s_barrier
    s_cmp_ge_u32 s57, 28
    s_cbranch_scc1 Lskip3l
    s_add_u32 s61, s76, 0
    buffer_load_dwordx4 v[232:235], v16, s[36:39], s61 offen
    s_add_u32 s61, s76, 13824
    buffer_load_dwordx4 v[236:239], v16, s[36:39], s61 offen
    s_add_u32 s61, s76, 27648
    buffer_load_dwordx4 v[240:243], v16, s[36:39], s61 offen
    s_add_u32 s61, s76, 41472
    buffer_load_dwordx4 v[244:247], v16, s[36:39], s61 offen
    s_add_u32 s76, s76, 221184
    s_cmp_eq_u32 s76, 2211840
    s_cselect_b32 s76, 0, s76
    ds_write_b128 v14, v[152:155] offset:0
    ds_write_b128 v14, v[156:159] offset:1024
    ds_write_b128 v14, v[160:163] offset:2048
    ds_write_b128 v14, v[164:167] offset:3072
    ds_write_b128 v14, v[168:171] offset:16384
    ds_write_b128 v14, v[172:175] offset:17408
    ds_write_b128 v14, v[176:179] offset:18432
    ds_write_b128 v14, v[180:183] offset:19456
    s_waitcnt vmcnt(12)
    ds_write_b128 v14, v[184:187] offset:32768
    ds_write_b128 v14, v[188:191] offset:33792
    ds_write_b128 v14, v[192:195] offset:34816
    ds_write_b128 v14, v[196:199] offset:35840
    s_waitcnt vmcnt(8)
    ds_write_b128 v14, v[200:203] offset:49152
    ds_write_b128 v14, v[204:207] offset:50176
    ds_write_b128 v14, v[208:211] offset:51200
    ds_write_b128 v14, v[212:215] offset:52224
    s_waitcnt vmcnt(4)
    ds_write_b128 v15, v[216:219] offset:0
    ds_write_b128 v15, v[220:223] offset:1024
    ds_write_b128 v15, v[224:227] offset:2048
    ds_write_b128 v15, v[228:231] offset:3072
    s_waitcnt vmcnt(0)
    ds_write_b128 v15, v[232:235] offset:16384
    ds_write_b128 v15, v[236:239] offset:17408
    ds_write_b128 v15, v[240:243] offset:18432
    ds_write_b128 v15, v[244:247] offset:19456
    s_mul_i32 s3, s23, 8192
    s_lshl_b32 s61, s72, 4
    s_add_u32 s3, s3, s61
    v_lshl_add_u32 v18, v1, 4, s3
    s_mul_i32 s75, s77, 32768
    v_and_b32 v2, 31, v1
    v_lshrrev_b32 v3, 5, v1
    v_lshlrev_b32 v3, 11, v3
    v_lshl_add_u32 v10, v2, 3, v3
    s_lshl_b32 s3, s23, 5
    s_add_u32 s3, s3, s72
    s_lshl_b32 s3, s3, 3
    v_add_u32 v10, s3, v10
    s_cmp_ge_u32 s57, 14
    s_cselect_b32 s61, 10, 0
    s_mov_b32 s60, 20
    s_add_u32 s62, s73, 32
    s_sub_u32 s62, s62, s61
    s_mul_i32 s62, s62, 64
    s_sub_u32 s62, s62, 16
    s_mul_i32 s61, s61, 64
    s_add_u32 s61, s61, 1642496
    v_mul_u32_u24 v2, 64, v1
    v_writelane_b32 v2, s62, 20
    s_bfm_b64 exec, s60, 0
    s_mov_b32 s60, 0x100000
poll_15:
    buffer_load_dwordx4 v[4:7], v2, s[52:55], s61 offen sc1
    s_sub_u32 s60, s60, 1
    s_cbranch_scc1 pollx_16
    s_waitcnt vmcnt(0)
    v_and_b32 v4, v4, v5
    v_and_b32 v6, v6, v7
    v_and_b32 v4, v4, v6
    v_cmp_ne_u32 vcc, 1, v4
    s_cbranch_vccnz poll_15
pollx_16:
    s_waitcnt vmcnt(0)
    s_mov_b64 exec, -1
    s_mov_b32 s62, s61
    s_add_u32 m0, s64, 98304
    s_add_u32 s61, s75, 917504
    buffer_load_dwordx4 v18, s[52:55], s61 offen sc1 lds
    s_add_u32 m0, s64, 99328
    s_add_u32 s61, s75, 918528
    buffer_load_dwordx4 v18, s[52:55], s61 offen sc1 lds
    s_add_u32 m0, s64, 100352
    s_add_u32 s61, s75, 921600
    buffer_load_dwordx4 v18, s[52:55], s61 offen sc1 lds
    s_add_u32 m0, s64, 101376
    s_add_u32 s61, s75, 922624
    buffer_load_dwordx4 v18, s[52:55], s61 offen sc1 lds
    s_add_u32 s75, s75, 32768
    s_cmp_eq_u32 s75, 327680
    s_cselect_b32 s75, 0, s75
    s_add_u32 m0, s64, 114688
    s_add_u32 s61, s75, 917504
    buffer_load_dwordx4 v18, s[52:55], s61 offen sc1 lds
    s_add_u32 m0, s64, 115712
    s_add_u32 s61, s75, 918528
    buffer_load_dwordx4 v18, s[52:55], s61 offen sc1 lds
    s_add_u32 m0, s64, 116736
    s_add_u32 s61, s75, 921600
    buffer_load_dwordx4 v18, s[52:55], s61 offen sc1 lds
    s_add_u32 m0, s64, 117760
    s_add_u32 s61, s75, 922624
    buffer_load_dwordx4 v18, s[52:55], s61 offen sc1 lds
    s_add_u32 s75, s75, 32768
    s_cmp_eq_u32 s75, 327680
    s_cselect_b32 s75, 0, s75
    s_waitcnt vmcnt(4)
    s_waitcnt lgkmcnt(0)
    s_barrier
    s_add_u32 m0, s64, 131072
    s_add_u32 s61, s75, 917504
    buffer_load_dwordx4 v18, s[52:55], s61 offen sc1 lds
    s_add_u32 m0, s64, 132096
    s_add_u32 s61, s75, 918528
    buffer_load_dwordx4 v18, s[52:55], s61 offen sc1 lds
    s_add_u32 m0, s64, 133120
    s_add_u32 s61, s75, 921600
    buffer_load_dwordx4 v18, s[52:55], s61 offen sc1 lds
    s_add_u32 m0, s64, 134144
    s_add_u32 s61, s75, 922624
    buffer_load_dwordx4 v18, s[52:55], s61 offen sc1 lds
    s_add_u32 s75, s75, 32768
    s_cmp_eq_u32 s75, 327680
    s_cselect_b32 s75, 0, s75
    s_add_u32 m0, s64, 147456
    s_add_u32 s61, s75, 917504
    buffer_load_dwordx4 v18, s[52:55], s61 offen sc1 lds
    s_add_u32 m0, s64, 148480
    s_add_u32 s61, s75, 918528
    buffer_load_dwordx4 v18, s[52:55], s61 offen sc1 lds
    s_add_u32 m0, s64, 149504
    s_add_u32 s61, s75, 921600
    buffer_load_dwordx4 v18, s[52:55], s61 offen sc1 lds
    s_add_u32 m0, s64, 150528
    s_add_u32 s61, s75, 922624
    buffer_load_dwordx4 v18, s[52:55], s61 offen sc1 lds
    s_add_u32 s75, s75, 32768
    s_cmp_eq_u32 s75, 327680
    s_cselect_b32 s75, 0, s75
    s_waitcnt vmcnt(8)
    s_barrier
    s_add_u32 m0, s64, 98304
    s_add_u32 s61, s75, 917504
    buffer_load_dwordx4 v18, s[52:55], s61 offen sc1 lds
    s_add_u32 m0, s64, 99328
    s_add_u32 s61, s75, 918528
    buffer_load_dwordx4 v18, s[52:55], s61 offen sc1 lds
    s_add_u32 m0, s64, 100352
    s_add_u32 s61, s75, 921600
    buffer_load_dwordx4 v18, s[52:55], s61 offen sc1 lds
    s_add_u32 m0, s64, 101376
    s_add_u32 s61, s75, 922624
    buffer_load_dwordx4 v18, s[52:55], s61 offen sc1 lds
    s_add_u32 s75, s75, 32768
    s_cmp_eq_u32 s75, 327680
    s_cselect_b32 s75, 0, s75
    s_add_u32 m0, s64, 0
    s_add_u32 s61, s76, 0
    buffer_load_dwordx4 v16, s[36:39], s61 offen lds
    s_add_u32 m0, s64, 1024
    s_add_u32 s61, s76, 13824
    buffer_load_dwordx4 v16, s[36:39], s61 offen lds
    s_add_u32 m0, s64, 2048
    s_add_u32 s61, s76, 27648
    buffer_load_dwordx4 v16, s[36:39], s61 offen lds
    s_add_u32 m0, s64, 3072
    s_add_u32 s61, s76, 41472
    buffer_load_dwordx4 v16, s[36:39], s61 offen lds
    s_add_u32 s76, s76, 221184
    s_cmp_eq_u32 s76, 2211840
    s_cselect_b32 s76, 0, s76
    s_waitcnt vmcnt(12)
    s_barrier
    s_add_u32 m0, s64, 114688
    s_add_u32 s61, s75, 917504
    buffer_load_dwordx4 v18, s[52:55], s61 offen sc1 lds
    s_add_u32 m0, s64, 115712
    s_add_u32 s61, s75, 918528
    buffer_load_dwordx4 v18, s[52:55], s61 offen sc1 lds
    s_add_u32 m0, s64, 116736
    s_add_u32 s61, s75, 921600
    buffer_load_dwordx4 v18, s[52:55], s61 offen sc1 lds
    s_add_u32 m0, s64, 117760
    s_add_u32 s61, s75, 922624
    buffer_load_dwordx4 v18, s[52:55], s61 offen sc1 lds
    s_add_u32 s75, s75, 32768
    s_cmp_eq_u32 s75, 327680
    s_cselect_b32 s75, 0, s75
    s_add_u32 m0, s64, 16384
    s_add_u32 s61, s76, 0
    buffer_load_dwordx4 v16, s[36:39], s61 offen lds
    s_add_u32 m0, s64, 17408
    s_add_u32 s61, s76, 13824
    buffer_load_dwordx4 v16, s[36:39], s61 offen lds
    s_add_u32 m0, s64, 18432
    s_add_u32 s61, s76, 27648
    buffer_load_dwordx4 v16, s[36:39], s61 offen lds
    s_add_u32 m0, s64, 19456
    s_add_u32 s61, s76, 41472
    buffer_load_dwordx4 v16, s[36:39], s61 offen lds
    s_add_u32 s76, s76, 221184
    s_cmp_eq_u32 s76, 2211840
    s_cselect_b32 s76, 0, s76
    s_waitcnt vmcnt(16)
    s_barrier
    s_add_u32 m0, s64, 131072
    s_add_u32 s61, s75, 917504
    buffer_load_dwordx4 v18, s[52:55], s61 offen sc1 lds
    s_add_u32 m0, s64, 132096
    s_add_u32 s61, s75, 918528
    buffer_load_dwordx4 v18, s[52:55], s61 offen sc1 lds
    s_add_u32 m0, s64, 133120
    s_add_u32 s61, s75, 921600
    buffer_load_dwordx4 v18, s[52:55], s61 offen sc1 lds
    s_add_u32 m0, s64, 134144
    s_add_u32 s61, s75, 922624
    buffer_load_dwordx4 v18, s[52:55], s61 offen sc1 lds
    s_add_u32 s75, s75, 32768
    s_cmp_eq_u32 s75, 327680
    s_cselect_b32 s75, 0, s75
    s_mov_b64 exec, 0x1fffff
    buffer_load_dwordx4 v[4:7], v2, s[52:55], s62 offen offset:16 sc1
    s_mov_b64 exec, -1
    s_add_u32 m0, s64, 32768
    s_add_u32 s61, s76, 0
    buffer_load_dwordx4 v16, s[36:39], s61 offen lds
    s_add_u32 m0, s64, 33792
    s_add_u32 s61, s76, 13824
    buffer_load_dwordx4 v16, s[36:39], s61 offen lds
    s_add_u32 m0, s64, 34816
    s_add_u32 s61, s76, 27648
    buffer_load_dwordx4 v16, s[36:39], s61 offen lds
    s_add_u32 m0, s64, 35840
    s_add_u32 s61, s76, 41472
    buffer_load_dwordx4 v16, s[36:39], s61 offen lds
    s_add_u32 s76, s76, 221184
    s_cmp_eq_u32 s76, 2211840
    s_cselect_b32 s76, 0, s76
    s_waitcnt vmcnt(21)
    s_barrier
    s_add_u32 m0, s64, 147456
    s_add_u32 s61, s75, 917504
    buffer_load_dwordx4 v18, s[52:55], s61 offen sc1 lds
    s_add_u32 m0, s64, 148480
    s_add_u32 s61, s75, 918528
    buffer_load_dwordx4 v18, s[52:55], s61 offen sc1 lds
    s_add_u32 m0, s64, 149504
    s_add_u32 s61, s75, 921600
    buffer_load_dwordx4 v18, s[52:55], s61 offen sc1 lds
    s_add_u32 m0, s64, 150528
    s_add_u32 s61, s75, 922624
    buffer_load_dwordx4 v18, s[52:55], s61 offen sc1 lds
    s_add_u32 s75, s75, 32768
    s_cmp_eq_u32 s75, 327680
    s_cselect_b32 s75, 0, s75
    s_add_u32 m0, s64, 49152
    s_add_u32 s61, s76, 0
    buffer_load_dwordx4 v16, s[36:39], s61 offen lds
    s_add_u32 m0, s64, 50176
    s_add_u32 s61, s76, 13824
    buffer_load_dwordx4 v16, s[36:39], s61 offen lds
    s_add_u32 m0, s64, 51200
    s_add_u32 s61, s76, 27648
    buffer_load_dwordx4 v16, s[36:39], s61 offen lds
    s_add_u32 m0, s64, 52224
    s_add_u32 s61, s76, 41472
    buffer_load_dwordx4 v16, s[36:39], s61 offen lds
    s_add_u32 s76, s76, 221184
    s_cmp_eq_u32 s76, 2211840
    s_cselect_b32 s76, 0, s76
    s_waitcnt vmcnt(21)
    s_barrier
    s_add_u32 m0, s64, 98304
    s_add_u32 s61, s75, 917504
    buffer_load_dwordx4 v18, s[52:55], s61 offen sc1 lds
    s_add_u32 m0, s64, 99328
    s_add_u32 s61, s75, 918528
    buffer_load_dwordx4 v18, s[52:55], s61 offen sc1 lds
    s_add_u32 m0, s64, 100352
    s_add_u32 s61, s75, 921600
    buffer_load_dwordx4 v18, s[52:55], s61 offen sc1 lds
    s_add_u32 m0, s64, 101376
    s_add_u32 s61, s75, 922624
    buffer_load_dwordx4 v18, s[52:55], s61 offen sc1 lds
    s_add_u32 s75, s75, 32768
    s_cmp_eq_u32 s75, 327680
    s_cselect_b32 s75, 0, s75
    s_waitcnt vmcnt(16)
    s_mov_b64 exec, 0x1fffff
    s_mov_b32 s60, 0x100000
sfchk_17:
    v_and_b32 v4, v4, v5
    v_and_b32 v6, v6, v7
    v_and_b32 v4, v4, v6
    v_cmp_ne_u32 vcc, 1, v4
    s_cbranch_vccnz sfre_19
sfok_18:
    s_mov_b64 exec, -1
    s_mov_b32 s61, 1245184
    buffer_load_dwordx2 v[20:21], v10, s[52:55], s61 offen sc1
    s_mov_b32 s61, 1249280
    buffer_load_dwordx2 v[22:23], v10, s[52:55], s61 offen sc1
    s_mov_b32 s61, 1253376
    buffer_load_dwordx2 v[24:25], v10, s[52:55], s61 offen sc1
    s_mov_b32 s61, 1257472
    buffer_load_dwordx2 v[26:27], v10, s[52:55], s61 offen sc1
    s_mov_b32 s61, 1261568
    buffer_load_dwordx2 v[28:29], v10, s[52:55], s61 offen sc1
    s_lshl_b32 s3, s23, 7
    s_add_u32 m0, s3, 66560
    s_lshl_b32 s61, s73, 9
    s_add_u32 s61, s61, s3
    s_add_u32 s61, s61, 1654784
    v_lshlrev_b32 v3, 4, v1
    s_mov_b64 exec, 255
    buffer_load_dwordx4 v3, s[52:55], s61 offen sc1 lds
    s_mov_b64 exec, -1
    s_barrier
    s_add_u32 m0, s64, 114688
    s_add_u32 s61, s75, 917504
    buffer_load_dwordx4 v18, s[52:55], s61 offen sc1 lds
    s_add_u32 m0, s64, 115712
    s_add_u32 s61, s75, 918528
    buffer_load_dwordx4 v18, s[52:55], s61 offen sc1 lds
    s_add_u32 m0, s64, 116736
    s_add_u32 s61, s75, 921600
    buffer_load_dwordx4 v18, s[52:55], s61 offen sc1 lds
    s_add_u32 m0, s64, 117760
    s_add_u32 s61, s75, 922624
    buffer_load_dwordx4 v18, s[52:55], s61 offen sc1 lds
    s_add_u32 s75, s75, 32768
    s_cmp_eq_u32 s75, 327680
    s_cselect_b32 s75, 0, s75
    s_mov_b32 s61, 1265664
    buffer_load_dwordx2 v[30:31], v10, s[52:55], s61 offen sc1
    s_mov_b32 s61, 1269760
    buffer_load_dwordx2 v[32:33], v10, s[52:55], s61 offen sc1
    s_mov_b32 s61, 1273856
    buffer_load_dwordx2 v[34:35], v10, s[52:55], s61 offen sc1
    s_mov_b32 s61, 1277952
    buffer_load_dwordx2 v[36:37], v10, s[52:55], s61 offen sc1
    s_mov_b32 s61, 1282048
    buffer_load_dwordx2 v[38:39], v10, s[52:55], s61 offen sc1
    s_waitcnt vmcnt(23)
    s_barrier
    s_add_u32 m0, s79, 73728
    s_add_u32 s61, s83, 0
    buffer_load_dwordx4 v17, s[40:43], s61 offen lds
    s_add_u32 m0, s79, 77824
    s_add_u32 s61, s83, 40960
    buffer_load_dwordx4 v17, s[40:43], s61 offen lds
    s_add_u32 s83, s83, 81920
    s_cmp_eq_u32 s83, 2211840
    s_cselect_b32 s83, 0, s83
    s_add_u32 m0, s79, 81920
    s_add_u32 s61, s83, 0
    buffer_load_dwordx4 v17, s[40:43], s61 offen lds
    s_add_u32 m0, s79, 86016
    s_add_u32 s61, s83, 40960
    buffer_load_dwordx4 v17, s[40:43], s61 offen lds
    s_add_u32 s83, s83, 81920
    s_cmp_eq_u32 s83, 2211840
    s_cselect_b32 s83, 0, s83
    s_add_u32 m0, s79, 90112
    s_add_u32 s61, s83, 0
    buffer_load_dwordx4 v17, s[40:43], s61 offen lds
    s_add_u32 m0, s79, 94208
    s_add_u32 s61, s83, 40960
    buffer_load_dwordx4 v17, s[40:43], s61 offen lds
    s_add_u32 s83, s83, 81920
    s_cmp_eq_u32 s83, 2211840
    s_cselect_b32 s83, 0, s83
    s_mul_i32 s3, s57, 3
    s_add_u32 s3, s3, s23
    s_add_u32 s3, s3, 186
    s_lshl_b32 s3, s3, 13
    s_cmp_lt_u32 s23, 3
    s_cselect_b32 s3, s3, 2147483648
    v_lshl_add_u32 v8, v1, 7, s3
    buffer_load_dword v60, v8, s[40:43], 0 offen
    s_waitcnt lgkmcnt(0)
    s_waitcnt vmcnt(16)
    s_barrier
    s_add_u32 m0, s79, 0
    s_add_u32 s61, s83, 0
    buffer_load_dwordx4 v17, s[40:43], s61 offen lds
    s_add_u32 m0, s79, 4096
    s_add_u32 s61, s83, 40960
    buffer_load_dwordx4 v17, s[40:43], s61 offen lds
    s_add_u32 s83, s83, 81920
    s_cmp_eq_u32 s83, 2211840
    s_cselect_b32 s83, 0, s83
    s_add_u32 m0, s79, 8192
    s_add_u32 s61, s83, 0
    buffer_load_dwordx4 v17, s[40:43], s61 offen lds
    s_add_u32 m0, s79, 12288
    s_add_u32 s61, s83, 40960
    buffer_load_dwordx4 v17, s[40:43], s61 offen lds
    s_add_u32 s83, s83, 81920
    s_cmp_eq_u32 s83, 2211840
    s_cselect_b32 s83, 0, s83
    s_waitcnt vmcnt(11)
    v_add_f32 v20, v20, v30
    v_add_f32 v21, v21, v31
    v_add_f32 v22, v22, v32
    v_add_f32 v23, v23, v33
    v_add_f32 v24, v24, v34
    v_add_f32 v25, v25, v35
    v_add_f32 v26, v26, v36
    v_add_f32 v27, v27, v37
    v_add_f32 v28, v28, v38
    v_add_f32 v29, v29, v39
    v_add_f32 v20, v20, v22
    v_add_f32 v21, v21, v23
    v_add_f32 v24, v24, v26
    v_add_f32 v25, v25, v27
    v_add_f32 v20, v20, v28
    v_add_f32 v21, v21, v29
    v_add_f32 v20, v20, v24
    v_add_f32 v21, v21, v25
    v_mov_b32 v48, v20
    v_mov_b32 v49, v21
    s_nop 0
    v_permlane32_swap_b32 v20, v48
    v_permlane32_swap_b32 v21, v49
    v_add_f32 v20, v20, v48
    v_add_f32 v21, v21, v49
    v_mul_f32 v49, 0.0015625, v20
    v_mul_f32 v21, 0.0015625, v21
    v_fma_f32 v21, -v49, v49, v21
    v_max_f32 v21, 0, v21
    v_add_f32 v21, 1e-5, v21
    v_rsq_f32 v48, v21
    v_and_b32 v2, 31, v1
    v_lshlrev_b32 v2, 3, v2
    s_lshl_b32 s3, s23, 8
    s_add_u32 s3, s3, 65536
    v_add_u32 v2, s3, v2
    ds_write_b64 v2, v[48:49]
    s_waitcnt lgkmcnt(0)
    s_barrier
    s_barrier
    s_add_u32 m0, s79, 16384
    s_add_u32 s61, s83, 0
    buffer_load_dwordx4 v17, s[40:43], s61 offen lds
    s_add_u32 m0, s79, 20480
    s_add_u32 s61, s83, 40960
    buffer_load_dwordx4 v17, s[40:43], s61 offen lds
    s_add_u32 s83, s83, 81920
    s_cmp_eq_u32 s83, 2211840
    s_cselect_b32 s83, 0, s83
    s_add_u32 m0, s79, 24576
    s_add_u32 s61, s83, 0
    buffer_load_dwordx4 v17, s[40:43], s61 offen lds
    s_add_u32 m0, s79, 28672
    s_add_u32 s61, s83, 40960
    buffer_load_dwordx4 v17, s[40:43], s61 offen lds
    s_add_u32 s83, s83, 81920
    s_cmp_eq_u32 s83, 2211840
    s_cselect_b32 s83, 0, s83
    s_add_u32 m0, s79, 32768
    s_add_u32 s61, s83, 0
    buffer_load_dwordx4 v17, s[40:43], s61 offen lds
    s_add_u32 m0, s79, 36864
    s_add_u32 s61, s83, 40960
    buffer_load_dwordx4 v17, s[40:43], s61 offen lds
    s_add_u32 s83, s83, 81920
    s_cmp_eq_u32 s83, 2211840
    s_cselect_b32 s83, 0, s83
    s_add_u32 m0, s79, 40960
    s_add_u32 s61, s83, 0
    buffer_load_dwordx4 v17, s[40:43], s61 offen lds
    s_add_u32 m0, s79, 45056
    s_add_u32 s61, s83, 40960
    buffer_load_dwordx4 v17, s[40:43], s61 offen lds
    s_add_u32 s83, s83, 81920
    s_cmp_eq_u32 s83, 2211840
    s_cselect_b32 s83, 0, s83
    s_add_u32 m0, s79, 49152
    s_add_u32 s61, s83, 0
    buffer_load_dwordx4 v17, s[40:43], s61 offen lds
    s_add_u32 m0, s79, 53248
    s_add_u32 s61, s83, 40960
    buffer_load_dwordx4 v17, s[40:43], s61 offen lds
    s_add_u32 s83, s83, 81920
    s_cmp_eq_u32 s83, 2211840
    s_cselect_b32 s83, 0, s83
    s_add_u32 m0, s79, 57344
    s_add_u32 s61, s83, 0
    buffer_load_dwordx4 v17, s[40:43], s61 offen lds
    s_add_u32 m0, s79, 61440
    s_add_u32 s61, s83, 40960
    buffer_load_dwordx4 v17, s[40:43], s61 offen lds
    s_add_u32 s83, s83, 81920
    s_cmp_eq_u32 s83, 2211840
    s_cselect_b32 s83, 0, s83
    s_add_u32 m0, s79, 65536
    s_add_u32 s61, s83, 0
    buffer_load_dwordx4 v17, s[40:43], s61 offen lds
    s_add_u32 m0, s79, 69632
    s_add_u32 s61, s83, 40960
    buffer_load_dwordx4 v17, s[40:43], s61 offen lds
    s_add_u32 s83, s83, 81920
    s_cmp_eq_u32 s83, 2211840
    s_cselect_b32 s83, 0, s83
    s_branch Lp4l
Lskip3l:
    s_barrier
    s_sub_u32 s60, s57, 28
    s_lshl_b32 s60, s60, 2
    s_add_u32 s60, s60, s23
    s_lshl_b32 s60, s60, 13
    s_lshr_b32 s3, s22, 2
    s_lshl_b32 s3, s3, 16
    s_add_u32 s60, s60, s3
    v_lshl_add_u32 v4, v1, 7, s60
    v_add_u32 v6, 393216, v4
    buffer_load_dword v7, v6, s[40:43], 0 offen
    s_waitcnt vmcnt(1)
    v_add_u32 v6, 524288, v4
    buffer_load_dword v7, v6, s[40:43], 0 offen
    s_waitcnt vmcnt(1)
    v_add_u32 v6, 655360, v4
    buffer_load_dword v7, v6, s[40:43], 0 offen
    s_waitcnt vmcnt(1)
    v_add_u32 v6, 786432, v4
    buffer_load_dword v7, v6, s[40:43], 0 offen
    s_waitcnt vmcnt(1)
    s_waitcnt vmcnt(0)
    s_add_u32 m0, s79, 73728
    s_add_u32 s61, s83, 0
    buffer_load_dwordx4 v17, s[40:43], s61 offen lds
    s_add_u32 m0, s79, 77824
    s_add_u32 s61, s83, 40960
    buffer_load_dwordx4 v17, s[40:43], s61 offen lds
    s_add_u32 s83, s83, 81920
    s_cmp_eq_u32 s83, 2211840
    s_cselect_b32 s83, 0, s83
    s_add_u32 m0, s79, 81920
    s_add_u32 s61, s83, 0
    buffer_load_dwordx4 v17, s[40:43], s61 offen lds
    s_add_u32 m0, s79, 86016
    s_add_u32 s61, s83, 40960
    buffer_load_dwordx4 v17, s[40:43], s61 offen lds
    s_add_u32 s83, s83, 81920
    s_cmp_eq_u32 s83, 2211840
    s_cselect_b32 s83, 0, s83
    s_add_u32 m0, s79, 90112
    s_add_u32 s61, s83, 0
    buffer_load_dwordx4 v17, s[40:43], s61 offen lds
    s_add_u32 m0, s79, 94208
    s_add_u32 s61, s83, 40960
    buffer_load_dwordx4 v17, s[40:43], s61 offen lds
    s_add_u32 s83, s83, 81920
    s_cmp_eq_u32 s83, 2211840
    s_cselect_b32 s83, 0, s83
    s_add_u32 m0, s79, 0
    s_add_u32 s61, s83, 0
    buffer_load_dwordx4 v17, s[40:43], s61 offen lds
    s_add_u32 m0, s79, 4096
    s_add_u32 s61, s83, 40960
    buffer_load_dwordx4 v17, s[40:43], s61 offen lds
    s_add_u32 s83, s83, 81920
    s_cmp_eq_u32 s83, 2211840
    s_cselect_b32 s83, 0, s83
    s_add_u32 m0, s79, 8192
    s_add_u32 s61, s83, 0
    buffer_load_dwordx4 v17, s[40:43], s61 offen lds
    s_add_u32 m0, s79, 12288
    s_add_u32 s61, s83, 40960
    buffer_load_dwordx4 v17, s[40:43], s61 offen lds
    s_add_u32 s83, s83, 81920
    s_cmp_eq_u32 s83, 2211840
    s_cselect_b32 s83, 0, s83
    s_add_u32 m0, s79, 16384
    s_add_u32 s61, s83, 0
    buffer_load_dwordx4 v17, s[40:43], s61 offen lds
    s_add_u32 m0, s79, 20480
    s_add_u32 s61, s83, 40960
    buffer_load_dwordx4 v17, s[40:43], s61 offen lds
    s_add_u32 s83, s83, 81920
    s_cmp_eq_u32 s83, 2211840
    s_cselect_b32 s83, 0, s83
    s_add_u32 m0, s79, 24576
    s_add_u32 s61, s83, 0
    buffer_load_dwordx4 v17, s[40:43], s61 offen lds
    s_add_u32 m0, s79, 28672
    s_add_u32 s61, s83, 40960
    buffer_load_dwordx4 v17, s[40:43], s61 offen lds
    s_add_u32 s83, s83, 81920
    s_cmp_eq_u32 s83, 2211840
    s_cselect_b32 s83, 0, s83
    s_add_u32 m0, s79, 32768
    s_add_u32 s61, s83, 0
    buffer_load_dwordx4 v17, s[40:43], s61 offen lds
    s_add_u32 m0, s79, 36864
    s_add_u32 s61, s83, 40960
    buffer_load_dwordx4 v17, s[40:43], s61 offen lds
    s_add_u32 s83, s83, 81920
    s_cmp_eq_u32 s83, 2211840
    s_cselect_b32 s83, 0, s83
    s_add_u32 m0, s79, 40960
    s_add_u32 s61, s83, 0
    buffer_load_dwordx4 v17, s[40:43], s61 offen lds
    s_add_u32 m0, s79, 45056
    s_add_u32 s61, s83, 40960
    buffer_load_dwordx4 v17, s[40:43], s61 offen lds
    s_add_u32 s83, s83, 81920
    s_cmp_eq_u32 s83, 2211840
    s_cselect_b32 s83, 0, s83
    s_add_u32 m0, s79, 49152
    s_add_u32 s61, s83, 0
    buffer_load_dwordx4 v17, s[40:43], s61 offen lds
    s_add_u32 m0, s79, 53248
    s_add_u32 s61, s83, 40960
    buffer_load_dwordx4 v17, s[40:43], s61 offen lds
    s_add_u32 s83, s83, 81920
    s_cmp_eq_u32 s83, 2211840
    s_cselect_b32 s83, 0, s83
    s_add_u32 m0, s79, 57344
    s_add_u32 s61, s83, 0
    buffer_load_dwordx4 v17, s[40:43], s61 offen lds
    s_add_u32 m0, s79, 61440
    s_add_u32 s61, s83, 40960
    buffer_load_dwordx4 v17, s[40:43], s61 offen lds
    s_add_u32 s83, s83, 81920
    s_cmp_eq_u32 s83, 2211840
    s_cselect_b32 s83, 0, s83
    s_add_u32 m0, s79, 65536
    s_add_u32 s61, s83, 0
    buffer_load_dwordx4 v17, s[40:43], s61 offen lds
    s_add_u32 m0, s79, 69632
    s_add_u32 s61, s83, 40960
    buffer_load_dwordx4 v17, s[40:43], s61 offen lds
    s_add_u32 s83, s83, 81920
    s_cmp_eq_u32 s83, 2211840
    s_cselect_b32 s83, 0, s83
Lp4l:
    s_mul_i32 s75, s82, 32768
    s_cmp_eq_u32 s66, 2
    s_cselect_b32 s61, 14, 0
    s_cmp_eq_u32 s66, 1
    s_cselect_b32 s60, 28, 14
    v_and_b32 v8, 15, v1
    v_lshlrev_b32 v10, 3, v8
    v_cmp_gt_u32 vcc, s69, v10
    v_lshlrev_b32 v8, 7, v8
    v_bfe_u32 v10, v1, 4, 1
    v_lshl_add_u32 v8, v10, 12, v8
    v_lshrrev_b32 v10, 5, v1
    v_mul_u32_u24 v10, 327680, v10
    v_add_u32 v8, v8, v10
    s_add_u32 s3, s67, 10
    s_lshl_b32 s3, s3, 2
    s_add_u32 s3, s3, s23
    s_lshl_b32 s3, s3, 13
    s_lshl_b32 s62, s63, 4
    s_add_u32 s3, s3, s62
    v_add_u32 v8, s3, v8
    s_cmp_lt_u32 s67, 7
    s_cselect_b32 vcc_hi, vcc_hi, 0
    v_mov_b32 v10, 2147483648
    v_cndmask_b32 v8, v10, v8, vcc
    s_mul_i32 s61, s61, 64
    s_add_u32 s61, s61, 1646592
    v_mul_u32_u24 v2, 64, v1
    s_bfm_b64 exec, s60, 0
    s_mov_b32 s60, 0x100000
poll_20:
    buffer_load_dwordx4 v[4:7], v2, s[52:55], s61 offen sc1
    s_sub_u32 s60, s60, 1
    s_cbranch_scc1 pollx_21
    s_waitcnt vmcnt(0)
    v_and_b32 v4, v4, v5
    v_and_b32 v6, v6, v7
    v_and_b32 v4, v4, v6
    v_cmp_ne_u32 vcc, 1, v4
    s_cbranch_vccnz poll_20
pollx_21:
    s_waitcnt vmcnt(0)
    s_mov_b64 exec, -1
    s_add_u32 s61, s75, 0
    s_add_u32 m0, s65, 102400
    s_nop 0
    buffer_load_dwordx4 v11, s[52:55], s61 offen sc1 lds
    s_add_u32 m0, s65, 103424
    s_nop 0
    buffer_load_dwordx4 v12, s[52:55], s61 offen sc1 lds
    s_add_u32 m0, s65, 104448
    s_nop 0
    buffer_load_dwordx4 v13, s[52:55], s61 offen sc1 lds
    s_add_u32 s75, s75, 32768
    s_cmp_eq_u32 s75, 884736
    s_cselect_b32 s75, 0, s75
    s_add_u32 s61, s75, 0
    s_add_u32 m0, s65, 114688
    s_nop 0
    buffer_load_dwordx4 v11, s[52:55], s61 offen sc1 lds
    s_add_u32 m0, s65, 115712
    s_nop 0
    buffer_load_dwordx4 v12, s[52:55], s61 offen sc1 lds
    s_add_u32 m0, s65, 116736
    s_nop 0
    buffer_load_dwordx4 v13, s[52:55], s61 offen sc1 lds
    s_add_u32 s75, s75, 32768
    s_cmp_eq_u32 s75, 884736
    s_cselect_b32 s75, 0, s75
    s_add_u32 s61, s75, 0
    s_add_u32 m0, s65, 126976
    s_nop 0
    buffer_load_dwordx4 v11, s[52:55], s61 offen sc1 lds
    s_add_u32 m0, s65, 128000
    s_nop 0
    buffer_load_dwordx4 v12, s[52:55], s61 offen sc1 lds
    s_add_u32 m0, s65, 129024
    s_nop 0
    buffer_load_dwordx4 v13, s[52:55], s61 offen sc1 lds
    s_add_u32 s75, s75, 32768
    s_cmp_eq_u32 s75, 884736
    s_cselect_b32 s75, 0, s75
    s_add_u32 s61, s75, 0
    s_add_u32 m0, s65, 139264
    s_nop 0
    buffer_load_dwordx4 v11, s[52:55], s61 offen sc1 lds
    s_add_u32 m0, s65, 140288
    s_nop 0
    buffer_load_dwordx4 v12, s[52:55], s61 offen sc1 lds
    s_add_u32 m0, s65, 141312
    s_nop 0
    buffer_load_dwordx4 v13, s[52:55], s61 offen sc1 lds
    s_add_u32 s75, s75, 32768
    s_cmp_eq_u32 s75, 884736
    s_cselect_b32 s75, 0, s75
    buffer_load_dword v10, v8, s[52:55], 0 offen sc1
    s_waitcnt vmcnt(10)
    s_barrier
    s_add_u32 s61, s75, 0
    s_add_u32 m0, s65, 151552
    s_nop 0
    buffer_load_dwordx4 v11, s[52:55], s61 offen sc1 lds
    s_add_u32 m0, s65, 152576
    s_nop 0
    buffer_load_dwordx4 v12, s[52:55], s61 offen sc1 lds
    s_add_u32 m0, s65, 153600
    s_nop 0
    buffer_load_dwordx4 v13, s[52:55], s61 offen sc1 lds
    s_add_u32 s75, s75, 32768
    s_cmp_eq_u32 s75, 884736
    s_cselect_b32 s75, 0, s75
    s_waitcnt vmcnt(10)
    s_barrier
    s_waitcnt vmcnt(7)
    s_barrier
    s_add_u32 s61, s75, 0
    s_add_u32 m0, s65, 102400
    s_nop 0
    buffer_load_dwordx4 v11, s[52:55], s61 offen sc1 lds
    s_add_u32 m0, s65, 103424
    s_nop 0
    buffer_load_dwordx4 v12, s[52:55], s61 offen sc1 lds
    s_add_u32 m0, s65, 104448
    s_nop 0
    buffer_load_dwordx4 v13, s[52:55], s61 offen sc1 lds
    s_add_u32 s75, s75, 32768
    s_cmp_eq_u32 s75, 884736
    s_cselect_b32 s75, 0, s75
    s_add_u32 m0, s79, 73728
    s_add_u32 s61, s83, 0
    buffer_load_dwordx4 v17, s[40:43], s61 offen lds
    s_add_u32 m0, s79, 77824
    s_add_u32 s61, s83, 40960
    buffer_load_dwordx4 v17, s[40:43], s61 offen lds
    s_add_u32 s83, s83, 81920
    s_cmp_eq_u32 s83, 2211840
    s_cselect_b32 s83, 0, s83
    s_waitcnt vmcnt(9)
    s_barrier
    s_add_u32 s61, s75, 0
    s_add_u32 m0, s65, 114688
    s_nop 0
    buffer_load_dwordx4 v11, s[52:55], s61 offen sc1 lds
    s_add_u32 m0, s65, 115712
    s_nop 0
    buffer_load_dwordx4 v12, s[52:55], s61 offen sc1 lds
    s_add_u32 m0, s65, 116736
    s_nop 0
    buffer_load_dwordx4 v13, s[52:55], s61 offen sc1 lds
    s_add_u32 s75, s75, 32768
    s_cmp_eq_u32 s75, 884736
    s_cselect_b32 s75, 0, s75
    s_add_u32 m0, s79, 81920
    s_add_u32 s61, s83, 0
    buffer_load_dwordx4 v17, s[40:43], s61 offen lds
    s_add_u32 m0, s79, 86016
    s_add_u32 s61, s83, 40960
    buffer_load_dwordx4 v17, s[40:43], s61 offen lds
    s_add_u32 s83, s83, 81920
    s_cmp_eq_u32 s83, 2211840
    s_cselect_b32 s83, 0, s83
    s_waitcnt vmcnt(10)
    s_barrier
    s_add_u32 s61, s75, 0
    s_add_u32 m0, s65, 126976
    s_nop 0
    buffer_load_dwordx4 v11, s[52:55], s61 offen sc1 lds
    s_add_u32 m0, s65, 128000
    s_nop 0
    buffer_load_dwordx4 v12, s[52:55], s61 offen sc1 lds
    s_add_u32 m0, s65, 129024
    s_nop 0
    buffer_load_dwordx4 v13, s[52:55], s61 offen sc1 lds
    s_add_u32 s75, s75, 32768
    s_cmp_eq_u32 s75, 884736
    s_cselect_b32 s75, 0, s75
    s_add_u32 m0, s79, 90112
    s_add_u32 s61, s83, 0
    buffer_load_dwordx4 v17, s[40:43], s61 offen lds
    s_add_u32 m0, s79, 94208
    s_add_u32 s61, s83, 40960
    buffer_load_dwordx4 v17, s[40:43], s61 offen lds
    s_add_u32 s83, s83, 81920
    s_cmp_eq_u32 s83, 2211840
    s_cselect_b32 s83, 0, s83
    s_waitcnt vmcnt(12)
    s_barrier
    s_add_u32 s61, s75, 0
    s_add_u32 m0, s65, 139264
    s_nop 0
    buffer_load_dwordx4 v11, s[52:55], s61 offen sc1 lds
    s_add_u32 m0, s65, 140288
    s_nop 0
    buffer_load_dwordx4 v12, s[52:55], s61 offen sc1 lds
    s_add_u32 m0, s65, 141312
    s_nop 0
    buffer_load_dwordx4 v13, s[52:55], s61 offen sc1 lds
    s_add_u32 s75, s75, 32768
    s_cmp_eq_u32 s75, 884736
    s_cselect_b32 s75, 0, s75
    s_add_u32 m0, s79, 0
    s_add_u32 s61, s83, 0
    buffer_load_dwordx4 v17, s[40:43], s61 offen lds
    s_add_u32 m0, s79, 4096
    s_add_u32 s61, s83, 40960
    buffer_load_dwordx4 v17, s[40:43], s61 offen lds
    s_add_u32 s83, s83, 81920
    s_cmp_eq_u32 s83, 2211840
    s_cselect_b32 s83, 0, s83
    s_waitcnt vmcnt(12)
    s_barrier
    s_add_u32 s61, s75, 0
    s_add_u32 m0, s65, 151552
    s_nop 0
    buffer_load_dwordx4 v11, s[52:55], s61 offen sc1 lds
    s_add_u32 m0, s65, 152576
    s_nop 0
    buffer_load_dwordx4 v12, s[52:55], s61 offen sc1 lds
    s_add_u32 m0, s65, 153600
    s_nop 0
    buffer_load_dwordx4 v13, s[52:55], s61 offen sc1 lds
    s_add_u32 s75, s75, 32768
    s_cmp_eq_u32 s75, 884736
    s_cselect_b32 s75, 0, s75
    s_add_u32 m0, s79, 8192
    s_add_u32 s61, s83, 0
    buffer_load_dwordx4 v17, s[40:43], s61 offen lds
    s_add_u32 m0, s79, 12288
    s_add_u32 s61, s83, 40960
    buffer_load_dwordx4 v17, s[40:43], s61 offen lds
    s_add_u32 s83, s83, 81920
    s_cmp_eq_u32 s83, 2211840
    s_cselect_b32 s83, 0, s83
    s_waitcnt vmcnt(12)
    s_barrier
    s_add_u32 s61, s75, 0
    s_add_u32 m0, s65, 102400
    s_nop 0
    buffer_load_dwordx4 v11, s[52:55], s61 offen sc1 lds
    s_add_u32 m0, s65, 103424
    s_nop 0
    buffer_load_dwordx4 v12, s[52:55], s61 offen sc1 lds
    s_add_u32 m0, s65, 104448
    s_nop 0
    buffer_load_dwordx4 v13, s[52:55], s61 offen sc1 lds
    s_add_u32 s75, s75, 32768
    s_cmp_eq_u32 s75, 884736
    s_cselect_b32 s75, 0, s75
    s_add_u32 m0, s79, 16384
    s_add_u32 s61, s83, 0
    buffer_load_dwordx4 v17, s[40:43], s61 offen lds
    s_add_u32 m0, s79, 20480
    s_add_u32 s61, s83, 40960
    buffer_load_dwordx4 v17, s[40:43], s61 offen lds
    s_add_u32 s83, s83, 81920
    s_cmp_eq_u32 s83, 2211840
    s_cselect_b32 s83, 0, s83
    s_waitcnt vmcnt(12)
    s_barrier
    s_add_u32 s61, s75, 0
    s_add_u32 m0, s65, 114688
    s_nop 0
    buffer_load_dwordx4 v11, s[52:55], s61 offen sc1 lds
    s_add_u32 m0, s65, 115712
    s_nop 0
    buffer_load_dwordx4 v12, s[52:55], s61 offen sc1 lds
    s_add_u32 m0, s65, 116736
    s_nop 0
    buffer_load_dwordx4 v13, s[52:55], s61 offen sc1 lds
    s_add_u32 s75, s75, 32768
    s_cmp_eq_u32 s75, 884736
    s_cselect_b32 s75, 0, s75
    s_add_u32 m0, s79, 24576
    s_add_u32 s61, s83, 0
    buffer_load_dwordx4 v17, s[40:43], s61 offen lds
    s_add_u32 m0, s79, 28672
    s_add_u32 s61, s83, 40960
    buffer_load_dwordx4 v17, s[40:43], s61 offen lds
    s_add_u32 s83, s83, 81920
    s_cmp_eq_u32 s83, 2211840
    s_cselect_b32 s83, 0, s83
    s_waitcnt vmcnt(12)
    s_barrier
    s_add_u32 s61, s75, 0
    s_add_u32 m0, s65, 126976
    s_nop 0
    buffer_load_dwordx4 v11, s[52:55], s61 offen sc1 lds
    s_add_u32 m0, s65, 128000
    s_nop 0
    buffer_load_dwordx4 v12, s[52:55], s61 offen sc1 lds
    s_add_u32 m0, s65, 129024
    s_nop 0
    buffer_load_dwordx4 v13, s[52:55], s61 offen sc1 lds
    s_add_u32 s75, s75, 32768
    s_cmp_eq_u32 s75, 884736
    s_cselect_b32 s75, 0, s75
    s_add_u32 m0, s79, 32768
    s_add_u32 s61, s83, 0
    buffer_load_dwordx4 v17, s[40:43], s61 offen lds
    s_add_u32 m0, s79, 36864
    s_add_u32 s61, s83, 40960
    buffer_load_dwordx4 v17, s[40:43], s61 offen lds
    s_add_u32 s83, s83, 81920
    s_cmp_eq_u32 s83, 2211840
    s_cselect_b32 s83, 0, s83
    s_waitcnt vmcnt(12)
    s_barrier
    s_add_u32 s61, s75, 0
    s_add_u32 m0, s65, 139264
    s_nop 0
    buffer_load_dwordx4 v11, s[52:55], s61 offen sc1 lds
    s_add_u32 m0, s65, 140288
    s_nop 0
    buffer_load_dwordx4 v12, s[52:55], s61 offen sc1 lds
    s_add_u32 m0, s65, 141312
    s_nop 0
    buffer_load_dwordx4 v13, s[52:55], s61 offen sc1 lds
    s_add_u32 s75, s75, 32768
    s_cmp_eq_u32 s75, 884736
    s_cselect_b32 s75, 0, s75
    s_add_u32 m0, s79, 40960
    s_add_u32 s61, s83, 0
    buffer_load_dwordx4 v17, s[40:43], s61 offen lds
    s_add_u32 m0, s79, 45056
    s_add_u32 s61, s83, 40960
    buffer_load_dwordx4 v17, s[40:43], s61 offen lds
    s_add_u32 s83, s83, 81920
    s_cmp_eq_u32 s83, 2211840
    s_cselect_b32 s83, 0, s83
    s_waitcnt vmcnt(12)
    s_barrier
    s_add_u32 s61, s75, 0
    s_add_u32 m0, s65, 151552
    s_nop 0
    buffer_load_dwordx4 v11, s[52:55], s61 offen sc1 lds
    s_add_u32 m0, s65, 152576
    s_nop 0
    buffer_load_dwordx4 v12, s[52:55], s61 offen sc1 lds
    s_add_u32 m0, s65, 153600
    s_nop 0
    buffer_load_dwordx4 v13, s[52:55], s61 offen sc1 lds
    s_add_u32 s75, s75, 32768
    s_cmp_eq_u32 s75, 884736
    s_cselect_b32 s75, 0, s75
    s_add_u32 m0, s79, 49152
    s_add_u32 s61, s83, 0
    buffer_load_dwordx4 v17, s[40:43], s61 offen lds
    s_add_u32 m0, s79, 53248
    s_add_u32 s61, s83, 40960
    buffer_load_dwordx4 v17, s[40:43], s61 offen lds
    s_add_u32 s83, s83, 81920
    s_cmp_eq_u32 s83, 2211840
    s_cselect_b32 s83, 0, s83
    s_waitcnt vmcnt(12)
    s_barrier
    s_add_u32 s61, s75, 0
    s_add_u32 m0, s65, 102400
    s_nop 0
    buffer_load_dwordx4 v11, s[52:55], s61 offen sc1 lds
    s_add_u32 m0, s65, 103424
    s_nop 0
    buffer_load_dwordx4 v12, s[52:55], s61 offen sc1 lds
    s_add_u32 m0, s65, 104448
    s_nop 0
    buffer_load_dwordx4 v13, s[52:55], s61 offen sc1 lds
    s_add_u32 s75, s75, 32768
    s_cmp_eq_u32 s75, 884736
    s_cselect_b32 s75, 0, s75
    s_add_u32 m0, s79, 57344
    s_add_u32 s61, s83, 0
    buffer_load_dwordx4 v17, s[40:43], s61 offen lds
    s_add_u32 m0, s79, 61440
    s_add_u32 s61, s83, 40960
    buffer_load_dwordx4 v17, s[40:43], s61 offen lds
    s_add_u32 s83, s83, 81920
    s_cmp_eq_u32 s83, 2211840
    s_cselect_b32 s83, 0, s83
    s_waitcnt vmcnt(12)
    s_barrier
    s_add_u32 s61, s75, 0
    s_add_u32 m0, s65, 114688
    s_nop 0
    buffer_load_dwordx4 v11, s[52:55], s61 offen sc1 lds
    s_add_u32 m0, s65, 115712
    s_nop 0
    buffer_load_dwordx4 v12, s[52:55], s61 offen sc1 lds
    s_add_u32 m0, s65, 116736
    s_nop 0
    buffer_load_dwordx4 v13, s[52:55], s61 offen sc1 lds
    s_add_u32 s75, s75, 32768
    s_cmp_eq_u32 s75, 884736
    s_cselect_b32 s75, 0, s75
    s_add_u32 m0, s79, 65536
    s_add_u32 s61, s83, 0
    buffer_load_dwordx4 v17, s[40:43], s61 offen lds
    s_add_u32 m0, s79, 69632
    s_add_u32 s61, s83, 40960
    buffer_load_dwordx4 v17, s[40:43], s61 offen lds
    s_add_u32 s83, s83, 81920
    s_cmp_eq_u32 s83, 2211840
    s_cselect_b32 s83, 0, s83
    s_waitcnt vmcnt(12)
    s_barrier
    s_add_u32 s61, s75, 0
    s_add_u32 m0, s65, 126976
    s_nop 0
    buffer_load_dwordx4 v11, s[52:55], s61 offen sc1 lds
    s_add_u32 m0, s65, 128000
    s_nop 0
    buffer_load_dwordx4 v12, s[52:55], s61 offen sc1 lds
    s_add_u32 m0, s65, 129024
    s_nop 0
    buffer_load_dwordx4 v13, s[52:55], s61 offen sc1 lds
    s_add_u32 s75, s75, 32768
    s_cmp_eq_u32 s75, 884736
    s_cselect_b32 s75, 0, s75
    s_add_u32 m0, s79, 73728
    s_add_u32 s61, s83, 0
    buffer_load_dwordx4 v17, s[40:43], s61 offen lds
    s_add_u32 m0, s79, 77824
    s_add_u32 s61, s83, 40960
    buffer_load_dwordx4 v17, s[40:43], s61 offen lds
    s_add_u32 s83, s83, 81920
    s_cmp_eq_u32 s83, 2211840
    s_cselect_b32 s83, 0, s83
    s_waitcnt vmcnt(12)
    s_barrier
    s_add_u32 s61, s75, 0
    s_add_u32 m0, s65, 139264
    s_nop 0
    buffer_load_dwordx4 v11, s[52:55], s61 offen sc1 lds
    s_add_u32 m0, s65, 140288
    s_nop 0
    buffer_load_dwordx4 v12, s[52:55], s61 offen sc1 lds
    s_add_u32 m0, s65, 141312
    s_nop 0
    buffer_load_dwordx4 v13, s[52:55], s61 offen sc1 lds
    s_add_u32 s75, s75, 32768
    s_cmp_eq_u32 s75, 884736
    s_cselect_b32 s75, 0, s75
    s_add_u32 m0, s79, 81920
    s_add_u32 s61, s83, 0
    buffer_load_dwordx4 v17, s[40:43], s61 offen lds
    s_add_u32 m0, s79, 86016
    s_add_u32 s61, s83, 40960
    buffer_load_dwordx4 v17, s[40:43], s61 offen lds
    s_add_u32 s83, s83, 81920
    s_cmp_eq_u32 s83, 2211840
    s_cselect_b32 s83, 0, s83
    s_waitcnt vmcnt(12)
    s_barrier
    s_add_u32 s61, s75, 0
    s_add_u32 m0, s65, 151552
    s_nop 0
    buffer_load_dwordx4 v11, s[52:55], s61 offen sc1 lds
    s_add_u32 m0, s65, 152576
    s_nop 0
    buffer_load_dwordx4 v12, s[52:55], s61 offen sc1 lds
    s_add_u32 m0, s65, 153600
    s_nop 0
    buffer_load_dwordx4 v13, s[52:55], s61 offen sc1 lds
    s_add_u32 s75, s75, 32768
    s_cmp_eq_u32 s75, 884736
    s_cselect_b32 s75, 0, s75
    s_add_u32 m0, s79, 90112
    s_add_u32 s61, s83, 0
    buffer_load_dwordx4 v17, s[40:43], s61 offen lds
    s_add_u32 m0, s79, 94208
    s_add_u32 s61, s83, 40960
    buffer_load_dwordx4 v17, s[40:43], s61 offen lds
    s_add_u32 s83, s83, 81920
    s_cmp_eq_u32 s83, 2211840
    s_cselect_b32 s83, 0, s83
    s_waitcnt vmcnt(12)
    s_barrier
    s_add_u32 s61, s75, 0
    s_add_u32 m0, s65, 102400
    s_nop 0
    buffer_load_dwordx4 v11, s[52:55], s61 offen sc1 lds
    s_add_u32 m0, s65, 103424
    s_nop 0
    buffer_load_dwordx4 v12, s[52:55], s61 offen sc1 lds
    s_add_u32 m0, s65, 104448
    s_nop 0
    buffer_load_dwordx4 v13, s[52:55], s61 offen sc1 lds
    s_add_u32 s75, s75, 32768
    s_cmp_eq_u32 s75, 884736
    s_cselect_b32 s75, 0, s75
    s_waitcnt vmcnt(10)
    s_barrier
    s_add_u32 s61, s75, 0
    s_add_u32 m0, s65, 114688
    s_nop 0
    buffer_load_dwordx4 v11, s[52:55], s61 offen sc1 lds
    s_add_u32 m0, s65, 115712
    s_nop 0
    buffer_load_dwordx4 v12, s[52:55], s61 offen sc1 lds
    s_add_u32 m0, s65, 116736
    s_nop 0
    buffer_load_dwordx4 v13, s[52:55], s61 offen sc1 lds
    s_add_u32 s75, s75, 32768
    s_cmp_eq_u32 s75, 884736
    s_cselect_b32 s75, 0, s75
    s_waitcnt vmcnt(8)
    s_barrier
    s_add_u32 s61, s75, 0
    s_add_u32 m0, s65, 126976
    s_nop 0
    buffer_load_dwordx4 v11, s[52:55], s61 offen sc1 lds
    s_add_u32 m0, s65, 128000
    s_nop 0
    buffer_load_dwordx4 v12, s[52:55], s61 offen sc1 lds
    s_add_u32 m0, s65, 129024
    s_nop 0
    buffer_load_dwordx4 v13, s[52:55], s61 offen sc1 lds
    s_add_u32 s75, s75, 32768
    s_cmp_eq_u32 s75, 884736
    s_cselect_b32 s75, 0, s75
    s_waitcnt vmcnt(6)
    s_barrier
    s_add_u32 s61, s75, 0
    s_add_u32 m0, s65, 139264
    s_nop 0
    buffer_load_dwordx4 v11, s[52:55], s61 offen sc1 lds
    s_add_u32 m0, s65, 140288
    s_nop 0
    buffer_load_dwordx4 v12, s[52:55], s61 offen sc1 lds
    s_add_u32 m0, s65, 141312
    s_nop 0
    buffer_load_dwordx4 v13, s[52:55], s61 offen sc1 lds
    s_add_u32 s75, s75, 32768
    s_cmp_eq_u32 s75, 884736
    s_cselect_b32 s75, 0, s75
    s_waitcnt vmcnt(6)
    s_barrier
    s_add_u32 s61, s75, 0
    s_add_u32 m0, s65, 151552
    s_nop 0
    buffer_load_dwordx4 v11, s[52:55], s61 offen sc1 lds
    s_add_u32 m0, s65, 152576
    s_nop 0
    buffer_load_dwordx4 v12, s[52:55], s61 offen sc1 lds
    s_add_u32 m0, s65, 153600
    s_nop 0
    buffer_load_dwordx4 v13, s[52:55], s61 offen sc1 lds
    s_add_u32 s75, s75, 32768
    s_cmp_eq_u32 s75, 884736
    s_cselect_b32 s75, 0, s75
    s_waitcnt vmcnt(6)
    s_barrier
    s_add_u32 s61, s75, 0
    s_add_u32 m0, s65, 102400
    s_nop 0
    buffer_load_dwordx4 v11, s[52:55], s61 offen sc1 lds
    s_add_u32 m0, s65, 103424
    s_nop 0
    buffer_load_dwordx4 v12, s[52:55], s61 offen sc1 lds
    s_add_u32 m0, s65, 104448
    s_nop 0
    buffer_load_dwordx4 v13, s[52:55], s61 offen sc1 lds
    s_add_u32 s75, s75, 32768
    s_cmp_eq_u32 s75, 884736
    s_cselect_b32 s75, 0, s75
    s_waitcnt vmcnt(6)
    s_barrier
    s_add_u32 s61, s75, 0
    s_add_u32 m0, s65, 114688
    s_nop 0
    buffer_load_dwordx4 v11, s[52:55], s61 offen sc1 lds
    s_add_u32 m0, s65, 115712
    s_nop 0
    buffer_load_dwordx4 v12, s[52:55], s61 offen sc1 lds
    s_add_u32 m0, s65, 116736
    s_nop 0
    buffer_load_dwordx4 v13, s[52:55], s61 offen sc1 lds
    s_add_u32 s75, s75, 32768
    s_cmp_eq_u32 s75, 884736
    s_cselect_b32 s75, 0, s75
    s_waitcnt vmcnt(6)
    s_barrier
    s_waitcnt vmcnt(3)
    s_barrier
    s_waitcnt vmcnt(0)
    s_barrier
    s_barrier
    s_endpgm
Lcomp:
    v_lshrrev_b32 v2, 3, v1
    v_and_b32 v2, 3, v2
    v_mul_u32_u24 v2, 40960, v2
    v_and_b32 v3, 7, v1
    v_lshl_add_u32 v2, v3, 4, v2
    v_mov_b32 v20, 0x3f803f80
    v_mov_b32 v21, 0x3f803f80
    v_mov_b32 v22, 0x3f803f80
    v_mov_b32 v23, 0x3f803f80
    ds_write_b128 v2, v[20:23]
    s_waitcnt lgkmcnt(0)
    s_lshl_b32 s3, s56, 21
    s_add_u32 s52, s20, s3
    s_addc_u32 s53, s21, 0
    s_mov_b32 s54, 2097152
    s_mov_b32 s55, 0x00020000
    s_mov_b32 s48, s18
    s_mov_b32 s49, s19
    s_mov_b32 s50, 256
    s_mov_b32 s51, 0x00020000
    s_mov_b32 s24, s4
    s_mov_b32 s25, s5
    s_mov_b32 s26, 2621440
    s_mov_b32 s27, 0x00020000
    s_mov_b32 s32, s8
    s_mov_b32 s33, s9
    s_mov_b32 s34, 819200
    s_mov_b32 s35, 0x00020000
    s_mov_b32 s36, s12
    s_mov_b32 s37, s13
    s_mov_b32 s38, 2211840
    s_mov_b32 s39, 0x00020000
    s_mov_b32 s40, s14
    s_mov_b32 s41, s15
    s_mov_b32 s42, 2211840
    s_mov_b32 s43, 0x00020000
    s_mov_b32 s44, s16
    s_mov_b32 s45, s17
    s_mov_b32 s46, 2621440
    s_mov_b32 s47, 0x00020000
    s_getreg_b32 s3, hwreg(HW_REG_XCC_ID, 0, 4)
    s_mul_i32 s88, s3, s3
    s_lshl_b32 s88, s88, 10
    s_add_u32 s88, s88, s3
    s_add_u32 s88, s88, 0x800000
    s_cmp_lg_u32 s22, 0
    s_cbranch_scc1 fc_22
    v_lshrrev_b32 v2, 3, v1
    v_lshlrev_b32 v2, 11, v2
    v_and_b32 v3, 7, v1
    v_lshl_add_u32 v2, v3, 2, v2
    v_mov_b32 v3, 0
    s_mul_i32 s61, s57, 64
    s_add_u32 s61, s61, 1638400
    s_mov_b32 exec_hi, 0xffff
    buffer_store_dword v3, v2, s[52:55], s61 offen sc1
    s_mov_b64 exec, -1
    s_lshl_b32 s61, s56, 5
    v_mov_b32 v3, s88
    s_waitcnt vmcnt(0)
    s_mov_b64 exec, 1
    buffer_atomic_add v3, off, s[48:51], s61
    s_mov_b64 exec, -1
fc_22:
    v_lshrrev_b32 v10, 2, v1
    v_mul_u32_u24 v10, 480, v10
    s_mul_i32 s3, s23, 40
    v_add_u32 v10, s3, v10
    v_and_b32 v3, 3, v1
    v_add_u32 v13, 1, v3
    v_mul_u32_u24 v13, 160, v13
    v_cmp_gt_u32 vcc, 2, v3
    s_nop 1
    v_cndmask_b32 v13, 0, v13, vcc
    v_add3_u32 v13, v13, v10, 32
    v_lshl_add_u32 v10, v3, 3, v10
    v_and_b32 v3, 15, v1
    v_lshrrev_b32 v2, 1, v3
    v_lshrrev_b32 v4, 4, v1
    v_xor_b32 v4, v4, v2
    v_lshlrev_b32 v4, 4, v4
    v_lshl_add_u32 v4, v3, 7, v4
    s_and_b32 s3, s57, 8
    s_lshl_b32 s3, s3, 3
    v_xor_b32 v4, s3, v4
    v_xor_b32 v7, 64, v4
    v_add_u32 v5, 0x10000, v4
    v_add_u32 v6, 0x20000, v4
    v_add_u32 v8, 0x10000, v7
    v_add_u32 v9, 0x20000, v7
    v_add_u32 v11, 0x10000, v10
    v_add_u32 v12, 0x20000, v10
    v_add_u32 v14, 0x10000, v13
    v_add_u32 v15, 0x20000, v13
    v_lshrrev_b32 v2, 4, v1
    v_mov_b32 v20, 0xf149f2ca
    v_and_b32 v21, 1, v3
    v_lshl_add_u32 v22, v2, 2, 0
    v_cmp_le_u32 vcc, v22, v3
    s_nop 1
    v_cndmask_b32 v240, v20, 0, vcc
    v_cndmask_b32 v244, 0, v20, vcc
    v_cmp_eq_u32 vcc, 0, v21
    s_nop 1
    v_cndmask_b32 v240, v20, v240, vcc
    v_cndmask_b32 v244, v20, v244, vcc
    v_lshl_add_u32 v22, v2, 2, 1
    v_cmp_le_u32 vcc, v22, v3
    s_nop 1
    v_cndmask_b32 v241, v20, 0, vcc
    v_cndmask_b32 v245, 0, v20, vcc
    v_cmp_eq_u32 vcc, 1, v21
    s_nop 1
    v_cndmask_b32 v241, v20, v241, vcc
    v_cndmask_b32 v245, v20, v245, vcc
    v_lshl_add_u32 v22, v2, 2, 2
    v_cmp_le_u32 vcc, v22, v3
    s_nop 1
    v_cndmask_b32 v242, v20, 0, vcc
    v_cndmask_b32 v246, 0, v20, vcc
    v_cmp_eq_u32 vcc, 0, v21
    s_nop 1
    v_cndmask_b32 v242, v20, v242, vcc
    v_cndmask_b32 v246, v20, v246, vcc
    v_lshl_add_u32 v22, v2, 2, 3
    v_cmp_le_u32 vcc, v22, v3
    s_nop 1
    v_cndmask_b32 v243, v20, 0, vcc
    v_cndmask_b32 v247, 0, v20, vcc
    v_cmp_eq_u32 vcc, 1, v21
    s_nop 1
    v_cndmask_b32 v243, v20, v243, vcc
    v_cndmask_b32 v247, v20, v247, vcc
    s_cmp_eq_u32 s59, 0
    s_cselect_b64 vcc, -1, 0
    v_cndmask_b32 v248, v244, v20, vcc
    v_cndmask_b32 v249, v245, v20, vcc
    v_cndmask_b32 v250, v246, v20, vcc
    v_cndmask_b32 v251, v247, v20, vcc
    v_lshlrev_b32 v23, 4, v21
    v_mov_b32 v24, 0xffff
    v_lshlrev_b32 v23, v23, v24
    v_lshl_add_u32 v22, v2, 2, 0
    v_add_u32 v22, v22, v21
    v_cmp_le_u32 vcc, v22, v3
    s_nop 1
    v_cndmask_b32 v94, 0, v23, vcc
    v_cndmask_b32 v92, v23, 0, vcc
    v_lshl_add_u32 v22, v2, 2, 2
    v_add_u32 v22, v22, v21
    v_cmp_le_u32 vcc, v22, v3
    s_nop 1
    v_cndmask_b32 v95, 0, v23, vcc
    v_cndmask_b32 v93, v23, 0, vcc
    v_mov_b32 v222, 0
    v_mov_b32 v223, 0
    v_mov_b32 v226, 0
    v_mov_b32 v227, 0
    v_mov_b32 v230, 0
    v_mov_b32 v231, 0
    v_mov_b32 v234, 0
    v_mov_b32 v235, 0
    v_mov_b32 v238, 0
    v_mov_b32 v239, 0
    s_mul_i32 s3, s23, 2560
    s_add_u32 s3, s3, 1024
    v_lshl_add_u32 v17, v3, 5, s3
    v_lshl_add_u32 v16, v2, 3, v17
    v_cmp_eq_u32 vcc, 0, v2
    s_nop 1
    v_cndmask_b32 v22, 24, 16, vcc
    v_add_u32 v17, v17, v22
    v_lshrrev_b32 v18, 2, v1
    v_lshl_add_u32 v18, v18, 5, s3
    v_add_u32 v18, 8, v18
    s_and_b32 s3, s59, 3
    s_lshl_b32 s3, s3, 10
    v_lshrrev_b32 v22, 1, v2
    v_lshlrev_b32 v19, 12, v22
    v_and_b32 v22, 1, v2
    v_lshl_add_u32 v19, v22, 3, v19
    v_lshl_add_u32 v19, v3, 4, v19
    v_add_u32 v19, s3, v19
    v_lshl_add_u32 v98, v1, 4, s3
    v_lshlrev_b32 v99, 2, v3
    v_lshlrev_b32 v252, 4, v2
    s_mul_i32 s60, s58, 10
    s_lshl_b32 s3, s23, 1
    s_add_u32 s89, s60, s3
    s_lshl_b32 s89, s89, 12
    s_lshr_b32 s3, s23, 1
    s_add_u32 s90, s60, s3
    s_add_u32 s90, s90, 8
    s_lshl_b32 s90, s90, 12
    v_and_b32 v22, 7, v1
    v_lshlrev_b32 v22, 7, v22
    v_bfe_u32 v23, v1, 3, 1
    v_lshl_add_u32 v22, v23, 12, v22
    s_and_b32 s3, s59, 3
    s_lshl_b32 s3, s3, 10
    v_add_u32 v22, s3, v22
    v_mov_b32 v97, v22
    s_and_b32 s3, s23, 1
    s_lshl_b32 s3, s3, 3
    s_add_u32 s90, s90, s3
    s_waitcnt lgkmcnt(0)
    s_barrier
    ds_read_b128 v[36:39], v4 offset:0
    ds_read_b128 v[40:43], v4 offset:2048
    ds_read_b128 v[44:47], v4 offset:4096
    ds_read_b128 v[48:51], v4 offset:6144
    ds_read_b128 v[52:55], v4 offset:8192
    ds_read_b64_tr_b16 v[32:33], v13 offset:10240
    ds_read_b64_tr_b16 v[34:35], v13 offset:17920
    ds_read_b64_tr_b16 v[20:21], v10 offset:10400
    ds_read_b64_tr_b16 v[22:23], v10 offset:18080
    ds_read_b64_tr_b16 v[28:29], v10 offset:10240
    ds_read_b64_tr_b16 v[30:31], v10 offset:17920
    ds_read_b64_tr_b16 v[24:25], v10 offset:10560
    ds_read_b64_tr_b16 v[26:27], v10 offset:18240
    s_waitcnt lgkmcnt(0)
    s_barrier
    ds_read_b128 v[72:75], v7 offset:0
    v_mfma_f32_16x16x32_bf16 v[160:163], v[32:35], v[36:39], 0
    ds_read_b128 v[76:79], v7 offset:2048
    v_mfma_f32_16x16x32_bf16 v[164:167], v[32:35], v[40:43], 0
    ds_read_b128 v[80:83], v7 offset:4096
    v_mfma_f32_16x16x32_bf16 v[168:171], v[32:35], v[44:47], 0
    ds_read_b128 v[84:87], v7 offset:6144
    v_mfma_f32_16x16x32_bf16 v[172:175], v[32:35], v[48:51], 0
    ds_read_b128 v[88:91], v7 offset:8192
    v_mfma_f32_16x16x32_bf16 v[176:179], v[32:35], v[52:55], 0
    ds_read_b64_tr_b16 v[68:69], v13 offset:25600
    v_mfma_f32_16x16x32_bf16 v[100:103], v[20:23], v[36:39], 0
    ds_read_b64_tr_b16 v[70:71], v13 offset:33280
    v_mfma_f32_16x16x32_bf16 v[104:107], v[20:23], v[40:43], 0
    ds_read_b64_tr_b16 v[56:57], v10 offset:25760
    v_mfma_f32_16x16x32_bf16 v[108:111], v[20:23], v[44:47], 0
    ds_read_b64_tr_b16 v[58:59], v10 offset:33440
    v_mfma_f32_16x16x32_bf16 v[112:115], v[20:23], v[48:51], 0
    ds_read_b64_tr_b16 v[64:65], v10 offset:25600
    v_mfma_f32_16x16x32_bf16 v[116:119], v[20:23], v[52:55], 0
    ds_read_b64_tr_b16 v[66:67], v10 offset:33280
    v_mfma_f32_16x16x32_bf16 v[140:143], v[28:31], v[36:39], 0
    ds_read_b64_tr_b16 v[60:61], v10 offset:25920
    v_mfma_f32_16x16x32_bf16 v[144:147], v[28:31], v[40:43], 0
    ds_read_b64_tr_b16 v[62:63], v10 offset:33600
    v_mfma_f32_16x16x32_bf16 v[148:151], v[28:31], v[44:47], 0
    v_mfma_f32_16x16x32_bf16 v[152:155], v[28:31], v[48:51], 0
    v_mfma_f32_16x16x32_bf16 v[156:159], v[28:31], v[52:55], 0
    v_mfma_f32_16x16x32_bf16 v[120:123], v[36:39], v[24:27], 0
    v_mfma_f32_16x16x32_bf16 v[124:127], v[40:43], v[24:27], 0
    v_mfma_f32_16x16x32_bf16 v[128:131], v[44:47], v[24:27], 0
    v_mfma_f32_16x16x32_bf16 v[132:135], v[48:51], v[24:27], 0
    v_mfma_f32_16x16x32_bf16 v[136:139], v[52:55], v[24:27], 0
    s_waitcnt lgkmcnt(0)
    s_barrier
    ds_read_b128 v[36:39], v4 offset:40960
    v_mfma_f32_16x16x32_bf16 v[160:163], v[68:71], v[72:75], v[160:163]
    ds_read_b128 v[40:43], v4 offset:43008
    v_mfma_f32_16x16x32_bf16 v[164:167], v[68:71], v[76:79], v[164:167]
    ds_read_b128 v[44:47], v4 offset:45056
    v_mfma_f32_16x16x32_bf16 v[168:171], v[68:71], v[80:83], v[168:171]
    ds_read_b128 v[48:51], v4 offset:47104
    v_mfma_f32_16x16x32_bf16 v[172:175], v[68:71], v[84:87], v[172:175]
    ds_read_b128 v[52:55], v4 offset:49152
    v_mfma_f32_16x16x32_bf16 v[176:179], v[68:71], v[88:91], v[176:179]
    ds_read_b64_tr_b16 v[32:33], v13 offset:51200
    v_mfma_f32_16x16x32_bf16 v[100:103], v[56:59], v[72:75], v[100:103]
    ds_read_b64_tr_b16 v[34:35], v13 offset:58880
    v_mfma_f32_16x16x32_bf16 v[104:107], v[56:59], v[76:79], v[104:107]
    ds_read_b64_tr_b16 v[20:21], v10 offset:51360
    v_mfma_f32_16x16x32_bf16 v[108:111], v[56:59], v[80:83], v[108:111]
    ds_read_b64_tr_b16 v[22:23], v10 offset:59040
    v_mfma_f32_16x16x32_bf16 v[112:115], v[56:59], v[84:87], v[112:115]
    ds_read_b64_tr_b16 v[28:29], v10 offset:51200
    v_mfma_f32_16x16x32_bf16 v[116:119], v[56:59], v[88:91], v[116:119]
    ds_read_b64_tr_b16 v[30:31], v10 offset:58880
    v_mfma_f32_16x16x32_bf16 v[140:143], v[64:67], v[72:75], v[140:143]
    ds_read_b64_tr_b16 v[24:25], v10 offset:51520
    v_mfma_f32_16x16x32_bf16 v[144:147], v[64:67], v[76:79], v[144:147]
    ds_read_b64_tr_b16 v[26:27], v10 offset:59200
    v_mfma_f32_16x16x32_bf16 v[148:151], v[64:67], v[80:83], v[148:151]
    v_mfma_f32_16x16x32_bf16 v[152:155], v[64:67], v[84:87], v[152:155]
    v_mfma_f32_16x16x32_bf16 v[156:159], v[64:67], v[88:91], v[156:159]
    v_mfma_f32_16x16x32_bf16 v[120:123], v[72:75], v[60:63], v[120:123]
    v_mfma_f32_16x16x32_bf16 v[124:127], v[76:79], v[60:63], v[124:127]
    v_mfma_f32_16x16x32_bf16 v[128:131], v[80:83], v[60:63], v[128:131]
    v_mfma_f32_16x16x32_bf16 v[132:135], v[84:87], v[60:63], v[132:135]
    v_mfma_f32_16x16x32_bf16 v[136:139], v[88:91], v[60:63], v[136:139]
    s_waitcnt lgkmcnt(0)
    s_barrier
    ds_read_b128 v[72:75], v7 offset:40960
    v_mfma_f32_16x16x32_bf16 v[160:163], v[32:35], v[36:39], v[160:163]
    ds_read_b128 v[76:79], v7 offset:43008
    v_mfma_f32_16x16x32_bf16 v[164:167], v[32:35], v[40:43], v[164:167]
    ds_read_b128 v[80:83], v7 offset:45056
    v_mfma_f32_16x16x32_bf16 v[168:171], v[32:35], v[44:47], v[168:171]
    ds_read_b128 v[84:87], v7 offset:47104
    v_mfma_f32_16x16x32_bf16 v[172:175], v[32:35], v[48:51], v[172:175]
    ds_read_b128 v[88:91], v7 offset:49152
    v_mfma_f32_16x16x32_bf16 v[176:179], v[32:35], v[52:55], v[176:179]
    ds_read_b64_tr_b16 v[68:69], v14 offset:1024
    v_mfma_f32_16x16x32_bf16 v[100:103], v[20:23], v[36:39], v[100:103]
    ds_read_b64_tr_b16 v[70:71], v14 offset:8704
    v_mfma_f32_16x16x32_bf16 v[104:107], v[20:23], v[40:43], v[104:107]
    ds_read_b64_tr_b16 v[56:57], v11 offset:1184
    v_mfma_f32_16x16x32_bf16 v[108:111], v[20:23], v[44:47], v[108:111]
    ds_read_b64_tr_b16 v[58:59], v11 offset:8864
    v_mfma_f32_16x16x32_bf16 v[112:115], v[20:23], v[48:51], v[112:115]
    ds_read_b64_tr_b16 v[64:65], v11 offset:1024
    v_mfma_f32_16x16x32_bf16 v[116:119], v[20:23], v[52:55], v[116:119]
    ds_read_b64_tr_b16 v[66:67], v11 offset:8704
    v_mfma_f32_16x16x32_bf16 v[140:143], v[28:31], v[36:39], v[140:143]
    ds_read_b64_tr_b16 v[60:61], v11 offset:1344
    v_mfma_f32_16x16x32_bf16 v[144:147], v[28:31], v[40:43], v[144:147]
    ds_read_b64_tr_b16 v[62:63], v11 offset:9024
    v_mfma_f32_16x16x32_bf16 v[148:151], v[28:31], v[44:47], v[148:151]
    v_mfma_f32_16x16x32_bf16 v[152:155], v[28:31], v[48:51], v[152:155]
    v_mfma_f32_16x16x32_bf16 v[156:159], v[28:31], v[52:55], v[156:159]
    v_mfma_f32_16x16x32_bf16 v[120:123], v[36:39], v[24:27], v[120:123]
    v_mfma_f32_16x16x32_bf16 v[124:127], v[40:43], v[24:27], v[124:127]
    v_mfma_f32_16x16x32_bf16 v[128:131], v[44:47], v[24:27], v[128:131]
    v_mfma_f32_16x16x32_bf16 v[132:135], v[48:51], v[24:27], v[132:135]
    v_mfma_f32_16x16x32_bf16 v[136:139], v[52:55], v[24:27], v[136:139]
    s_waitcnt lgkmcnt(0)
    s_barrier
    ds_read_b128 v[36:39], v5 offset:16384
    v_mfma_f32_16x16x32_bf16 v[160:163], v[68:71], v[72:75], v[160:163]
    ds_read_b128 v[40:43], v5 offset:18432
    v_mfma_f32_16x16x32_bf16 v[164:167], v[68:71], v[76:79], v[164:167]
    ds_read_b128 v[44:47], v5 offset:20480
    v_mfma_f32_16x16x32_bf16 v[168:171], v[68:71], v[80:83], v[168:171]
    ds_read_b128 v[48:51], v5 offset:22528
    v_mfma_f32_16x16x32_bf16 v[172:175], v[68:71], v[84:87], v[172:175]
    ds_read_b128 v[52:55], v5 offset:24576
    v_mfma_f32_16x16x32_bf16 v[176:179], v[68:71], v[88:91], v[176:179]
    ds_read_b64_tr_b16 v[32:33], v14 offset:26624
    v_mfma_f32_16x16x32_bf16 v[100:103], v[56:59], v[72:75], v[100:103]
    ds_read_b64_tr_b16 v[34:35], v14 offset:34304
    v_mfma_f32_16x16x32_bf16 v[104:107], v[56:59], v[76:79], v[104:107]
    ds_read_b64_tr_b16 v[20:21], v11 offset:26784
    v_mfma_f32_16x16x32_bf16 v[108:111], v[56:59], v[80:83], v[108:111]
    ds_read_b64_tr_b16 v[22:23], v11 offset:34464
    v_mfma_f32_16x16x32_bf16 v[112:115], v[56:59], v[84:87], v[112:115]
    ds_read_b64_tr_b16 v[28:29], v11 offset:26624
    v_mfma_f32_16x16x32_bf16 v[116:119], v[56:59], v[88:91], v[116:119]
    ds_read_b64_tr_b16 v[30:31], v11 offset:34304
    v_mfma_f32_16x16x32_bf16 v[140:143], v[64:67], v[72:75], v[140:143]
    ds_read_b64_tr_b16 v[24:25], v11 offset:26944
    v_mfma_f32_16x16x32_bf16 v[144:147], v[64:67], v[76:79], v[144:147]
    ds_read_b64_tr_b16 v[26:27], v11 offset:34624
    v_mfma_f32_16x16x32_bf16 v[148:151], v[64:67], v[80:83], v[148:151]
    v_mfma_f32_16x16x32_bf16 v[152:155], v[64:67], v[84:87], v[152:155]
    v_mfma_f32_16x16x32_bf16 v[156:159], v[64:67], v[88:91], v[156:159]
    v_mfma_f32_16x16x32_bf16 v[120:123], v[72:75], v[60:63], v[120:123]
    v_mfma_f32_16x16x32_bf16 v[124:127], v[76:79], v[60:63], v[124:127]
    v_mfma_f32_16x16x32_bf16 v[128:131], v[80:83], v[60:63], v[128:131]
    v_mfma_f32_16x16x32_bf16 v[132:135], v[84:87], v[60:63], v[132:135]
    v_mfma_f32_16x16x32_bf16 v[136:139], v[88:91], v[60:63], v[136:139]
    s_waitcnt lgkmcnt(0)
    s_barrier
    ds_read_b128 v[72:75], v8 offset:16384
    v_mfma_f32_16x16x32_bf16 v[160:163], v[32:35], v[36:39], v[160:163]
    ds_read_b128 v[76:79], v8 offset:18432
    v_mfma_f32_16x16x32_bf16 v[164:167], v[32:35], v[40:43], v[164:167]
    ds_read_b128 v[80:83], v8 offset:20480
    v_mfma_f32_16x16x32_bf16 v[168:171], v[32:35], v[44:47], v[168:171]
    ds_read_b128 v[84:87], v8 offset:22528
    v_mfma_f32_16x16x32_bf16 v[172:175], v[32:35], v[48:51], v[172:175]
    ds_read_b128 v[88:91], v8 offset:24576
    v_mfma_f32_16x16x32_bf16 v[176:179], v[32:35], v[52:55], v[176:179]
    ds_read_b64_tr_b16 v[68:69], v14 offset:41984
    v_mfma_f32_16x16x32_bf16 v[100:103], v[20:23], v[36:39], v[100:103]
    ds_read_b64_tr_b16 v[70:71], v14 offset:49664
    v_mfma_f32_16x16x32_bf16 v[104:107], v[20:23], v[40:43], v[104:107]
    ds_read_b64_tr_b16 v[56:57], v11 offset:42144
    v_mfma_f32_16x16x32_bf16 v[108:111], v[20:23], v[44:47], v[108:111]
    ds_read_b64_tr_b16 v[58:59], v11 offset:49824
    v_mfma_f32_16x16x32_bf16 v[112:115], v[20:23], v[48:51], v[112:115]
    ds_read_b64_tr_b16 v[64:65], v11 offset:41984
    v_mfma_f32_16x16x32_bf16 v[116:119], v[20:23], v[52:55], v[116:119]
    ds_read_b64_tr_b16 v[66:67], v11 offset:49664
    v_mfma_f32_16x16x32_bf16 v[140:143], v[28:31], v[36:39], v[140:143]
    ds_read_b64_tr_b16 v[60:61], v11 offset:42304
    v_mfma_f32_16x16x32_bf16 v[144:147], v[28:31], v[40:43], v[144:147]
    ds_read_b64_tr_b16 v[62:63], v11 offset:49984
    v_mfma_f32_16x16x32_bf16 v[148:151], v[28:31], v[44:47], v[148:151]
    v_mfma_f32_16x16x32_bf16 v[152:155], v[28:31], v[48:51], v[152:155]
    v_mfma_f32_16x16x32_bf16 v[156:159], v[28:31], v[52:55], v[156:159]
    v_mfma_f32_16x16x32_bf16 v[120:123], v[36:39], v[24:27], v[120:123]
    v_mfma_f32_16x16x32_bf16 v[124:127], v[40:43], v[24:27], v[124:127]
    v_mfma_f32_16x16x32_bf16 v[128:131], v[44:47], v[24:27], v[128:131]
    v_mfma_f32_16x16x32_bf16 v[132:135], v[48:51], v[24:27], v[132:135]
    v_mfma_f32_16x16x32_bf16 v[136:139], v[52:55], v[24:27], v[136:139]
    s_waitcnt lgkmcnt(0)
    s_barrier
    ds_read_b128 v[36:39], v5 offset:57344
    v_mfma_f32_16x16x32_bf16 v[160:163], v[68:71], v[72:75], v[160:163]
    ds_read_b128 v[40:43], v5 offset:59392
    v_mfma_f32_16x16x32_bf16 v[164:167], v[68:71], v[76:79], v[164:167]
    ds_read_b128 v[44:47], v5 offset:61440
    v_mfma_f32_16x16x32_bf16 v[168:171], v[68:71], v[80:83], v[168:171]
    ds_read_b128 v[48:51], v5 offset:63488
    v_mfma_f32_16x16x32_bf16 v[172:175], v[68:71], v[84:87], v[172:175]
    ds_read_b128 v[52:55], v6 offset:0
    v_mfma_f32_16x16x32_bf16 v[176:179], v[68:71], v[88:91], v[176:179]
    ds_read_b64_tr_b16 v[32:33], v15 offset:2048
    v_mfma_f32_16x16x32_bf16 v[100:103], v[56:59], v[72:75], v[100:103]
    ds_read_b64_tr_b16 v[34:35], v15 offset:9728
    v_mfma_f32_16x16x32_bf16 v[104:107], v[56:59], v[76:79], v[104:107]
    ds_read_b64_tr_b16 v[20:21], v12 offset:2208
    v_mfma_f32_16x16x32_bf16 v[108:111], v[56:59], v[80:83], v[108:111]
    ds_read_b64_tr_b16 v[22:23], v12 offset:9888
    v_mfma_f32_16x16x32_bf16 v[112:115], v[56:59], v[84:87], v[112:115]
    ds_read_b64_tr_b16 v[28:29], v12 offset:2048
    v_mfma_f32_16x16x32_bf16 v[116:119], v[56:59], v[88:91], v[116:119]
    ds_read_b64_tr_b16 v[30:31], v12 offset:9728
    v_mfma_f32_16x16x32_bf16 v[140:143], v[64:67], v[72:75], v[140:143]
    ds_read_b64_tr_b16 v[24:25], v12 offset:2368
    v_mfma_f32_16x16x32_bf16 v[144:147], v[64:67], v[76:79], v[144:147]
    ds_read_b64_tr_b16 v[26:27], v12 offset:10048
    v_mfma_f32_16x16x32_bf16 v[148:151], v[64:67], v[80:83], v[148:151]
    v_mfma_f32_16x16x32_bf16 v[152:155], v[64:67], v[84:87], v[152:155]
    v_mfma_f32_16x16x32_bf16 v[156:159], v[64:67], v[88:91], v[156:159]
    v_mfma_f32_16x16x32_bf16 v[120:123], v[72:75], v[60:63], v[120:123]
    v_mfma_f32_16x16x32_bf16 v[124:127], v[76:79], v[60:63], v[124:127]
    v_mfma_f32_16x16x32_bf16 v[128:131], v[80:83], v[60:63], v[128:131]
    v_mfma_f32_16x16x32_bf16 v[132:135], v[84:87], v[60:63], v[132:135]
    v_mfma_f32_16x16x32_bf16 v[136:139], v[88:91], v[60:63], v[136:139]
    s_waitcnt lgkmcnt(0)
    s_barrier
    ds_read_b128 v[72:75], v8 offset:57344
    v_mfma_f32_16x16x32_bf16 v[160:163], v[32:35], v[36:39], v[160:163]
    ds_read_b128 v[76:79], v8 offset:59392
    v_mfma_f32_16x16x32_bf16 v[164:167], v[32:35], v[40:43], v[164:167]
    ds_read_b128 v[80:83], v8 offset:61440
    v_mfma_f32_16x16x32_bf16 v[168:171], v[32:35], v[44:47], v[168:171]
    ds_read_b128 v[84:87], v8 offset:63488
    v_mfma_f32_16x16x32_bf16 v[172:175], v[32:35], v[48:51], v[172:175]
    ds_read_b128 v[88:91], v9 offset:0
    v_mfma_f32_16x16x32_bf16 v[176:179], v[32:35], v[52:55], v[176:179]
    ds_read_b64_tr_b16 v[68:69], v15 offset:17408
    v_mfma_f32_16x16x32_bf16 v[100:103], v[20:23], v[36:39], v[100:103]
    ds_read_b64_tr_b16 v[70:71], v15 offset:25088
    v_mfma_f32_16x16x32_bf16 v[104:107], v[20:23], v[40:43], v[104:107]
    ds_read_b64_tr_b16 v[56:57], v12 offset:17568
    v_mfma_f32_16x16x32_bf16 v[108:111], v[20:23], v[44:47], v[108:111]
    ds_read_b64_tr_b16 v[58:59], v12 offset:25248
    v_mfma_f32_16x16x32_bf16 v[112:115], v[20:23], v[48:51], v[112:115]
    ds_read_b64_tr_b16 v[64:65], v12 offset:17408
    v_mfma_f32_16x16x32_bf16 v[116:119], v[20:23], v[52:55], v[116:119]
    ds_read_b64_tr_b16 v[66:67], v12 offset:25088
    v_mfma_f32_16x16x32_bf16 v[140:143], v[28:31], v[36:39], v[140:143]
    ds_read_b64_tr_b16 v[60:61], v12 offset:17728
    v_mfma_f32_16x16x32_bf16 v[144:147], v[28:31], v[40:43], v[144:147]
    ds_read_b64_tr_b16 v[62:63], v12 offset:25408
    v_mfma_f32_16x16x32_bf16 v[148:151], v[28:31], v[44:47], v[148:151]
    v_mfma_f32_16x16x32_bf16 v[152:155], v[28:31], v[48:51], v[152:155]
    v_mfma_f32_16x16x32_bf16 v[156:159], v[28:31], v[52:55], v[156:159]
    v_mfma_f32_16x16x32_bf16 v[120:123], v[36:39], v[24:27], v[120:123]
    v_mfma_f32_16x16x32_bf16 v[124:127], v[40:43], v[24:27], v[124:127]
    v_mfma_f32_16x16x32_bf16 v[128:131], v[44:47], v[24:27], v[128:131]
    v_mfma_f32_16x16x32_bf16 v[132:135], v[48:51], v[24:27], v[132:135]
    v_mfma_f32_16x16x32_bf16 v[136:139], v[52:55], v[24:27], v[136:139]
    s_waitcnt lgkmcnt(0)
    s_barrier
    ds_read_b128 v[36:39], v4 offset:0
    v_mfma_f32_16x16x32_bf16 v[160:163], v[68:71], v[72:75], v[160:163]
    ds_read_b128 v[40:43], v4 offset:2048
    v_mfma_f32_16x16x32_bf16 v[164:167], v[68:71], v[76:79], v[164:167]
    ds_read_b128 v[44:47], v4 offset:4096
    v_mfma_f32_16x16x32_bf16 v[168:171], v[68:71], v[80:83], v[168:171]
    ds_read_b128 v[48:51], v4 offset:6144
    v_mfma_f32_16x16x32_bf16 v[172:175], v[68:71], v[84:87], v[172:175]
    ds_read_b128 v[52:55], v4 offset:8192
    v_mfma_f32_16x16x32_bf16 v[176:179], v[68:71], v[88:91], v[176:179]
    ds_read_b64_tr_b16 v[32:33], v13 offset:10240
    v_mfma_f32_16x16x32_bf16 v[100:103], v[56:59], v[72:75], v[100:103]
    ds_read_b64_tr_b16 v[34:35], v13 offset:17920
    v_mfma_f32_16x16x32_bf16 v[104:107], v[56:59], v[76:79], v[104:107]
    ds_read_b64_tr_b16 v[20:21], v10 offset:10400
    v_mfma_f32_16x16x32_bf16 v[108:111], v[56:59], v[80:83], v[108:111]
    ds_read_b64_tr_b16 v[22:23], v10 offset:18080
    v_mfma_f32_16x16x32_bf16 v[112:115], v[56:59], v[84:87], v[112:115]
    ds_read_b64_tr_b16 v[28:29], v10 offset:10240
    v_mfma_f32_16x16x32_bf16 v[116:119], v[56:59], v[88:91], v[116:119]
    ds_read_b64_tr_b16 v[30:31], v10 offset:17920
    v_mfma_f32_16x16x32_bf16 v[140:143], v[64:67], v[72:75], v[140:143]
    ds_read_b64_tr_b16 v[24:25], v10 offset:10560
    v_mfma_f32_16x16x32_bf16 v[144:147], v[64:67], v[76:79], v[144:147]
    ds_read_b64_tr_b16 v[26:27], v10 offset:18240
    v_mfma_f32_16x16x32_bf16 v[148:151], v[64:67], v[80:83], v[148:151]
    v_mfma_f32_16x16x32_bf16 v[152:155], v[64:67], v[84:87], v[152:155]
    v_mfma_f32_16x16x32_bf16 v[156:159], v[64:67], v[88:91], v[156:159]
    v_mfma_f32_16x16x32_bf16 v[120:123], v[72:75], v[60:63], v[120:123]
    v_mfma_f32_16x16x32_bf16 v[124:127], v[76:79], v[60:63], v[124:127]
    v_mfma_f32_16x16x32_bf16 v[128:131], v[80:83], v[60:63], v[128:131]
    v_mfma_f32_16x16x32_bf16 v[132:135], v[84:87], v[60:63], v[132:135]
    v_mfma_f32_16x16x32_bf16 v[136:139], v[88:91], v[60:63], v[136:139]
    s_waitcnt lgkmcnt(0)
    s_barrier
    ds_read_b128 v[72:75], v7 offset:0
    v_mfma_f32_16x16x32_bf16 v[160:163], v[32:35], v[36:39], v[160:163]
    ds_read_b128 v[76:79], v7 offset:2048
    v_mfma_f32_16x16x32_bf16 v[164:167], v[32:35], v[40:43], v[164:167]
    ds_read_b128 v[80:83], v7 offset:4096
    v_mfma_f32_16x16x32_bf16 v[168:171], v[32:35], v[44:47], v[168:171]
    ds_read_b128 v[84:87], v7 offset:6144
    v_mfma_f32_16x16x32_bf16 v[172:175], v[32:35], v[48:51], v[172:175]
    ds_read_b128 v[88:91], v7 offset:8192
    v_mfma_f32_16x16x32_bf16 v[176:179], v[32:35], v[52:55], v[176:179]
    ds_read_b64_tr_b16 v[68:69], v13 offset:25600
    v_mfma_f32_16x16x32_bf16 v[100:103], v[20:23], v[36:39], v[100:103]
    ds_read_b64_tr_b16 v[70:71], v13 offset:33280
    v_mfma_f32_16x16x32_bf16 v[104:107], v[20:23], v[40:43], v[104:107]
    ds_read_b64_tr_b16 v[56:57], v10 offset:25760
    v_mfma_f32_16x16x32_bf16 v[108:111], v[20:23], v[44:47], v[108:111]
    ds_read_b64_tr_b16 v[58:59], v10 offset:33440
    v_mfma_f32_16x16x32_bf16 v[112:115], v[20:23], v[48:51], v[112:115]
    ds_read_b64_tr_b16 v[64:65], v10 offset:25600
    v_mfma_f32_16x16x32_bf16 v[116:119], v[20:23], v[52:55], v[116:119]
    ds_read_b64_tr_b16 v[66:67], v10 offset:33280
    v_mfma_f32_16x16x32_bf16 v[140:143], v[28:31], v[36:39], v[140:143]
    ds_read_b64_tr_b16 v[60:61], v10 offset:25920
    v_mfma_f32_16x16x32_bf16 v[144:147], v[28:31], v[40:43], v[144:147]
    ds_read_b64_tr_b16 v[62:63], v10 offset:33600
    v_mfma_f32_16x16x32_bf16 v[148:151], v[28:31], v[44:47], v[148:151]
    v_mfma_f32_16x16x32_bf16 v[152:155], v[28:31], v[48:51], v[152:155]
    v_mfma_f32_16x16x32_bf16 v[156:159], v[28:31], v[52:55], v[156:159]
    v_mfma_f32_16x16x32_bf16 v[120:123], v[36:39], v[24:27], v[120:123]
    v_mfma_f32_16x16x32_bf16 v[124:127], v[40:43], v[24:27], v[124:127]
    v_mfma_f32_16x16x32_bf16 v[128:131], v[44:47], v[24:27], v[128:131]
    v_mfma_f32_16x16x32_bf16 v[132:135], v[48:51], v[24:27], v[132:135]
    v_mfma_f32_16x16x32_bf16 v[136:139], v[52:55], v[24:27], v[136:139]
    s_waitcnt lgkmcnt(0)
    s_barrier
    ds_read_b128 v[36:39], v4 offset:40960
    v_mfma_f32_16x16x32_bf16 v[160:163], v[68:71], v[72:75], v[160:163]
    ds_read_b128 v[40:43], v4 offset:43008
    v_mfma_f32_16x16x32_bf16 v[164:167], v[68:71], v[76:79], v[164:167]
    ds_read_b128 v[44:47], v4 offset:45056
    v_mfma_f32_16x16x32_bf16 v[168:171], v[68:71], v[80:83], v[168:171]
    ds_read_b128 v[48:51], v4 offset:47104
    v_mfma_f32_16x16x32_bf16 v[172:175], v[68:71], v[84:87], v[172:175]
    ds_read_b128 v[52:55], v4 offset:49152
    v_mfma_f32_16x16x32_bf16 v[176:179], v[68:71], v[88:91], v[176:179]
    ds_read_b64_tr_b16 v[32:33], v13 offset:51200
    v_mfma_f32_16x16x32_bf16 v[100:103], v[56:59], v[72:75], v[100:103]
    ds_read_b64_tr_b16 v[34:35], v13 offset:58880
    v_mfma_f32_16x16x32_bf16 v[104:107], v[56:59], v[76:79], v[104:107]
    ds_read_b64_tr_b16 v[20:21], v10 offset:51360
    v_mfma_f32_16x16x32_bf16 v[108:111], v[56:59], v[80:83], v[108:111]
    ds_read_b64_tr_b16 v[22:23], v10 offset:59040
    v_mfma_f32_16x16x32_bf16 v[112:115], v[56:59], v[84:87], v[112:115]
    ds_read_b64_tr_b16 v[28:29], v10 offset:51200
    v_mfma_f32_16x16x32_bf16 v[116:119], v[56:59], v[88:91], v[116:119]
    ds_read_b64_tr_b16 v[30:31], v10 offset:58880
    v_mfma_f32_16x16x32_bf16 v[140:143], v[64:67], v[72:75], v[140:143]
    ds_read_b64_tr_b16 v[24:25], v10 offset:51520
    v_mfma_f32_16x16x32_bf16 v[144:147], v[64:67], v[76:79], v[144:147]
    ds_read_b64_tr_b16 v[26:27], v10 offset:59200
    v_mfma_f32_16x16x32_bf16 v[148:151], v[64:67], v[80:83], v[148:151]
    v_mfma_f32_16x16x32_bf16 v[152:155], v[64:67], v[84:87], v[152:155]
    v_mfma_f32_16x16x32_bf16 v[156:159], v[64:67], v[88:91], v[156:159]
    v_mfma_f32_16x16x32_bf16 v[120:123], v[72:75], v[60:63], v[120:123]
    v_mfma_f32_16x16x32_bf16 v[124:127], v[76:79], v[60:63], v[124:127]
    v_mfma_f32_16x16x32_bf16 v[128:131], v[80:83], v[60:63], v[128:131]
    v_mfma_f32_16x16x32_bf16 v[132:135], v[84:87], v[60:63], v[132:135]
    v_mfma_f32_16x16x32_bf16 v[136:139], v[88:91], v[60:63], v[136:139]
    s_waitcnt lgkmcnt(0)
    s_barrier
    s_mov_b64 exec, 0xffff
    buffer_load_dword v96, v97, s[52:55], s89 offen
    s_mov_b64 exec, 0xff
    buffer_load_dword v96, v97, s[52:55], s90 offen
    s_mov_b64 exec, -1
    ds_read_b128 v[72:75], v7 offset:40960
    v_mfma_f32_16x16x32_bf16 v[160:163], v[32:35], v[36:39], v[160:163]
    ds_read_b128 v[76:79], v7 offset:43008
    v_mfma_f32_16x16x32_bf16 v[164:167], v[32:35], v[40:43], v[164:167]
    ds_read_b128 v[80:83], v7 offset:45056
    v_mfma_f32_16x16x32_bf16 v[168:171], v[32:35], v[44:47], v[168:171]
    ds_read_b128 v[84:87], v7 offset:47104
    v_mfma_f32_16x16x32_bf16 v[172:175], v[32:35], v[48:51], v[172:175]
    ds_read_b128 v[88:91], v7 offset:49152
    v_mfma_f32_16x16x32_bf16 v[176:179], v[32:35], v[52:55], v[176:179]
    ds_read_b64_tr_b16 v[68:69], v14 offset:1024
    v_mfma_f32_16x16x32_bf16 v[100:103], v[20:23], v[36:39], v[100:103]
    ds_read_b64_tr_b16 v[70:71], v14 offset:8704
    v_mfma_f32_16x16x32_bf16 v[104:107], v[20:23], v[40:43], v[104:107]
    ds_read_b64_tr_b16 v[56:57], v11 offset:1184
    v_mfma_f32_16x16x32_bf16 v[108:111], v[20:23], v[44:47], v[108:111]
    ds_read_b64_tr_b16 v[58:59], v11 offset:8864
    v_mfma_f32_16x16x32_bf16 v[112:115], v[20:23], v[48:51], v[112:115]
    ds_read_b64_tr_b16 v[64:65], v11 offset:1024
    v_mfma_f32_16x16x32_bf16 v[116:119], v[20:23], v[52:55], v[116:119]
    ds_read_b64_tr_b16 v[66:67], v11 offset:8704
    v_mfma_f32_16x16x32_bf16 v[140:143], v[28:31], v[36:39], v[140:143]
    ds_read_b64_tr_b16 v[60:61], v11 offset:1344
    v_mfma_f32_16x16x32_bf16 v[144:147], v[28:31], v[40:43], v[144:147]
    ds_read_b64_tr_b16 v[62:63], v11 offset:9024
    v_mfma_f32_16x16x32_bf16 v[148:151], v[28:31], v[44:47], v[148:151]
    v_mfma_f32_16x16x32_bf16 v[152:155], v[28:31], v[48:51], v[152:155]
    v_mfma_f32_16x16x32_bf16 v[156:159], v[28:31], v[52:55], v[156:159]
    v_mfma_f32_16x16x32_bf16 v[120:123], v[36:39], v[24:27], v[120:123]
    v_mfma_f32_16x16x32_bf16 v[124:127], v[40:43], v[24:27], v[124:127]
    v_mfma_f32_16x16x32_bf16 v[128:131], v[44:47], v[24:27], v[128:131]
    v_mfma_f32_16x16x32_bf16 v[132:135], v[48:51], v[24:27], v[132:135]
    v_mfma_f32_16x16x32_bf16 v[136:139], v[52:55], v[24:27], v[136:139]
    s_waitcnt lgkmcnt(0)
    s_barrier
    v_lshlrev_b32 v204, 5, v1
    buffer_load_dword v205, v204, s[48:51], 0 offen sc1
    ds_read_b128 v[36:39], v5 offset:16384
    v_mfma_f32_16x16x32_bf16 v[160:163], v[68:71], v[72:75], v[160:163]
    ds_read_b128 v[40:43], v5 offset:18432
    v_mfma_f32_16x16x32_bf16 v[164:167], v[68:71], v[76:79], v[164:167]
    ds_read_b128 v[44:47], v5 offset:20480
    v_mfma_f32_16x16x32_bf16 v[168:171], v[68:71], v[80:83], v[168:171]
    ds_read_b128 v[48:51], v5 offset:22528
    v_mfma_f32_16x16x32_bf16 v[172:175], v[68:71], v[84:87], v[172:175]
    ds_read_b128 v[52:55], v5 offset:24576
    v_mfma_f32_16x16x32_bf16 v[176:179], v[68:71], v[88:91], v[176:179]
    ds_read_b64_tr_b16 v[32:33], v14 offset:26624
    v_mfma_f32_16x16x32_bf16 v[100:103], v[56:59], v[72:75], v[100:103]
    ds_read_b64_tr_b16 v[34:35], v14 offset:34304
    v_mfma_f32_16x16x32_bf16 v[104:107], v[56:59], v[76:79], v[104:107]
    ds_read_b64_tr_b16 v[20:21], v11 offset:26784
    v_mfma_f32_16x16x32_bf16 v[108:111], v[56:59], v[80:83], v[108:111]
    ds_read_b64_tr_b16 v[22:23], v11 offset:34464
    v_mfma_f32_16x16x32_bf16 v[112:115], v[56:59], v[84:87], v[112:115]
    ds_read_b64_tr_b16 v[28:29], v11 offset:26624
    v_mfma_f32_16x16x32_bf16 v[116:119], v[56:59], v[88:91], v[116:119]
    ds_read_b64_tr_b16 v[30:31], v11 offset:34304
    v_mfma_f32_16x16x32_bf16 v[140:143], v[64:67], v[72:75], v[140:143]
    ds_read_b64_tr_b16 v[24:25], v11 offset:26944
    v_mfma_f32_16x16x32_bf16 v[144:147], v[64:67], v[76:79], v[144:147]
    ds_read_b64_tr_b16 v[26:27], v11 offset:34624
    v_mfma_f32_16x16x32_bf16 v[148:151], v[64:67], v[80:83], v[148:151]
    v_mfma_f32_16x16x32_bf16 v[152:155], v[64:67], v[84:87], v[152:155]
    v_mfma_f32_16x16x32_bf16 v[156:159], v[64:67], v[88:91], v[156:159]
    v_mfma_f32_16x16x32_bf16 v[120:123], v[72:75], v[60:63], v[120:123]
    v_mfma_f32_16x16x32_bf16 v[124:127], v[76:79], v[60:63], v[124:127]
    v_mfma_f32_16x16x32_bf16 v[128:131], v[80:83], v[60:63], v[128:131]
    v_mfma_f32_16x16x32_bf16 v[132:135], v[84:87], v[60:63], v[132:135]
    v_mfma_f32_16x16x32_bf16 v[136:139], v[88:91], v[60:63], v[136:139]
    s_waitcnt lgkmcnt(0)
    s_barrier
    ds_read_b128 v[72:75], v8 offset:16384
    v_mfma_f32_16x16x32_bf16 v[160:163], v[32:35], v[36:39], v[160:163]
    ds_read_b128 v[76:79], v8 offset:18432
    v_mfma_f32_16x16x32_bf16 v[164:167], v[32:35], v[40:43], v[164:167]
    ds_read_b128 v[80:83], v8 offset:20480
    v_mfma_f32_16x16x32_bf16 v[168:171], v[32:35], v[44:47], v[168:171]
    ds_read_b128 v[84:87], v8 offset:22528
    v_mfma_f32_16x16x32_bf16 v[172:175], v[32:35], v[48:51], v[172:175]
    ds_read_b128 v[88:91], v8 offset:24576
    v_mfma_f32_16x16x32_bf16 v[176:179], v[32:35], v[52:55], v[176:179]
    ds_read_b64_tr_b16 v[68:69], v14 offset:41984
    v_mfma_f32_16x16x32_bf16 v[100:103], v[20:23], v[36:39], v[100:103]
    ds_read_b64_tr_b16 v[70:71], v14 offset:49664
    v_mfma_f32_16x16x32_bf16 v[104:107], v[20:23], v[40:43], v[104:107]
    ds_read_b64_tr_b16 v[56:57], v11 offset:42144
    v_mfma_f32_16x16x32_bf16 v[108:111], v[20:23], v[44:47], v[108:111]
    ds_read_b64_tr_b16 v[58:59], v11 offset:49824
    v_mfma_f32_16x16x32_bf16 v[112:115], v[20:23], v[48:51], v[112:115]
    ds_read_b64_tr_b16 v[64:65], v11 offset:41984
    v_mfma_f32_16x16x32_bf16 v[116:119], v[20:23], v[52:55], v[116:119]
    ds_read_b64_tr_b16 v[66:67], v11 offset:49664
    v_mfma_f32_16x16x32_bf16 v[140:143], v[28:31], v[36:39], v[140:143]
    ds_read_b64_tr_b16 v[60:61], v11 offset:42304
    v_mfma_f32_16x16x32_bf16 v[144:147], v[28:31], v[40:43], v[144:147]
    ds_read_b64_tr_b16 v[62:63], v11 offset:49984
    v_mfma_f32_16x16x32_bf16 v[148:151], v[28:31], v[44:47], v[148:151]
    v_mfma_f32_16x16x32_bf16 v[152:155], v[28:31], v[48:51], v[152:155]
    v_mfma_f32_16x16x32_bf16 v[156:159], v[28:31], v[52:55], v[156:159]
    v_mfma_f32_16x16x32_bf16 v[120:123], v[36:39], v[24:27], v[120:123]
    v_mfma_f32_16x16x32_bf16 v[124:127], v[40:43], v[24:27], v[124:127]
    v_mfma_f32_16x16x32_bf16 v[128:131], v[44:47], v[24:27], v[128:131]
    v_mfma_f32_16x16x32_bf16 v[132:135], v[48:51], v[24:27], v[132:135]
    v_mfma_f32_16x16x32_bf16 v[136:139], v[52:55], v[24:27], v[136:139]
    s_waitcnt lgkmcnt(0)
    s_barrier
    ds_read_b128 v[36:39], v5 offset:57344
    v_mfma_f32_16x16x32_bf16 v[160:163], v[68:71], v[72:75], v[160:163]
    ds_read_b128 v[40:43], v5 offset:59392
    v_mfma_f32_16x16x32_bf16 v[164:167], v[68:71], v[76:79], v[164:167]
    ds_read_b128 v[44:47], v5 offset:61440
    v_mfma_f32_16x16x32_bf16 v[168:171], v[68:71], v[80:83], v[168:171]
    ds_read_b128 v[48:51], v5 offset:63488
    v_mfma_f32_16x16x32_bf16 v[172:175], v[68:71], v[84:87], v[172:175]
    ds_read_b128 v[52:55], v6 offset:0
    v_mfma_f32_16x16x32_bf16 v[176:179], v[68:71], v[88:91], v[176:179]
    ds_read_b64_tr_b16 v[32:33], v15 offset:2048
    v_mfma_f32_16x16x32_bf16 v[100:103], v[56:59], v[72:75], v[100:103]
    ds_read_b64_tr_b16 v[34:35], v15 offset:9728
    v_mfma_f32_16x16x32_bf16 v[104:107], v[56:59], v[76:79], v[104:107]
    ds_read_b64_tr_b16 v[20:21], v12 offset:2208
    v_mfma_f32_16x16x32_bf16 v[108:111], v[56:59], v[80:83], v[108:111]
    ds_read_b64_tr_b16 v[22:23], v12 offset:9888
    v_mfma_f32_16x16x32_bf16 v[112:115], v[56:59], v[84:87], v[112:115]
    ds_read_b64_tr_b16 v[28:29], v12 offset:2048
    v_mfma_f32_16x16x32_bf16 v[116:119], v[56:59], v[88:91], v[116:119]
    ds_read_b64_tr_b16 v[30:31], v12 offset:9728
    v_mfma_f32_16x16x32_bf16 v[140:143], v[64:67], v[72:75], v[140:143]
    ds_read_b64_tr_b16 v[24:25], v12 offset:2368
    v_mfma_f32_16x16x32_bf16 v[144:147], v[64:67], v[76:79], v[144:147]
    ds_read_b64_tr_b16 v[26:27], v12 offset:10048
    v_mfma_f32_16x16x32_bf16 v[148:151], v[64:67], v[80:83], v[148:151]
    v_mfma_f32_16x16x32_bf16 v[152:155], v[64:67], v[84:87], v[152:155]
    v_mfma_f32_16x16x32_bf16 v[156:159], v[64:67], v[88:91], v[156:159]
    v_mfma_f32_16x16x32_bf16 v[120:123], v[72:75], v[60:63], v[120:123]
    v_mfma_f32_16x16x32_bf16 v[124:127], v[76:79], v[60:63], v[124:127]
    v_mfma_f32_16x16x32_bf16 v[128:131], v[80:83], v[60:63], v[128:131]
    v_mfma_f32_16x16x32_bf16 v[132:135], v[84:87], v[60:63], v[132:135]
    v_mfma_f32_16x16x32_bf16 v[136:139], v[88:91], v[60:63], v[136:139]
    s_waitcnt lgkmcnt(0)
    s_barrier
    ds_read_b128 v[72:75], v8 offset:57344
    v_mfma_f32_16x16x32_bf16 v[160:163], v[32:35], v[36:39], v[160:163]
    ds_read_b128 v[76:79], v8 offset:59392
    v_mfma_f32_16x16x32_bf16 v[164:167], v[32:35], v[40:43], v[164:167]
    ds_read_b128 v[80:83], v8 offset:61440
    v_mfma_f32_16x16x32_bf16 v[168:171], v[32:35], v[44:47], v[168:171]
    ds_read_b128 v[84:87], v8 offset:63488
    v_mfma_f32_16x16x32_bf16 v[172:175], v[32:35], v[48:51], v[172:175]
    ds_read_b128 v[88:91], v9 offset:0
    v_mfma_f32_16x16x32_bf16 v[176:179], v[32:35], v[52:55], v[176:179]
    ds_read_b64_tr_b16 v[68:69], v15 offset:17408
    v_mfma_f32_16x16x32_bf16 v[100:103], v[20:23], v[36:39], v[100:103]
    ds_read_b64_tr_b16 v[70:71], v15 offset:25088
    v_mfma_f32_16x16x32_bf16 v[104:107], v[20:23], v[40:43], v[104:107]
    ds_read_b64_tr_b16 v[56:57], v12 offset:17568
    v_mfma_f32_16x16x32_bf16 v[108:111], v[20:23], v[44:47], v[108:111]
    ds_read_b64_tr_b16 v[58:59], v12 offset:25248
    v_mfma_f32_16x16x32_bf16 v[112:115], v[20:23], v[48:51], v[112:115]
    ds_read_b64_tr_b16 v[64:65], v12 offset:17408
    v_mfma_f32_16x16x32_bf16 v[116:119], v[20:23], v[52:55], v[116:119]
    ds_read_b64_tr_b16 v[66:67], v12 offset:25088
    v_mfma_f32_16x16x32_bf16 v[140:143], v[28:31], v[36:39], v[140:143]
    ds_read_b64_tr_b16 v[60:61], v12 offset:17728
    v_mfma_f32_16x16x32_bf16 v[144:147], v[28:31], v[40:43], v[144:147]
    ds_read_b64_tr_b16 v[62:63], v12 offset:25408
    v_mfma_f32_16x16x32_bf16 v[148:151], v[28:31], v[44:47], v[148:151]
    v_mfma_f32_16x16x32_bf16 v[152:155], v[28:31], v[48:51], v[152:155]
    v_mfma_f32_16x16x32_bf16 v[156:159], v[28:31], v[52:55], v[156:159]
    v_mfma_f32_16x16x32_bf16 v[120:123], v[36:39], v[24:27], v[120:123]
    v_mfma_f32_16x16x32_bf16 v[124:127], v[40:43], v[24:27], v[124:127]
    v_mfma_f32_16x16x32_bf16 v[128:131], v[44:47], v[24:27], v[128:131]
    v_mfma_f32_16x16x32_bf16 v[132:135], v[48:51], v[24:27], v[132:135]
    v_mfma_f32_16x16x32_bf16 v[136:139], v[52:55], v[24:27], v[136:139]
    s_waitcnt lgkmcnt(0)
    s_barrier
    ds_read_b128 v[36:39], v4 offset:0
    v_mfma_f32_16x16x32_bf16 v[160:163], v[68:71], v[72:75], v[160:163]
    ds_read_b128 v[40:43], v4 offset:2048
    v_mfma_f32_16x16x32_bf16 v[164:167], v[68:71], v[76:79], v[164:167]
    ds_read_b128 v[44:47], v4 offset:4096
    v_mfma_f32_16x16x32_bf16 v[168:171], v[68:71], v[80:83], v[168:171]
    ds_read_b128 v[48:51], v4 offset:6144
    v_mfma_f32_16x16x32_bf16 v[172:175], v[68:71], v[84:87], v[172:175]
    ds_read_b128 v[52:55], v4 offset:8192
    v_mfma_f32_16x16x32_bf16 v[176:179], v[68:71], v[88:91], v[176:179]
    ds_read_b64_tr_b16 v[32:33], v13 offset:10240
    v_mfma_f32_16x16x32_bf16 v[100:103], v[56:59], v[72:75], v[100:103]
    ds_read_b64_tr_b16 v[34:35], v13 offset:17920
    v_mfma_f32_16x16x32_bf16 v[104:107], v[56:59], v[76:79], v[104:107]
    ds_read_b64_tr_b16 v[20:21], v10 offset:10400
    v_mfma_f32_16x16x32_bf16 v[108:111], v[56:59], v[80:83], v[108:111]
    ds_read_b64_tr_b16 v[22:23], v10 offset:18080
    v_mfma_f32_16x16x32_bf16 v[112:115], v[56:59], v[84:87], v[112:115]
    ds_read_b64_tr_b16 v[28:29], v10 offset:10240
    v_mfma_f32_16x16x32_bf16 v[116:119], v[56:59], v[88:91], v[116:119]
    ds_read_b64_tr_b16 v[30:31], v10 offset:17920
    v_mfma_f32_16x16x32_bf16 v[140:143], v[64:67], v[72:75], v[140:143]
    ds_read_b64_tr_b16 v[24:25], v10 offset:10560
    v_mfma_f32_16x16x32_bf16 v[144:147], v[64:67], v[76:79], v[144:147]
    ds_read_b64_tr_b16 v[26:27], v10 offset:18240
    v_mfma_f32_16x16x32_bf16 v[148:151], v[64:67], v[80:83], v[148:151]
    v_mfma_f32_16x16x32_bf16 v[152:155], v[64:67], v[84:87], v[152:155]
    v_mfma_f32_16x16x32_bf16 v[156:159], v[64:67], v[88:91], v[156:159]
    v_mfma_f32_16x16x32_bf16 v[120:123], v[72:75], v[60:63], v[120:123]
    v_mfma_f32_16x16x32_bf16 v[124:127], v[76:79], v[60:63], v[124:127]
    v_mfma_f32_16x16x32_bf16 v[128:131], v[80:83], v[60:63], v[128:131]
    v_mfma_f32_16x16x32_bf16 v[132:135], v[84:87], v[60:63], v[132:135]
    v_mfma_f32_16x16x32_bf16 v[136:139], v[88:91], v[60:63], v[136:139]
    s_mov_b64 exec, 255
    s_mov_b32 s60, 0x100000
    s_mov_b32 s61, 0x10000000
cpl_24:
    s_waitcnt vmcnt(0)
    v_cmp_gt_u32 vcc, s61, v205
    s_cbranch_vccz cp_23
    buffer_load_dword v205, v204, s[48:51], 0 offen sc1
    s_sub_u32 s60, s60, 1
    s_cbranch_scc0 cpl_24
cp_23:
    s_mov_b64 exec, -1
    s_waitcnt vmcnt(0)
    v_readlane_b32 s3, v205, s56
    s_lshl_b32 s88, s88, 5
    s_cmp_eq_u32 s3, s88
    s_cselect_b64 s[86:87], -1, 0
    s_waitcnt lgkmcnt(0)
    s_barrier
    ds_read_b128 v[72:75], v7 offset:0
    v_mfma_f32_16x16x32_bf16 v[160:163], v[32:35], v[36:39], v[160:163]
    ds_read_b128 v[76:79], v7 offset:2048
    v_mfma_f32_16x16x32_bf16 v[164:167], v[32:35], v[40:43], v[164:167]
    ds_read_b128 v[80:83], v7 offset:4096
    v_mfma_f32_16x16x32_bf16 v[168:171], v[32:35], v[44:47], v[168:171]
    ds_read_b128 v[84:87], v7 offset:6144
    v_mfma_f32_16x16x32_bf16 v[172:175], v[32:35], v[48:51], v[172:175]
    ds_read_b128 v[88:91], v7 offset:8192
    v_mfma_f32_16x16x32_bf16 v[176:179], v[32:35], v[52:55], v[176:179]
    ds_read_b64_tr_b16 v[68:69], v13 offset:25600
    v_mfma_f32_16x16x32_bf16 v[100:103], v[20:23], v[36:39], v[100:103]
    ds_read_b64_tr_b16 v[70:71], v13 offset:33280
    v_mfma_f32_16x16x32_bf16 v[104:107], v[20:23], v[40:43], v[104:107]
    ds_read_b64_tr_b16 v[56:57], v10 offset:25760
    v_mfma_f32_16x16x32_bf16 v[108:111], v[20:23], v[44:47], v[108:111]
    ds_read_b64_tr_b16 v[58:59], v10 offset:33440
    v_mfma_f32_16x16x32_bf16 v[112:115], v[20:23], v[48:51], v[112:115]
    ds_read_b64_tr_b16 v[64:65], v10 offset:25600
    v_mfma_f32_16x16x32_bf16 v[116:119], v[20:23], v[52:55], v[116:119]
    ds_read_b64_tr_b16 v[66:67], v10 offset:33280
    v_mfma_f32_16x16x32_bf16 v[140:143], v[28:31], v[36:39], v[140:143]
    ds_read_b64_tr_b16 v[60:61], v10 offset:25920
    v_mfma_f32_16x16x32_bf16 v[144:147], v[28:31], v[40:43], v[144:147]
    ds_read_b64_tr_b16 v[62:63], v10 offset:33600
    v_mfma_f32_16x16x32_bf16 v[148:151], v[28:31], v[44:47], v[148:151]
    v_mfma_f32_16x16x32_bf16 v[152:155], v[28:31], v[48:51], v[152:155]
    v_mfma_f32_16x16x32_bf16 v[156:159], v[28:31], v[52:55], v[156:159]
    v_mfma_f32_16x16x32_bf16 v[120:123], v[36:39], v[24:27], v[120:123]
    v_mfma_f32_16x16x32_bf16 v[124:127], v[40:43], v[24:27], v[124:127]
    v_mfma_f32_16x16x32_bf16 v[128:131], v[44:47], v[24:27], v[128:131]
    v_mfma_f32_16x16x32_bf16 v[132:135], v[48:51], v[24:27], v[132:135]
    v_mfma_f32_16x16x32_bf16 v[136:139], v[52:55], v[24:27], v[136:139]
    s_waitcnt lgkmcnt(0)
    s_barrier
    ds_read_b128 v[36:39], v4 offset:40960
    v_mfma_f32_16x16x32_bf16 v[160:163], v[68:71], v[72:75], v[160:163]
    ds_read_b128 v[40:43], v4 offset:43008
    v_mfma_f32_16x16x32_bf16 v[164:167], v[68:71], v[76:79], v[164:167]
    ds_read_b128 v[44:47], v4 offset:45056
    v_mfma_f32_16x16x32_bf16 v[168:171], v[68:71], v[80:83], v[168:171]
    ds_read_b128 v[48:51], v4 offset:47104
    v_mfma_f32_16x16x32_bf16 v[172:175], v[68:71], v[84:87], v[172:175]
    ds_read_b128 v[52:55], v4 offset:49152
    v_mfma_f32_16x16x32_bf16 v[176:179], v[68:71], v[88:91], v[176:179]
    ds_read_b64_tr_b16 v[32:33], v13 offset:51200
    v_mfma_f32_16x16x32_bf16 v[100:103], v[56:59], v[72:75], v[100:103]
    ds_read_b64_tr_b16 v[34:35], v13 offset:58880
    v_mfma_f32_16x16x32_bf16 v[104:107], v[56:59], v[76:79], v[104:107]
    ds_read_b64_tr_b16 v[20:21], v10 offset:51360
    v_mfma_f32_16x16x32_bf16 v[108:111], v[56:59], v[80:83], v[108:111]
    ds_read_b64_tr_b16 v[22:23], v10 offset:59040
    v_mfma_f32_16x16x32_bf16 v[112:115], v[56:59], v[84:87], v[112:115]
    ds_read_b64_tr_b16 v[28:29], v10 offset:51200
    v_mfma_f32_16x16x32_bf16 v[116:119], v[56:59], v[88:91], v[116:119]
    ds_read_b64_tr_b16 v[30:31], v10 offset:58880
    v_mfma_f32_16x16x32_bf16 v[140:143], v[64:67], v[72:75], v[140:143]
    ds_read_b64_tr_b16 v[24:25], v10 offset:51520
    v_mfma_f32_16x16x32_bf16 v[144:147], v[64:67], v[76:79], v[144:147]
    ds_read_b64_tr_b16 v[26:27], v10 offset:59200
    v_mfma_f32_16x16x32_bf16 v[148:151], v[64:67], v[80:83], v[148:151]
    v_mfma_f32_16x16x32_bf16 v[152:155], v[64:67], v[84:87], v[152:155]
    v_mfma_f32_16x16x32_bf16 v[156:159], v[64:67], v[88:91], v[156:159]
    v_mfma_f32_16x16x32_bf16 v[120:123], v[72:75], v[60:63], v[120:123]
    v_mfma_f32_16x16x32_bf16 v[124:127], v[76:79], v[60:63], v[124:127]
    v_mfma_f32_16x16x32_bf16 v[128:131], v[80:83], v[60:63], v[128:131]
    v_mfma_f32_16x16x32_bf16 v[132:135], v[84:87], v[60:63], v[132:135]
    v_mfma_f32_16x16x32_bf16 v[136:139], v[88:91], v[60:63], v[136:139]
    s_waitcnt lgkmcnt(0)
    s_barrier
    s_mul_i32 s66, s57, 26
    s_lshr_b32 s66, s66, 8
    s_mul_i32 s3, s66, 10
    s_sub_u32 s67, s57, s3
    s_lshl_b32 s68, s56, 8
    s_mul_i32 s63, s66, 88
    s_add_u32 s68, s68, s63
    s_cmp_eq_u32 s66, 2
    s_cselect_b32 s69, 0, 8
    s_add_u32 s69, s69, 80
    v_and_b32 v200, 15, v1
    v_lshlrev_b32 v201, 3, v200
    v_cmp_gt_u32 vcc, s69, v201
    v_lshlrev_b32 v200, 7, v200
    v_lshrrev_b32 v201, 4, v1
    v_lshl_add_u32 v200, v201, 12, v200
    s_lshl_b32 s61, s67, 2
    s_add_u32 s61, s61, s23
    s_lshl_b32 s61, s61, 13
    s_lshl_b32 s3, s63, 4
    s_add_u32 s61, s61, s3
    s_add_u32 s61, s61, 917504
    s_cmp_lt_u32 s57, 30
    s_cselect_b32 s61, s61, 2147483648
    v_add_u32 v200, s61, v200
    s_mov_b32 exec_lo, vcc_lo
    s_mov_b32 exec_hi, 0
    buffer_load_dword v96, v200, s[52:55], 0 offen
    s_mov_b64 exec, -1
    ds_read_b128 v[72:75], v7 offset:40960
    v_mfma_f32_16x16x32_bf16 v[160:163], v[32:35], v[36:39], v[160:163]
    ds_read_b128 v[76:79], v7 offset:43008
    v_mfma_f32_16x16x32_bf16 v[164:167], v[32:35], v[40:43], v[164:167]
    ds_read_b128 v[80:83], v7 offset:45056
    v_mfma_f32_16x16x32_bf16 v[168:171], v[32:35], v[44:47], v[168:171]
    ds_read_b128 v[84:87], v7 offset:47104
    v_mfma_f32_16x16x32_bf16 v[172:175], v[32:35], v[48:51], v[172:175]
    ds_read_b128 v[88:91], v7 offset:49152
    v_mfma_f32_16x16x32_bf16 v[176:179], v[32:35], v[52:55], v[176:179]
    ds_read_b64_tr_b16 v[68:69], v14 offset:1024
    v_mfma_f32_16x16x32_bf16 v[100:103], v[20:23], v[36:39], v[100:103]
    ds_read_b64_tr_b16 v[70:71], v14 offset:8704
    v_mfma_f32_16x16x32_bf16 v[104:107], v[20:23], v[40:43], v[104:107]
    ds_read_b64_tr_b16 v[56:57], v11 offset:1184
    v_mfma_f32_16x16x32_bf16 v[108:111], v[20:23], v[44:47], v[108:111]
    ds_read_b64_tr_b16 v[58:59], v11 offset:8864
    v_mfma_f32_16x16x32_bf16 v[112:115], v[20:23], v[48:51], v[112:115]
    ds_read_b64_tr_b16 v[64:65], v11 offset:1024
    v_mfma_f32_16x16x32_bf16 v[116:119], v[20:23], v[52:55], v[116:119]
    ds_read_b64_tr_b16 v[66:67], v11 offset:8704
    v_mfma_f32_16x16x32_bf16 v[140:143], v[28:31], v[36:39], v[140:143]
    ds_read_b64_tr_b16 v[60:61], v11 offset:1344
    v_mfma_f32_16x16x32_bf16 v[144:147], v[28:31], v[40:43], v[144:147]
    ds_read_b64_tr_b16 v[62:63], v11 offset:9024
    v_mfma_f32_16x16x32_bf16 v[148:151], v[28:31], v[44:47], v[148:151]
    v_mfma_f32_16x16x32_bf16 v[152:155], v[28:31], v[48:51], v[152:155]
    v_mfma_f32_16x16x32_bf16 v[156:159], v[28:31], v[52:55], v[156:159]
    v_mfma_f32_16x16x32_bf16 v[120:123], v[36:39], v[24:27], v[120:123]
    v_mfma_f32_16x16x32_bf16 v[124:127], v[40:43], v[24:27], v[124:127]
    v_mfma_f32_16x16x32_bf16 v[128:131], v[44:47], v[24:27], v[128:131]
    v_mfma_f32_16x16x32_bf16 v[132:135], v[48:51], v[24:27], v[132:135]
    v_mfma_f32_16x16x32_bf16 v[136:139], v[52:55], v[24:27], v[136:139]
    s_waitcnt lgkmcnt(0)
    s_barrier
    ds_read2_b32 v[20:21], v99 offset0:0 offset1:80
    v_mfma_f32_16x16x32_bf16 v[160:163], v[68:71], v[72:75], v[160:163]
    ds_read2_b32 v[22:23], v99 offset0:16 offset1:96
    v_mfma_f32_16x16x32_bf16 v[164:167], v[68:71], v[76:79], v[164:167]
    ds_read2_b32 v[24:25], v99 offset0:32 offset1:112
    v_mfma_f32_16x16x32_bf16 v[168:171], v[68:71], v[80:83], v[168:171]
    ds_read2_b32 v[26:27], v99 offset0:48 offset1:128
    v_mfma_f32_16x16x32_bf16 v[172:175], v[68:71], v[84:87], v[172:175]
    ds_read2_b32 v[28:29], v99 offset0:64 offset1:144
    v_mfma_f32_16x16x32_bf16 v[176:179], v[68:71], v[88:91], v[176:179]
    ds_read_b128 v[180:183], v252 offset:0
    v_mfma_f32_16x16x32_bf16 v[100:103], v[56:59], v[72:75], v[100:103]
    ds_read_b128 v[184:187], v252 offset:320
    v_mfma_f32_16x16x32_bf16 v[104:107], v[56:59], v[76:79], v[104:107]
    ds_read_b128 v[188:191], v252 offset:64
    v_mfma_f32_16x16x32_bf16 v[108:111], v[56:59], v[80:83], v[108:111]
    ds_read_b128 v[192:195], v252 offset:384
    v_mfma_f32_16x16x32_bf16 v[112:115], v[56:59], v[84:87], v[112:115]
    ds_read_b128 v[196:199], v252 offset:128
    v_mfma_f32_16x16x32_bf16 v[116:119], v[56:59], v[88:91], v[116:119]
    ds_read_b128 v[200:203], v252 offset:448
    v_mfma_f32_16x16x32_bf16 v[140:143], v[64:67], v[72:75], v[140:143]
    ds_read_b128 v[204:207], v252 offset:192
    v_mfma_f32_16x16x32_bf16 v[144:147], v[64:67], v[76:79], v[144:147]
    ds_read_b128 v[208:211], v252 offset:512
    v_mfma_f32_16x16x32_bf16 v[148:151], v[64:67], v[80:83], v[148:151]
    ds_read_b128 v[212:215], v252 offset:256
    v_mfma_f32_16x16x32_bf16 v[152:155], v[64:67], v[84:87], v[152:155]
    ds_read_b128 v[216:219], v252 offset:576
    v_mfma_f32_16x16x32_bf16 v[156:159], v[64:67], v[88:91], v[156:159]
    s_waitcnt lgkmcnt(10)
    v_mfma_f32_16x16x32_bf16 v[120:123], v[72:75], v[60:63], v[120:123]
    v_mov_b32_dpp v44, v160 row_newbcast:0 row_mask:0xf bank_mask:0xf
    v_mov_b32_dpp v45, v161 row_newbcast:0 row_mask:0xf bank_mask:0xf
    v_mov_b32_dpp v46, v162 row_newbcast:0 row_mask:0xf bank_mask:0xf
    v_mfma_f32_16x16x32_bf16 v[124:127], v[76:79], v[60:63], v[124:127]
    v_mov_b32_dpp v47, v163 row_newbcast:0 row_mask:0xf bank_mask:0xf
    v_pk_fma_f32 v[160:161], v[44:45], v[20:21], v[160:161] op_sel:[0,1,0] op_sel_hi:[1,1,1] neg_lo:[0,1,0] neg_hi:[0,1,0]
    v_pk_fma_f32 v[162:163], v[46:47], v[20:21], v[162:163] op_sel:[0,1,0] op_sel_hi:[1,1,1] neg_lo:[0,1,0] neg_hi:[0,1,0]
    v_mfma_f32_16x16x32_bf16 v[128:131], v[80:83], v[60:63], v[128:131]
    v_pk_fma_f32 v[164:165], v[44:45], v[22:23], v[164:165] op_sel:[0,1,0] op_sel_hi:[1,1,1] neg_lo:[0,1,0] neg_hi:[0,1,0]
    v_pk_fma_f32 v[166:167], v[46:47], v[22:23], v[166:167] op_sel:[0,1,0] op_sel_hi:[1,1,1] neg_lo:[0,1,0] neg_hi:[0,1,0]
    v_pk_fma_f32 v[168:169], v[44:45], v[24:25], v[168:169] op_sel:[0,1,0] op_sel_hi:[1,1,1] neg_lo:[0,1,0] neg_hi:[0,1,0]
    v_mfma_f32_16x16x32_bf16 v[132:135], v[84:87], v[60:63], v[132:135]
    v_pk_fma_f32 v[170:171], v[46:47], v[24:25], v[170:171] op_sel:[0,1,0] op_sel_hi:[1,1,1] neg_lo:[0,1,0] neg_hi:[0,1,0]
    v_pk_fma_f32 v[172:173], v[44:45], v[26:27], v[172:173] op_sel:[0,1,0] op_sel_hi:[1,1,1] neg_lo:[0,1,0] neg_hi:[0,1,0]
    v_pk_fma_f32 v[174:175], v[46:47], v[26:27], v[174:175] op_sel:[0,1,0] op_sel_hi:[1,1,1] neg_lo:[0,1,0] neg_hi:[0,1,0]
    v_mfma_f32_16x16x32_bf16 v[136:139], v[88:91], v[60:63], v[136:139]
    v_pk_fma_f32 v[176:177], v[44:45], v[28:29], v[176:177] op_sel:[0,1,0] op_sel_hi:[1,1,1] neg_lo:[0,1,0] neg_hi:[0,1,0]
    v_pk_fma_f32 v[178:179], v[46:47], v[28:29], v[178:179] op_sel:[0,1,0] op_sel_hi:[1,1,1] neg_lo:[0,1,0] neg_hi:[0,1,0]
    v_pk_mul_f32 v[160:161], v[160:161], v[20:21] op_sel_hi:[1,0]
    v_pk_mul_f32 v[162:163], v[162:163], v[20:21] op_sel_hi:[1,0]
    v_pk_mul_f32 v[164:165], v[164:165], v[22:23] op_sel_hi:[1,0]
    v_pk_mul_f32 v[166:167], v[166:167], v[22:23] op_sel_hi:[1,0]
    v_pk_mul_f32 v[168:169], v[168:169], v[24:25] op_sel_hi:[1,0]
    v_pk_mul_f32 v[170:171], v[170:171], v[24:25] op_sel_hi:[1,0]
    v_pk_mul_f32 v[172:173], v[172:173], v[26:27] op_sel_hi:[1,0]
    v_pk_mul_f32 v[174:175], v[174:175], v[26:27] op_sel_hi:[1,0]
    v_pk_mul_f32 v[176:177], v[176:177], v[28:29] op_sel_hi:[1,0]
    v_pk_mul_f32 v[178:179], v[178:179], v[28:29] op_sel_hi:[1,0]
    s_mov_b32 exec_hi, 0xffff
    v_cvt_pk_bf16_f32 v222, v160, v161
    v_cvt_pk_bf16_f32 v223, v162, v163
    v_cvt_pk_bf16_f32 v226, v164, v165
    v_cvt_pk_bf16_f32 v227, v166, v167
    v_cvt_pk_bf16_f32 v230, v168, v169
    v_cvt_pk_bf16_f32 v231, v170, v171
    v_cvt_pk_bf16_f32 v234, v172, v173
    v_cvt_pk_bf16_f32 v235, v174, v175
    v_cvt_pk_bf16_f32 v238, v176, v177
    v_cvt_pk_bf16_f32 v239, v178, v179
    s_mov_b32 exec_hi, -1
    ds_write_b64 v16, v[222:223] offset:0
    ds_write_b64 v16, v[226:227] offset:512
    ds_write_b64 v16, v[230:231] offset:1024
    ds_write_b64 v16, v[234:235] offset:1536
    ds_write_b64 v16, v[238:239] offset:2048
    v_mov_b32_dpp v32, v100 row_newbcast:0 row_mask:0xf bank_mask:0xf
    v_mov_b32_dpp v33, v101 row_newbcast:0 row_mask:0xf bank_mask:0xf
    v_mov_b32_dpp v34, v102 row_newbcast:0 row_mask:0xf bank_mask:0xf
    v_mov_b32_dpp v35, v103 row_newbcast:0 row_mask:0xf bank_mask:0xf
    v_pk_fma_f32 v[100:101], v[32:33], v[20:21], v[100:101] op_sel:[0,1,0] op_sel_hi:[1,1,1] neg_lo:[0,1,0] neg_hi:[0,1,0]
    v_pk_fma_f32 v[102:103], v[34:35], v[20:21], v[102:103] op_sel:[0,1,0] op_sel_hi:[1,1,1] neg_lo:[0,1,0] neg_hi:[0,1,0]
    v_pk_fma_f32 v[104:105], v[32:33], v[22:23], v[104:105] op_sel:[0,1,0] op_sel_hi:[1,1,1] neg_lo:[0,1,0] neg_hi:[0,1,0]
    v_pk_fma_f32 v[106:107], v[34:35], v[22:23], v[106:107] op_sel:[0,1,0] op_sel_hi:[1,1,1] neg_lo:[0,1,0] neg_hi:[0,1,0]
    v_pk_fma_f32 v[108:109], v[32:33], v[24:25], v[108:109] op_sel:[0,1,0] op_sel_hi:[1,1,1] neg_lo:[0,1,0] neg_hi:[0,1,0]
    v_pk_fma_f32 v[110:111], v[34:35], v[24:25], v[110:111] op_sel:[0,1,0] op_sel_hi:[1,1,1] neg_lo:[0,1,0] neg_hi:[0,1,0]
    v_pk_fma_f32 v[112:113], v[32:33], v[26:27], v[112:113] op_sel:[0,1,0] op_sel_hi:[1,1,1] neg_lo:[0,1,0] neg_hi:[0,1,0]
    v_pk_fma_f32 v[114:115], v[34:35], v[26:27], v[114:115] op_sel:[0,1,0] op_sel_hi:[1,1,1] neg_lo:[0,1,0] neg_hi:[0,1,0]
    v_pk_fma_f32 v[116:117], v[32:33], v[28:29], v[116:117] op_sel:[0,1,0] op_sel_hi:[1,1,1] neg_lo:[0,1,0] neg_hi:[0,1,0]
    v_pk_fma_f32 v[118:119], v[34:35], v[28:29], v[118:119] op_sel:[0,1,0] op_sel_hi:[1,1,1] neg_lo:[0,1,0] neg_hi:[0,1,0]
    v_pk_mul_f32 v[100:101], v[100:101], v[20:21] op_sel_hi:[1,0]
    v_pk_mul_f32 v[102:103], v[102:103], v[20:21] op_sel_hi:[1,0]
    v_pk_mul_f32 v[104:105], v[104:105], v[22:23] op_sel_hi:[1,0]
    v_pk_mul_f32 v[106:107], v[106:107], v[22:23] op_sel_hi:[1,0]
    v_pk_mul_f32 v[108:109], v[108:109], v[24:25] op_sel_hi:[1,0]
    v_pk_mul_f32 v[110:111], v[110:111], v[24:25] op_sel_hi:[1,0]
    v_pk_mul_f32 v[112:113], v[112:113], v[26:27] op_sel_hi:[1,0]
    v_pk_mul_f32 v[114:115], v[114:115], v[26:27] op_sel_hi:[1,0]
    v_pk_mul_f32 v[116:117], v[116:117], v[28:29] op_sel_hi:[1,0]
    v_pk_mul_f32 v[118:119], v[118:119], v[28:29] op_sel_hi:[1,0]
    ds_read_b64 v[58:59], v17 offset:512
    ds_read_b64 v[62:63], v17 offset:1024
    ds_read_b64 v[66:67], v17 offset:1536
    ds_read_b64 v[70:71], v17 offset:2048
    ds_read_b64_tr_b16 v[82:83], v18 offset:0
    ds_read_b64_tr_b16 v[84:85], v18 offset:512
    ds_read_b64_tr_b16 v[86:87], v18 offset:1024
    ds_read_b64_tr_b16 v[88:89], v18 offset:1536
    ds_read_b64_tr_b16 v[90:91], v18 offset:2048
    v_cvt_pk_bf16_f32 v220, v100, v101
    v_cvt_pk_bf16_f32 v221, v102, v103
    v_cvt_pk_bf16_f32 v224, v104, v105
    v_cvt_pk_bf16_f32 v225, v106, v107
    v_cvt_pk_bf16_f32 v228, v108, v109
    v_cvt_pk_bf16_f32 v229, v110, v111
    v_cvt_pk_bf16_f32 v232, v112, v113
    v_cvt_pk_bf16_f32 v233, v114, v115
    v_cvt_pk_bf16_f32 v236, v116, v117
    v_cvt_pk_bf16_f32 v237, v118, v119
    v_mov_b32_dpp v40, v140 row_newbcast:0 row_mask:0xf bank_mask:0xf
    v_mov_b32_dpp v41, v141 row_newbcast:0 row_mask:0xf bank_mask:0xf
    v_mov_b32_dpp v42, v142 row_newbcast:0 row_mask:0xf bank_mask:0xf
    v_mov_b32_dpp v43, v143 row_newbcast:0 row_mask:0xf bank_mask:0xf
    v_pk_fma_f32 v[144:145], v[40:41], v[22:23], v[144:145] op_sel:[0,1,0] op_sel_hi:[1,1,1] neg_lo:[0,1,0] neg_hi:[0,1,0]
    v_pk_fma_f32 v[146:147], v[42:43], v[22:23], v[146:147] op_sel:[0,1,0] op_sel_hi:[1,1,1] neg_lo:[0,1,0] neg_hi:[0,1,0]
    v_pk_fma_f32 v[148:149], v[40:41], v[24:25], v[148:149] op_sel:[0,1,0] op_sel_hi:[1,1,1] neg_lo:[0,1,0] neg_hi:[0,1,0]
    v_pk_fma_f32 v[150:151], v[42:43], v[24:25], v[150:151] op_sel:[0,1,0] op_sel_hi:[1,1,1] neg_lo:[0,1,0] neg_hi:[0,1,0]
    v_pk_fma_f32 v[152:153], v[40:41], v[26:27], v[152:153] op_sel:[0,1,0] op_sel_hi:[1,1,1] neg_lo:[0,1,0] neg_hi:[0,1,0]
    v_pk_fma_f32 v[154:155], v[42:43], v[26:27], v[154:155] op_sel:[0,1,0] op_sel_hi:[1,1,1] neg_lo:[0,1,0] neg_hi:[0,1,0]
    v_pk_fma_f32 v[156:157], v[40:41], v[28:29], v[156:157] op_sel:[0,1,0] op_sel_hi:[1,1,1] neg_lo:[0,1,0] neg_hi:[0,1,0]
    v_pk_fma_f32 v[158:159], v[42:43], v[28:29], v[158:159] op_sel:[0,1,0] op_sel_hi:[1,1,1] neg_lo:[0,1,0] neg_hi:[0,1,0]
    v_pk_mul_f32 v[144:145], v[144:145], v[22:23] op_sel_hi:[1,0]
    v_pk_mul_f32 v[146:147], v[146:147], v[22:23] op_sel_hi:[1,0]
    v_pk_mul_f32 v[148:149], v[148:149], v[24:25] op_sel_hi:[1,0]
    v_pk_mul_f32 v[150:151], v[150:151], v[24:25] op_sel_hi:[1,0]
    v_pk_mul_f32 v[152:153], v[152:153], v[26:27] op_sel_hi:[1,0]
    v_pk_mul_f32 v[154:155], v[154:155], v[26:27] op_sel_hi:[1,0]
    v_pk_mul_f32 v[156:157], v[156:157], v[28:29] op_sel_hi:[1,0]
    v_pk_mul_f32 v[158:159], v[158:159], v[28:29] op_sel_hi:[1,0]
    v_cvt_pk_bf16_f32 v56, v144, v145
    v_cvt_pk_bf16_f32 v57, v146, v147
    v_cvt_pk_bf16_f32 v60, v148, v149
    v_cvt_pk_bf16_f32 v61, v150, v151
    v_cvt_pk_bf16_f32 v64, v152, v153
    v_cvt_pk_bf16_f32 v65, v154, v155
    v_cvt_pk_bf16_f32 v68, v156, v157
    v_cvt_pk_bf16_f32 v69, v158, v159
    v_mov_b32 v36, v120
    v_mov_b32 v37, v120
    s_waitcnt lgkmcnt(0)
    v_mfma_f32_16x16x32_bf16 v[100:103], v[224:227], v[56:59], v[240:243]
    v_permlane16_swap_b32 v36, v37
    v_mov_b32 v52, 0x3f803f80
    v_mov_b32 v37, v36
    v_mfma_f32_16x16x32_bf16 v[160:163], v[220:223], v[56:59], v[248:251]
    v_mov_b32 v53, 0x3f803f80
    v_mov_b32 v54, 0x3f803f80
    v_permlane32_swap_b32 v36, v37
    v_mfma_f32_16x16x32_bf16 v[104:107], v[228:231], v[60:63], v[240:243]
    v_mov_b32 v55, 0x3f803f80
    v_pk_fma_f32 v[120:121], v[36:37], v[184:185], v[120:121] op_sel_hi:[0,1,1] neg_lo:[0,1,0] neg_hi:[0,1,0]
    v_pk_fma_f32 v[122:123], v[36:37], v[186:187], v[122:123] op_sel_hi:[0,1,1] neg_lo:[0,1,0] neg_hi:[0,1,0]
    v_mfma_f32_16x16x32_bf16 v[164:167], v[224:227], v[60:63], v[244:247]
    v_pk_fma_f32 v[124:125], v[36:37], v[192:193], v[124:125] op_sel_hi:[0,1,1] neg_lo:[0,1,0] neg_hi:[0,1,0]
    v_pk_fma_f32 v[126:127], v[36:37], v[194:195], v[126:127] op_sel_hi:[0,1,1] neg_lo:[0,1,0] neg_hi:[0,1,0]
    v_pk_fma_f32 v[128:129], v[36:37], v[200:201], v[128:129] op_sel_hi:[0,1,1] neg_lo:[0,1,0] neg_hi:[0,1,0]
    v_mfma_f32_16x16x32_bf16 v[108:111], v[232:235], v[64:67], v[240:243]
    v_pk_fma_f32 v[130:131], v[36:37], v[202:203], v[130:131] op_sel_hi:[0,1,1] neg_lo:[0,1,0] neg_hi:[0,1,0]
    v_pk_fma_f32 v[132:133], v[36:37], v[208:209], v[132:133] op_sel_hi:[0,1,1] neg_lo:[0,1,0] neg_hi:[0,1,0]
    v_pk_fma_f32 v[134:135], v[36:37], v[210:211], v[134:135] op_sel_hi:[0,1,1] neg_lo:[0,1,0] neg_hi:[0,1,0]
    v_mfma_f32_16x16x32_bf16 v[168:171], v[228:231], v[64:67], v[244:247]
    v_pk_fma_f32 v[136:137], v[36:37], v[216:217], v[136:137] op_sel_hi:[0,1,1] neg_lo:[0,1,0] neg_hi:[0,1,0]
    v_pk_fma_f32 v[138:139], v[36:37], v[218:219], v[138:139] op_sel_hi:[0,1,1] neg_lo:[0,1,0] neg_hi:[0,1,0]
    v_pk_mul_f32 v[120:121], v[120:121], v[180:181]
    v_mfma_f32_16x16x32_bf16 v[112:115], v[236:239], v[68:71], v[240:243]
    v_pk_mul_f32 v[122:123], v[122:123], v[182:183]
    v_pk_mul_f32 v[124:125], v[124:125], v[188:189]
    v_pk_mul_f32 v[126:127], v[126:127], v[190:191]
    v_mfma_f32_16x16x32_bf16 v[172:175], v[232:235], v[68:71], v[244:247]
    v_pk_mul_f32 v[128:129], v[128:129], v[196:197]
    v_pk_mul_f32 v[130:131], v[130:131], v[198:199]
    v_pk_mul_f32 v[132:133], v[132:133], v[204:205]
    v_pk_mul_f32 v[134:135], v[134:135], v[206:207]
    v_pk_mul_f32 v[136:137], v[136:137], v[212:213]
    v_pk_mul_f32 v[138:139], v[138:139], v[214:215]
    v_max3_f32 v20, v100, v101, v160
    v_max_f32 v20, v20, v161
    v_max3_f32 v21, v102, v103, v162
    v_max_f32 v21, v21, v163
    v_max3_f32 v22, v104, v105, v164
    v_max_f32 v22, v22, v165
    v_max3_f32 v23, v106, v107, v166
    v_max_f32 v23, v23, v167
    v_max3_f32 v24, v108, v109, v168
    v_max_f32 v24, v24, v169
    v_max3_f32 v25, v110, v111, v170
    v_max_f32 v25, v25, v171
    v_max3_f32 v26, v112, v113, v172
    v_max_f32 v26, v26, v173
    v_max3_f32 v27, v114, v115, v174
    v_max_f32 v27, v27, v175
    v_max_f32 v28, v20, v21
    v_max_f32 v29, v22, v23
    v_max_f32 v30, v24, v25
    v_max_f32 v31, v26, v27
    s_mov_b32 s3, 0.3225964182229561
    v_cvt_pk_bf16_f32 v72, v120, v121
    v_cvt_pk_bf16_f32 v73, v122, v123
    v_permlane32_swap_b32 v28, v29
    v_permlane32_swap_b32 v30, v31
    v_max_f32 v28, v28, v29
    v_max_f32 v30, v30, v31
    v_cvt_pk_bf16_f32 v74, v124, v125
    v_cvt_pk_bf16_f32 v75, v126, v127
    v_permlane16_swap_b32 v28, v30
    v_max_f32 v28, v28, v30
    v_mul_f32 v28, s3, v28
    v_mov_b32 v30, v28
    v_cvt_pk_bf16_f32 v76, v128, v129
    v_cvt_pk_bf16_f32 v77, v130, v131
    v_permlane16_swap_b32 v28, v30
    v_mov_b32 v29, v28
    v_mov_b32 v31, v30
    v_cvt_pk_bf16_f32 v78, v132, v133
    v_cvt_pk_bf16_f32 v79, v134, v135
    v_permlane32_swap_b32 v28, v29
    v_permlane32_swap_b32 v30, v31
    v_cvt_pk_bf16_f32 v80, v136, v137
    v_cvt_pk_bf16_f32 v81, v138, v139
    v_fma_f32 v20, v20, s3, -v28
    v_fma_f32 v21, v21, s3, -v28
    v_fma_f32 v22, v22, s3, -v29
    v_fma_f32 v23, v23, s3, -v29
    v_fma_f32 v24, v24, s3, -v30
    v_fma_f32 v25, v25, s3, -v30
    v_fma_f32 v26, v26, s3, -v31
    v_fma_f32 v27, v27, s3, -v31
    v_exp_f32 v20, v20
    v_exp_f32 v21, v21
    v_exp_f32 v22, v22
    v_exp_f32 v23, v23
    v_exp_f32 v24, v24
    v_exp_f32 v25, v25
    v_exp_f32 v26, v26
    v_exp_f32 v27, v27
    s_mov_b64 vcc, s[86:87]
    v_cvt_pk_bf16_f32 v20, v20, v20
    v_cvt_pk_bf16_f32 v21, v21, v21
    v_and_b32 v32, v20, v92
    v_and_b32 v33, v21, v93
    v_and_b32 v34, v20, v94
    v_and_b32 v35, v21, v95
    v_cvt_pk_bf16_f32 v22, v22, v22
    v_cvt_pk_bf16_f32 v23, v23, v23
    v_and_b32 v36, v22, v92
    v_and_b32 v37, v23, v93
    v_and_b32 v38, v22, v94
    v_and_b32 v39, v23, v95
    v_mfma_f32_16x16x32_bf16 v[108:111], v[52:55], v[32:35], 0
    v_mfma_f32_16x16x32_bf16 v[100:103], v[72:75], v[32:35], 0
    v_mfma_f32_16x16x32_bf16 v[104:107], v[82:85], v[32:35], 0
    v_cvt_pk_bf16_f32 v24, v24, v24
    v_cvt_pk_bf16_f32 v25, v25, v25
    v_and_b32 v40, v24, v92
    v_and_b32 v41, v25, v93
    v_and_b32 v42, v24, v94
    v_and_b32 v43, v25, v95
    v_mfma_f32_16x16x32_bf16 v[120:123], v[52:55], v[36:39], 0
    v_mfma_f32_16x16x32_bf16 v[112:115], v[74:77], v[36:39], 0
    v_mfma_f32_16x16x32_bf16 v[116:119], v[84:87], v[36:39], 0
    v_cvt_pk_bf16_f32 v26, v26, v26
    v_cvt_pk_bf16_f32 v27, v27, v27
    v_and_b32 v44, v26, v92
    v_and_b32 v45, v27, v93
    v_and_b32 v46, v26, v94
    v_and_b32 v47, v27, v95
    v_mfma_f32_16x16x32_bf16 v[132:135], v[52:55], v[40:43], 0
    v_mfma_f32_16x16x32_bf16 v[124:127], v[76:79], v[40:43], 0
    v_mfma_f32_16x16x32_bf16 v[128:131], v[86:89], v[40:43], 0
    v_rcp_f32 v108, v108
    s_nop 0
    v_pk_mul_f32 v[100:101], v[100:101], v[108:109] op_sel_hi:[1,0]
    v_pk_mul_f32 v[102:103], v[102:103], v[108:109] op_sel_hi:[1,0]
    v_pk_mul_f32 v[104:105], v[104:105], v[108:109] op_sel_hi:[1,0]
    v_pk_mul_f32 v[106:107], v[106:107], v[108:109] op_sel_hi:[1,0]
    v_cvt_pk_bf16_f32 v100, v100, v101
    v_cvt_pk_bf16_f32 v101, v102, v103
    s_cbranch_vccz slow_25
    buffer_store_dwordx2 v[100:101], v19, s[52:55], s89 offen offset:0
back_26:
    v_cvt_pk_bf16_f32 v150, v104, v105
    v_cvt_pk_bf16_f32 v151, v106, v107
    v_mfma_f32_16x16x32_bf16 v[144:147], v[52:55], v[44:47], 0
    v_mfma_f32_16x16x32_bf16 v[136:139], v[78:81], v[44:47], 0
    v_mfma_f32_16x16x32_bf16 v[140:143], v[88:91], v[44:47], 0
    v_rcp_f32 v120, v120
    s_nop 0
    v_pk_mul_f32 v[112:113], v[112:113], v[120:121] op_sel_hi:[1,0]
    v_pk_mul_f32 v[114:115], v[114:115], v[120:121] op_sel_hi:[1,0]
    v_pk_mul_f32 v[116:117], v[116:117], v[120:121] op_sel_hi:[1,0]
    v_pk_mul_f32 v[118:119], v[118:119], v[120:121] op_sel_hi:[1,0]
    v_cvt_pk_bf16_f32 v112, v112, v113
    v_cvt_pk_bf16_f32 v113, v114, v115
    s_cbranch_vccz slow_27
    buffer_store_dwordx2 v[112:113], v19, s[52:55], s89 offen offset:256
back_28:
    s_mov_b32 exec_lo, 0xffff0000
    v_cvt_pk_bf16_f32 v150, v116, v117
    v_cvt_pk_bf16_f32 v151, v118, v119
    s_mov_b64 exec, -1
    v_rcp_f32 v132, v132
    s_nop 0
    v_pk_mul_f32 v[124:125], v[124:125], v[132:133] op_sel_hi:[1,0]
    v_pk_mul_f32 v[126:127], v[126:127], v[132:133] op_sel_hi:[1,0]
    v_pk_mul_f32 v[128:129], v[128:129], v[132:133] op_sel_hi:[1,0]
    v_pk_mul_f32 v[130:131], v[130:131], v[132:133] op_sel_hi:[1,0]
    v_cvt_pk_bf16_f32 v124, v124, v125
    v_cvt_pk_bf16_f32 v125, v126, v127
    s_cbranch_vccz slow_29
    buffer_store_dwordx2 v[124:125], v19, s[52:55], s89 offen offset:512
back_30:
    s_mov_b32 exec_lo, 0
    v_cvt_pk_bf16_f32 v150, v128, v129
    v_cvt_pk_bf16_f32 v151, v130, v131
    s_mov_b64 exec, -1
    v_rcp_f32 v144, v144
    s_nop 0
    v_pk_mul_f32 v[136:137], v[136:137], v[144:145] op_sel_hi:[1,0]
    v_pk_mul_f32 v[138:139], v[138:139], v[144:145] op_sel_hi:[1,0]
    v_pk_mul_f32 v[140:141], v[140:141], v[144:145] op_sel_hi:[1,0]
    v_pk_mul_f32 v[142:143], v[142:143], v[144:145] op_sel_hi:[1,0]
    v_cvt_pk_bf16_f32 v136, v136, v137
    v_cvt_pk_bf16_f32 v137, v138, v139
    s_cbranch_vccz slow_31
    buffer_store_dwordx2 v[136:137], v19, s[52:55], s89 offen offset:768
back_32:
    s_mov_b32 exec_lo, 0
    s_mov_b32 exec_hi, 0xffff0000
    v_cvt_pk_bf16_f32 v150, v140, v141
    v_cvt_pk_bf16_f32 v151, v142, v143
    s_mov_b64 exec, -1
    s_cbranch_vccz slow_33
    buffer_store_dwordx2 v[150:151], v98, s[52:55], s90 offen
back_34:
    s_mul_i32 s61, s57, 64
    s_lshl_b32 s3, s23, 2
    s_add_u32 s61, s61, s3
    s_add_u32 s61, s61, 1638400
    v_mov_b32 v3, 1
    s_waitcnt vmcnt(0)
    s_mov_b64 exec, 1
    s_cbranch_vccz slow_35
    buffer_store_dword v3, off, s[52:55], s61
back_36:
    s_mov_b64 exec, -1
    s_cmp_ge_u32 s57, 30
    s_cbranch_scc1 Lcsum
    s_mul_i32 s66, s57, 26
    s_lshr_b32 s66, s66, 8
    s_mul_i32 s3, s66, 10
    s_sub_u32 s67, s57, s3
    s_lshl_b32 s68, s56, 8
    s_mul_i32 s63, s66, 88
    s_add_u32 s68, s68, s63
    s_cmp_eq_u32 s66, 2
    s_cselect_b32 s69, 0, 8
    s_add_u32 s69, s69, 80
    s_lshr_b32 s70, s23, 1
    s_and_b32 s71, s23, 1
    v_lshrrev_b32 v11, 3, v1
    v_and_b32 v11, 3, v11
    s_lshl_b32 s3, s71, 1
    v_xor_b32 v11, s3, v11
    v_lshrrev_b32 v2, 2, v1
    v_lshlrev_b32 v2, 7, v2
    v_and_b32 v3, 3, v1
    v_lshl_add_u32 v2, v3, 3, v2
    v_xor_b32 v3, 1, v11
    v_lshl_add_u32 v5, v3, 5, v2
    v_lshl_add_u32 v2, v11, 5, v2
    v_add_u32 v3, 0x10000, v2
    v_add_u32 v4, 0x20000, v2
    v_add_u32 v6, 0x10000, v5
    v_add_u32 v7, 0x20000, v5
    v_lshrrev_b32 v8, 4, v1
    v_mul_u32_u24 v8, 1536, v8
    v_and_b32 v11, 15, v1
    v_lshl_add_u32 v8, v11, 4, v8
    s_mul_i32 s3, s70, 768
    v_add_u32 v8, s3, v8
    v_add_u32 v9, 0x10000, v8
    v_add_u32 v10, 0x20000, v8
    v_and_b32 v12, 15, v1
    s_mul_i32 s3, s70, 48
    v_add_u32 v12, s3, v12
    v_lshrrev_b32 v13, 4, v1
    v_and_b32 v14, 1, v13
    v_lshlrev_b32 v14, 1, v14
    v_lshrrev_b32 v11, 1, v13
    v_add_u32 v14, v14, v11
    s_lshl_b32 s3, s71, 2
    v_add_u32 v14, s3, v14
    v_add_u32 v11, 0, v12
    v_cmp_gt_u32 vcc, s69, v11
    v_add_u32 v11, s68, v11
    v_mul_u32_u24 v11, 1280, v11
    v_lshl_add_u32 v11, v14, 4, v11
    s_lshl_b32 s3, s67, 7
    v_add_u32 v11, s3, v11
    v_mov_b32 v16, 2147483648
    v_cndmask_b32 v16, v16, v11, vcc
    v_add_u32 v11, 16, v12
    v_cmp_gt_u32 vcc, s69, v11
    v_add_u32 v11, s68, v11
    v_mul_u32_u24 v11, 1280, v11
    v_lshl_add_u32 v11, v14, 4, v11
    s_lshl_b32 s3, s67, 7
    v_add_u32 v11, s3, v11
    v_mov_b32 v17, 2147483648
    v_cndmask_b32 v17, v17, v11, vcc
    v_add_u32 v11, 32, v12
    v_cmp_gt_u32 vcc, s69, v11
    v_add_u32 v11, s68, v11
    v_mul_u32_u24 v11, 1280, v11
    v_lshl_add_u32 v11, v14, 4, v11
    s_lshl_b32 s3, s67, 7
    v_add_u32 v11, s3, v11
    v_mov_b32 v18, 2147483648
    v_cndmask_b32 v18, v18, v11, vcc
    buffer_load_dwordx4 v[220:223], v16, s[24:27], 0 offen
    buffer_load_dwordx4 v[224:227], v17, s[24:27], 0 offen
    buffer_load_dwordx4 v[228:231], v18, s[24:27], 0 offen
    s_lshl_b32 s3, s67, 3
    v_add_u32 v16, s3, v14
    v_mul_u32_u24 v16, 4096, v16
    v_add_u32 v11, 0, v12
    v_cmp_gt_u32 vcc, s69, v11
    v_add_u32 v11, s63, v11
    v_lshl_add_u32 v11, v11, 4, v16
    v_mov_b32 v16, 2147483648
    v_cndmask_b32 v16, v16, v11, vcc
    s_lshl_b32 s3, s67, 3
    v_add_u32 v17, s3, v14
    v_mul_u32_u24 v17, 4096, v17
    v_add_u32 v11, 16, v12
    v_cmp_gt_u32 vcc, s69, v11
    v_add_u32 v11, s63, v11
    v_lshl_add_u32 v11, v11, 4, v17
    v_mov_b32 v17, 2147483648
    v_cndmask_b32 v17, v17, v11, vcc
    s_lshl_b32 s3, s67, 3
    v_add_u32 v18, s3, v14
    v_mul_u32_u24 v18, 4096, v18
    v_add_u32 v11, 32, v12
    v_cmp_gt_u32 vcc, s69, v11
    v_add_u32 v11, s63, v11
    v_lshl_add_u32 v11, v11, 4, v18
    v_mov_b32 v18, 2147483648
    v_cndmask_b32 v18, v18, v11, vcc
    v_and_b32 v232, 1, v13
    v_lshl_add_u32 v232, v232, 4, v12
    v_add_u32 v233, 32, v12
    v_lshrrev_b32 v11, 1, v13
    v_lshlrev_b32 v11, 2, v11
    v_mov_b32 v15, 2147483648
    v_cmp_gt_u32 vcc, s69, v232
    v_add_u32 v232, s63, v232
    v_lshl_add_u32 v232, v232, 3, v11
    v_cndmask_b32 v232, v15, v232, vcc
    v_cmp_gt_u32 vcc, s69, v233
    v_add_u32 v233, s63, v233
    v_lshl_add_u32 v233, v233, 3, v11
    v_cndmask_b32 v233, v15, v233, vcc
    s_lshl_b32 s60, s67, 1
    s_add_u32 s60, s60, s71
    s_lshl_b32 s60, s60, 11
    s_add_u32 s60, s60, 1245184
    s_waitcnt vmcnt(0)
    v_lshlrev_b32 v100, 16, v220
    v_and_b32 v101, 0xffff0000, v220
    v_lshlrev_b32 v102, 16, v221
    v_and_b32 v103, 0xffff0000, v221
    v_lshlrev_b32 v104, 16, v222
    v_and_b32 v105, 0xffff0000, v222
    v_lshlrev_b32 v106, 16, v223
    v_and_b32 v107, 0xffff0000, v223
    v_permlane16_swap_b32 v100, v104
    v_permlane16_swap_b32 v101, v105
    v_permlane16_swap_b32 v102, v106
    v_permlane16_swap_b32 v103, v107
    v_lshlrev_b32 v108, 16, v224
    v_and_b32 v109, 0xffff0000, v224
    v_lshlrev_b32 v110, 16, v225
    v_and_b32 v111, 0xffff0000, v225
    v_lshlrev_b32 v112, 16, v226
    v_and_b32 v113, 0xffff0000, v226
    v_lshlrev_b32 v114, 16, v227
    v_and_b32 v115, 0xffff0000, v227
    v_permlane16_swap_b32 v108, v112
    v_permlane16_swap_b32 v109, v113
    v_permlane16_swap_b32 v110, v114
    v_permlane16_swap_b32 v111, v115
    v_lshlrev_b32 v116, 16, v228
    v_and_b32 v117, 0xffff0000, v228
    v_lshlrev_b32 v118, 16, v229
    v_and_b32 v119, 0xffff0000, v229
    v_lshlrev_b32 v120, 16, v230
    v_and_b32 v121, 0xffff0000, v230
    v_lshlrev_b32 v122, 16, v231
    v_and_b32 v123, 0xffff0000, v231
    v_permlane16_swap_b32 v116, v120
    v_permlane16_swap_b32 v117, v121
    v_permlane16_swap_b32 v118, v122
    v_permlane16_swap_b32 v119, v123
    s_barrier
    ds_read_b64_tr_b16 v[20:21], v3 offset:16384
    ds_read_b128 v[28:31], v8 offset:12288
    ds_read_b64_tr_b16 v[22:23], v3 offset:18432
    ds_read_b128 v[32:35], v8 offset:12544
    ds_read_b64_tr_b16 v[24:25], v6 offset:16384
    ds_read_b64_tr_b16 v[26:27], v6 offset:18432
    ds_read_b128 v[36:39], v8 offset:12800
    ds_read_b64_tr_b16 v[40:41], v3 offset:20480
    ds_read_b128 v[48:51], v8 offset:18432
    ds_read_b64_tr_b16 v[42:43], v3 offset:22528
    ds_read_b128 v[52:55], v8 offset:18688
    ds_read_b64_tr_b16 v[44:45], v6 offset:20480
    ds_read_b64_tr_b16 v[46:47], v6 offset:22528
    ds_read_b128 v[56:59], v8 offset:18944
    s_barrier
    s_waitcnt lgkmcnt(7)
    v_mfma_f32_16x16x32_bf16 v[100:103], v[20:23], v[28:31], v[100:103]
    ds_read_b64_tr_b16 v[60:61], v3 offset:24576
    v_mfma_f32_16x16x32_bf16 v[108:111], v[20:23], v[32:35], v[108:111]
    ds_read_b128 v[68:71], v8 offset:24576
    v_mfma_f32_16x16x32_bf16 v[116:119], v[20:23], v[36:39], v[116:119]
    ds_read_b64_tr_b16 v[62:63], v3 offset:26624
    v_mfma_f32_16x16x32_bf16 v[104:107], v[24:27], v[28:31], v[104:107]
    ds_read_b128 v[72:75], v8 offset:24832
    v_mfma_f32_16x16x32_bf16 v[112:115], v[24:27], v[32:35], v[112:115]
    ds_read_b64_tr_b16 v[64:65], v6 offset:24576
    v_mfma_f32_16x16x32_bf16 v[120:123], v[24:27], v[36:39], v[120:123]
    ds_read_b64_tr_b16 v[66:67], v6 offset:26624
    ds_read_b128 v[76:79], v8 offset:25088
    s_waitcnt lgkmcnt(7)
    v_mfma_f32_16x16x32_bf16 v[100:103], v[40:43], v[48:51], v[100:103]
    ds_read_b64_tr_b16 v[80:81], v3 offset:28672
    v_mfma_f32_16x16x32_bf16 v[108:111], v[40:43], v[52:55], v[108:111]
    ds_read_b128 v[88:91], v8 offset:30720
    v_mfma_f32_16x16x32_bf16 v[116:119], v[40:43], v[56:59], v[116:119]
    ds_read_b64_tr_b16 v[82:83], v3 offset:30720
    v_mfma_f32_16x16x32_bf16 v[104:107], v[44:47], v[48:51], v[104:107]
    ds_read_b128 v[92:95], v8 offset:30976
    v_mfma_f32_16x16x32_bf16 v[112:115], v[44:47], v[52:55], v[112:115]
    ds_read_b64_tr_b16 v[84:85], v6 offset:28672
    v_mfma_f32_16x16x32_bf16 v[120:123], v[44:47], v[56:59], v[120:123]
    ds_read_b64_tr_b16 v[86:87], v6 offset:30720
    ds_read_b128 v[96:99], v8 offset:31232
    s_barrier
    s_waitcnt lgkmcnt(7)
    v_mfma_f32_16x16x32_bf16 v[100:103], v[60:63], v[68:71], v[100:103]
    ds_read_b64_tr_b16 v[20:21], v3 offset:32768
    v_mfma_f32_16x16x32_bf16 v[108:111], v[60:63], v[72:75], v[108:111]
    ds_read_b128 v[28:31], v8 offset:36864
    v_mfma_f32_16x16x32_bf16 v[116:119], v[60:63], v[76:79], v[116:119]
    ds_read_b64_tr_b16 v[22:23], v3 offset:34816
    v_mfma_f32_16x16x32_bf16 v[104:107], v[64:67], v[68:71], v[104:107]
    ds_read_b128 v[32:35], v8 offset:37120
    v_mfma_f32_16x16x32_bf16 v[112:115], v[64:67], v[72:75], v[112:115]
    ds_read_b64_tr_b16 v[24:25], v6 offset:32768
    v_mfma_f32_16x16x32_bf16 v[120:123], v[64:67], v[76:79], v[120:123]
    ds_read_b64_tr_b16 v[26:27], v6 offset:34816
    ds_read_b128 v[36:39], v8 offset:37376
    s_waitcnt lgkmcnt(7)
    v_mfma_f32_16x16x32_bf16 v[100:103], v[80:83], v[88:91], v[100:103]
    ds_read_b64_tr_b16 v[40:41], v3 offset:36864
    v_mfma_f32_16x16x32_bf16 v[108:111], v[80:83], v[92:95], v[108:111]
    ds_read_b128 v[48:51], v8 offset:43008
    v_mfma_f32_16x16x32_bf16 v[116:119], v[80:83], v[96:99], v[116:119]
    ds_read_b64_tr_b16 v[42:43], v3 offset:38912
    v_mfma_f32_16x16x32_bf16 v[104:107], v[84:87], v[88:91], v[104:107]
    ds_read_b128 v[52:55], v8 offset:43264
    v_mfma_f32_16x16x32_bf16 v[112:115], v[84:87], v[92:95], v[112:115]
    ds_read_b64_tr_b16 v[44:45], v6 offset:36864
    v_mfma_f32_16x16x32_bf16 v[120:123], v[84:87], v[96:99], v[120:123]
    ds_read_b64_tr_b16 v[46:47], v6 offset:38912
    ds_read_b128 v[56:59], v8 offset:43520
    s_barrier
    s_waitcnt lgkmcnt(7)
    v_mfma_f32_16x16x32_bf16 v[100:103], v[20:23], v[28:31], v[100:103]
    ds_read_b64_tr_b16 v[60:61], v3 offset:40960
    v_mfma_f32_16x16x32_bf16 v[108:111], v[20:23], v[32:35], v[108:111]
    ds_read_b128 v[68:71], v8 offset:49152
    v_mfma_f32_16x16x32_bf16 v[116:119], v[20:23], v[36:39], v[116:119]
    ds_read_b64_tr_b16 v[62:63], v3 offset:43008
    v_mfma_f32_16x16x32_bf16 v[104:107], v[24:27], v[28:31], v[104:107]
    ds_read_b128 v[72:75], v8 offset:49408
    v_mfma_f32_16x16x32_bf16 v[112:115], v[24:27], v[32:35], v[112:115]
    ds_read_b64_tr_b16 v[64:65], v6 offset:40960
    v_mfma_f32_16x16x32_bf16 v[120:123], v[24:27], v[36:39], v[120:123]
    ds_read_b64_tr_b16 v[66:67], v6 offset:43008
    ds_read_b128 v[76:79], v8 offset:49664
    s_waitcnt lgkmcnt(7)
    v_mfma_f32_16x16x32_bf16 v[100:103], v[40:43], v[48:51], v[100:103]
    ds_read_b64_tr_b16 v[80:81], v3 offset:45056
    v_mfma_f32_16x16x32_bf16 v[108:111], v[40:43], v[52:55], v[108:111]
    ds_read_b128 v[88:91], v8 offset:55296
    v_mfma_f32_16x16x32_bf16 v[116:119], v[40:43], v[56:59], v[116:119]
    ds_read_b64_tr_b16 v[82:83], v3 offset:47104
    v_mfma_f32_16x16x32_bf16 v[104:107], v[44:47], v[48:51], v[104:107]
    ds_read_b128 v[92:95], v8 offset:55552
    v_mfma_f32_16x16x32_bf16 v[112:115], v[44:47], v[52:55], v[112:115]
    ds_read_b64_tr_b16 v[84:85], v6 offset:45056
    v_mfma_f32_16x16x32_bf16 v[120:123], v[44:47], v[56:59], v[120:123]
    ds_read_b64_tr_b16 v[86:87], v6 offset:47104
    ds_read_b128 v[96:99], v8 offset:55808
    s_barrier
    s_waitcnt lgkmcnt(7)
    v_mfma_f32_16x16x32_bf16 v[100:103], v[60:63], v[68:71], v[100:103]
    ds_read_b64_tr_b16 v[20:21], v3 offset:49152
    v_mfma_f32_16x16x32_bf16 v[108:111], v[60:63], v[72:75], v[108:111]
    ds_read_b128 v[28:31], v8 offset:61440
    v_mfma_f32_16x16x32_bf16 v[116:119], v[60:63], v[76:79], v[116:119]
    ds_read_b64_tr_b16 v[22:23], v3 offset:51200
    v_mfma_f32_16x16x32_bf16 v[104:107], v[64:67], v[68:71], v[104:107]
    ds_read_b128 v[32:35], v8 offset:61696
    v_mfma_f32_16x16x32_bf16 v[112:115], v[64:67], v[72:75], v[112:115]
    ds_read_b64_tr_b16 v[24:25], v6 offset:49152
    v_mfma_f32_16x16x32_bf16 v[120:123], v[64:67], v[76:79], v[120:123]
    ds_read_b64_tr_b16 v[26:27], v6 offset:51200
    ds_read_b128 v[36:39], v8 offset:61952
    s_waitcnt lgkmcnt(7)
    v_mfma_f32_16x16x32_bf16 v[100:103], v[80:83], v[88:91], v[100:103]
    ds_read_b64_tr_b16 v[40:41], v3 offset:53248
    v_mfma_f32_16x16x32_bf16 v[108:111], v[80:83], v[92:95], v[108:111]
    ds_read_b128 v[48:51], v9 offset:2048
    v_mfma_f32_16x16x32_bf16 v[116:119], v[80:83], v[96:99], v[116:119]
    ds_read_b64_tr_b16 v[42:43], v3 offset:55296
    v_mfma_f32_16x16x32_bf16 v[104:107], v[84:87], v[88:91], v[104:107]
    ds_read_b128 v[52:55], v9 offset:2304
    v_mfma_f32_16x16x32_bf16 v[112:115], v[84:87], v[92:95], v[112:115]
    ds_read_b64_tr_b16 v[44:45], v6 offset:53248
    v_mfma_f32_16x16x32_bf16 v[120:123], v[84:87], v[96:99], v[120:123]
    ds_read_b64_tr_b16 v[46:47], v6 offset:55296
    ds_read_b128 v[56:59], v9 offset:2560
    s_barrier
    s_waitcnt lgkmcnt(7)
    v_mfma_f32_16x16x32_bf16 v[100:103], v[20:23], v[28:31], v[100:103]
    ds_read_b64_tr_b16 v[60:61], v3 offset:57344
    v_mfma_f32_16x16x32_bf16 v[108:111], v[20:23], v[32:35], v[108:111]
    ds_read_b128 v[68:71], v8 offset:0
    v_mfma_f32_16x16x32_bf16 v[116:119], v[20:23], v[36:39], v[116:119]
    ds_read_b64_tr_b16 v[62:63], v3 offset:59392
    v_mfma_f32_16x16x32_bf16 v[104:107], v[24:27], v[28:31], v[104:107]
    ds_read_b128 v[72:75], v8 offset:256
    v_mfma_f32_16x16x32_bf16 v[112:115], v[24:27], v[32:35], v[112:115]
    ds_read_b64_tr_b16 v[64:65], v6 offset:57344
    v_mfma_f32_16x16x32_bf16 v[120:123], v[24:27], v[36:39], v[120:123]
    ds_read_b64_tr_b16 v[66:67], v6 offset:59392
    ds_read_b128 v[76:79], v8 offset:512
    s_waitcnt lgkmcnt(7)
    v_mfma_f32_16x16x32_bf16 v[100:103], v[40:43], v[48:51], v[100:103]
    ds_read_b64_tr_b16 v[80:81], v3 offset:61440
    v_mfma_f32_16x16x32_bf16 v[108:111], v[40:43], v[52:55], v[108:111]
    ds_read_b128 v[88:91], v8 offset:6144
    v_mfma_f32_16x16x32_bf16 v[116:119], v[40:43], v[56:59], v[116:119]
    ds_read_b64_tr_b16 v[82:83], v3 offset:63488
    v_mfma_f32_16x16x32_bf16 v[104:107], v[44:47], v[48:51], v[104:107]
    ds_read_b128 v[92:95], v8 offset:6400
    v_mfma_f32_16x16x32_bf16 v[112:115], v[44:47], v[52:55], v[112:115]
    ds_read_b64_tr_b16 v[84:85], v6 offset:61440
    v_mfma_f32_16x16x32_bf16 v[120:123], v[44:47], v[56:59], v[120:123]
    ds_read_b64_tr_b16 v[86:87], v6 offset:63488
    ds_read_b128 v[96:99], v8 offset:6656
    s_barrier
    s_waitcnt lgkmcnt(7)
    v_mfma_f32_16x16x32_bf16 v[100:103], v[60:63], v[68:71], v[100:103]
    ds_read_b64_tr_b16 v[20:21], v4 offset:0
    v_mfma_f32_16x16x32_bf16 v[108:111], v[60:63], v[72:75], v[108:111]
    ds_read_b128 v[28:31], v8 offset:12288
    v_mfma_f32_16x16x32_bf16 v[116:119], v[60:63], v[76:79], v[116:119]
    ds_read_b64_tr_b16 v[22:23], v4 offset:2048
    v_mfma_f32_16x16x32_bf16 v[104:107], v[64:67], v[68:71], v[104:107]
    ds_read_b128 v[32:35], v8 offset:12544
    v_mfma_f32_16x16x32_bf16 v[112:115], v[64:67], v[72:75], v[112:115]
    ds_read_b64_tr_b16 v[24:25], v7 offset:0
    v_mfma_f32_16x16x32_bf16 v[120:123], v[64:67], v[76:79], v[120:123]
    ds_read_b64_tr_b16 v[26:27], v7 offset:2048
    ds_read_b128 v[36:39], v8 offset:12800
    s_waitcnt lgkmcnt(7)
    v_mfma_f32_16x16x32_bf16 v[100:103], v[80:83], v[88:91], v[100:103]
    ds_read_b64_tr_b16 v[40:41], v4 offset:4096
    v_mfma_f32_16x16x32_bf16 v[108:111], v[80:83], v[92:95], v[108:111]
    ds_read_b128 v[48:51], v8 offset:18432
    v_mfma_f32_16x16x32_bf16 v[116:119], v[80:83], v[96:99], v[116:119]
    ds_read_b64_tr_b16 v[42:43], v4 offset:6144
    v_mfma_f32_16x16x32_bf16 v[104:107], v[84:87], v[88:91], v[104:107]
    ds_read_b128 v[52:55], v8 offset:18688
    v_mfma_f32_16x16x32_bf16 v[112:115], v[84:87], v[92:95], v[112:115]
    ds_read_b64_tr_b16 v[44:45], v7 offset:4096
    v_mfma_f32_16x16x32_bf16 v[120:123], v[84:87], v[96:99], v[120:123]
    ds_read_b64_tr_b16 v[46:47], v7 offset:6144
    ds_read_b128 v[56:59], v8 offset:18944
    s_barrier
    s_waitcnt lgkmcnt(7)
    v_mfma_f32_16x16x32_bf16 v[100:103], v[20:23], v[28:31], v[100:103]
    ds_read_b64_tr_b16 v[60:61], v4 offset:8192
    v_mfma_f32_16x16x32_bf16 v[108:111], v[20:23], v[32:35], v[108:111]
    ds_read_b128 v[68:71], v8 offset:24576
    v_mfma_f32_16x16x32_bf16 v[116:119], v[20:23], v[36:39], v[116:119]
    ds_read_b64_tr_b16 v[62:63], v4 offset:10240
    v_mfma_f32_16x16x32_bf16 v[104:107], v[24:27], v[28:31], v[104:107]
    ds_read_b128 v[72:75], v8 offset:24832
    v_mfma_f32_16x16x32_bf16 v[112:115], v[24:27], v[32:35], v[112:115]
    ds_read_b64_tr_b16 v[64:65], v7 offset:8192
    v_mfma_f32_16x16x32_bf16 v[120:123], v[24:27], v[36:39], v[120:123]
    ds_read_b64_tr_b16 v[66:67], v7 offset:10240
    ds_read_b128 v[76:79], v8 offset:25088
    s_waitcnt lgkmcnt(7)
    v_mfma_f32_16x16x32_bf16 v[100:103], v[40:43], v[48:51], v[100:103]
    ds_read_b64_tr_b16 v[80:81], v4 offset:12288
    v_mfma_f32_16x16x32_bf16 v[108:111], v[40:43], v[52:55], v[108:111]
    ds_read_b128 v[88:91], v8 offset:30720
    v_mfma_f32_16x16x32_bf16 v[116:119], v[40:43], v[56:59], v[116:119]
    ds_read_b64_tr_b16 v[82:83], v4 offset:14336
    v_mfma_f32_16x16x32_bf16 v[104:107], v[44:47], v[48:51], v[104:107]
    ds_read_b128 v[92:95], v8 offset:30976
    v_mfma_f32_16x16x32_bf16 v[112:115], v[44:47], v[52:55], v[112:115]
    ds_read_b64_tr_b16 v[84:85], v7 offset:12288
    v_mfma_f32_16x16x32_bf16 v[120:123], v[44:47], v[56:59], v[120:123]
    ds_read_b64_tr_b16 v[86:87], v7 offset:14336
    ds_read_b128 v[96:99], v8 offset:31232
    s_barrier
    s_waitcnt lgkmcnt(7)
    v_mfma_f32_16x16x32_bf16 v[100:103], v[60:63], v[68:71], v[100:103]
    ds_read_b64_tr_b16 v[20:21], v4 offset:16384
    v_mfma_f32_16x16x32_bf16 v[108:111], v[60:63], v[72:75], v[108:111]
    ds_read_b128 v[28:31], v8 offset:36864
    v_mfma_f32_16x16x32_bf16 v[116:119], v[60:63], v[76:79], v[116:119]
    ds_read_b64_tr_b16 v[22:23], v4 offset:18432
    v_mfma_f32_16x16x32_bf16 v[104:107], v[64:67], v[68:71], v[104:107]
    ds_read_b128 v[32:35], v8 offset:37120
    v_mfma_f32_16x16x32_bf16 v[112:115], v[64:67], v[72:75], v[112:115]
    ds_read_b64_tr_b16 v[24:25], v7 offset:16384
    v_mfma_f32_16x16x32_bf16 v[120:123], v[64:67], v[76:79], v[120:123]
    ds_read_b64_tr_b16 v[26:27], v7 offset:18432
    ds_read_b128 v[36:39], v8 offset:37376
    s_waitcnt lgkmcnt(7)
    v_mfma_f32_16x16x32_bf16 v[100:103], v[80:83], v[88:91], v[100:103]
    ds_read_b64_tr_b16 v[40:41], v4 offset:20480
    v_mfma_f32_16x16x32_bf16 v[108:111], v[80:83], v[92:95], v[108:111]
    ds_read_b128 v[48:51], v8 offset:43008
    v_mfma_f32_16x16x32_bf16 v[116:119], v[80:83], v[96:99], v[116:119]
    ds_read_b64_tr_b16 v[42:43], v4 offset:22528
    v_mfma_f32_16x16x32_bf16 v[104:107], v[84:87], v[88:91], v[104:107]
    ds_read_b128 v[52:55], v8 offset:43264
    v_mfma_f32_16x16x32_bf16 v[112:115], v[84:87], v[92:95], v[112:115]
    ds_read_b64_tr_b16 v[44:45], v7 offset:20480
    v_mfma_f32_16x16x32_bf16 v[120:123], v[84:87], v[96:99], v[120:123]
    ds_read_b64_tr_b16 v[46:47], v7 offset:22528
    ds_read_b128 v[56:59], v8 offset:43520
    s_barrier
    s_waitcnt lgkmcnt(7)
    v_mfma_f32_16x16x32_bf16 v[100:103], v[20:23], v[28:31], v[100:103]
    ds_read_b64_tr_b16 v[60:61], v4 offset:24576
    v_mfma_f32_16x16x32_bf16 v[108:111], v[20:23], v[32:35], v[108:111]
    ds_read_b128 v[68:71], v8 offset:49152
    v_mfma_f32_16x16x32_bf16 v[116:119], v[20:23], v[36:39], v[116:119]
    ds_read_b64_tr_b16 v[62:63], v4 offset:26624
    v_mfma_f32_16x16x32_bf16 v[104:107], v[24:27], v[28:31], v[104:107]
    ds_read_b128 v[72:75], v8 offset:49408
    v_mfma_f32_16x16x32_bf16 v[112:115], v[24:27], v[32:35], v[112:115]
    ds_read_b64_tr_b16 v[64:65], v7 offset:24576
    v_mfma_f32_16x16x32_bf16 v[120:123], v[24:27], v[36:39], v[120:123]
    ds_read_b64_tr_b16 v[66:67], v7 offset:26624
    ds_read_b128 v[76:79], v8 offset:49664
    s_waitcnt lgkmcnt(7)
    v_mfma_f32_16x16x32_bf16 v[100:103], v[40:43], v[48:51], v[100:103]
    ds_read_b64_tr_b16 v[80:81], v4 offset:28672
    v_mfma_f32_16x16x32_bf16 v[108:111], v[40:43], v[52:55], v[108:111]
    ds_read_b128 v[88:91], v8 offset:55296
    v_mfma_f32_16x16x32_bf16 v[116:119], v[40:43], v[56:59], v[116:119]
    ds_read_b64_tr_b16 v[82:83], v4 offset:30720
    v_mfma_f32_16x16x32_bf16 v[104:107], v[44:47], v[48:51], v[104:107]
    ds_read_b128 v[92:95], v8 offset:55552
    v_mfma_f32_16x16x32_bf16 v[112:115], v[44:47], v[52:55], v[112:115]
    ds_read_b64_tr_b16 v[84:85], v7 offset:28672
    v_mfma_f32_16x16x32_bf16 v[120:123], v[44:47], v[56:59], v[120:123]
    ds_read_b64_tr_b16 v[86:87], v7 offset:30720
    ds_read_b128 v[96:99], v8 offset:55808
    s_waitcnt lgkmcnt(7)
    v_mfma_f32_16x16x32_bf16 v[100:103], v[60:63], v[68:71], v[100:103]
    v_mfma_f32_16x16x32_bf16 v[108:111], v[60:63], v[72:75], v[108:111]
    v_mfma_f32_16x16x32_bf16 v[116:119], v[60:63], v[76:79], v[116:119]
    v_mfma_f32_16x16x32_bf16 v[104:107], v[64:67], v[68:71], v[104:107]
    v_mfma_f32_16x16x32_bf16 v[112:115], v[64:67], v[72:75], v[112:115]
    v_mfma_f32_16x16x32_bf16 v[120:123], v[64:67], v[76:79], v[120:123]
    s_waitcnt lgkmcnt(0)
    s_barrier
    v_mfma_f32_16x16x32_bf16 v[100:103], v[80:83], v[88:91], v[100:103]
    v_mfma_f32_16x16x32_bf16 v[108:111], v[80:83], v[92:95], v[108:111]
    v_mfma_f32_16x16x32_bf16 v[104:107], v[84:87], v[88:91], v[104:107]
    v_mfma_f32_16x16x32_bf16 v[116:119], v[80:83], v[96:99], v[116:119]
    v_mfma_f32_16x16x32_bf16 v[112:115], v[84:87], v[92:95], v[112:115]
    v_mfma_f32_16x16x32_bf16 v[120:123], v[84:87], v[96:99], v[120:123]
    s_waitcnt vmcnt(0)
    s_mov_b32 s61, 917504
    s_mov_b64 vcc, s[86:87]
    s_nop 1
    v_permlane16_swap_b32 v100, v104
    v_permlane16_swap_b32 v101, v105
    v_permlane16_swap_b32 v102, v106
    v_permlane16_swap_b32 v103, v107
    v_cvt_pk_bf16_f32 v240, v100, v101
    v_cvt_pk_bf16_f32 v241, v102, v103
    v_cvt_pk_bf16_f32 v242, v104, v105
    v_cvt_pk_bf16_f32 v243, v106, v107
    s_cbranch_vccz slow_37
    buffer_store_dwordx4 v[240:243], v16, s[52:55], s61 offen
back_38:
    v_permlane16_swap_b32 v108, v112
    v_permlane16_swap_b32 v109, v113
    v_permlane16_swap_b32 v110, v114
    v_permlane16_swap_b32 v111, v115
    v_cvt_pk_bf16_f32 v244, v108, v109
    v_cvt_pk_bf16_f32 v245, v110, v111
    v_cvt_pk_bf16_f32 v246, v112, v113
    v_cvt_pk_bf16_f32 v247, v114, v115
    s_cbranch_vccz slow_39
    buffer_store_dwordx4 v[244:247], v17, s[52:55], s61 offen
back_40:
    v_permlane16_swap_b32 v116, v120
    v_permlane16_swap_b32 v117, v121
    v_permlane16_swap_b32 v118, v122
    v_permlane16_swap_b32 v119, v123
    v_cvt_pk_bf16_f32 v248, v116, v117
    v_cvt_pk_bf16_f32 v249, v118, v119
    v_cvt_pk_bf16_f32 v250, v120, v121
    v_cvt_pk_bf16_f32 v251, v122, v123
    s_cbranch_vccz slow_41
    buffer_store_dwordx4 v[248:251], v18, s[52:55], s61 offen
back_42:
    v_mov_b32 v30, 0x3f803f80
    v_mov_b32 v20, 0
    v_mov_b32 v21, 0
    v_mov_b32 v22, 0
    v_mov_b32 v23, 0
    v_mov_b32 v24, 0
    v_mov_b32 v25, 0
    v_dot2c_f32_bf16 v20, v240, v30
    v_dot2c_f32_bf16 v21, v240, v240
    v_dot2c_f32_bf16 v22, v244, v30
    v_dot2c_f32_bf16 v23, v244, v244
    v_dot2c_f32_bf16 v24, v248, v30
    v_dot2c_f32_bf16 v25, v248, v248
    v_dot2c_f32_bf16 v20, v241, v30
    v_dot2c_f32_bf16 v21, v241, v241
    v_dot2c_f32_bf16 v22, v245, v30
    v_dot2c_f32_bf16 v23, v245, v245
    v_dot2c_f32_bf16 v24, v249, v30
    v_dot2c_f32_bf16 v25, v249, v249
    v_dot2c_f32_bf16 v20, v242, v30
    v_dot2c_f32_bf16 v21, v242, v242
    v_dot2c_f32_bf16 v22, v246, v30
    v_dot2c_f32_bf16 v23, v246, v246
    v_dot2c_f32_bf16 v24, v250, v30
    v_dot2c_f32_bf16 v25, v250, v250
    v_dot2c_f32_bf16 v20, v243, v30
    v_dot2c_f32_bf16 v21, v243, v243
    v_dot2c_f32_bf16 v22, v247, v30
    v_dot2c_f32_bf16 v23, v247, v247
    v_dot2c_f32_bf16 v24, v251, v30
    v_dot2c_f32_bf16 v25, v251, v251
    s_mul_i32 s61, s57, 64
    s_lshl_b32 s3, s23, 2
    s_add_u32 s61, s61, s3
    s_add_u32 s61, s61, 1642496
    v_mov_b32 v3, 1
    s_waitcnt vmcnt(0)
    s_mov_b64 exec, 1
    s_cbranch_vccz slow_43
    buffer_store_dword v3, off, s[52:55], s61
back_44:
    s_mov_b64 exec, -1
    v_permlane32_swap_b32 v20, v21
    v_permlane32_swap_b32 v22, v23
    v_permlane32_swap_b32 v24, v25
    v_add_f32 v20, v20, v21
    v_add_f32 v22, v22, v23
    v_add_f32 v24, v24, v25
    v_mov_b32 v25, v24
    v_permlane16_swap_b32 v20, v22
    s_nop 0
    v_permlane16_swap_b32 v24, v25
    v_add_f32 v20, v20, v22
    v_add_f32 v24, v24, v25
    s_cbranch_vccz slow_45
    buffer_store_dword v20, v232, s[52:55], s60 offen
back_46:
    s_cbranch_vccz slow_47
    buffer_store_dword v24, v233, s[52:55], s60 offen
back_48:
    s_waitcnt vmcnt(0)
    s_mov_b64 exec, 1
    s_cbranch_vccz slow_49
    buffer_store_dword v3, off, s[52:55], s61 offset:16
back_50:
    s_mov_b64 exec, -1
    s_cmp_ge_u32 s57, 28
    s_cbranch_scc1 Lskip3b
    s_cmp_ge_u32 s57, 14
    s_cselect_b32 s3, 1, 0
    s_cselect_b32 s73, 14, 0
    s_sub_u32 s73, s57, s73
    s_lshl_b32 s72, s3, 7
    v_lshrrev_b32 v11, 2, v1
    v_and_b32 v11, 3, v11
    v_lshrrev_b32 v2, 5, v1
    v_lshl_add_u32 v2, v2, 3, v11
    v_lshlrev_b32 v2, 8, v2
    v_lshrrev_b32 v3, 4, v1
    v_and_b32 v3, 1, v3
    v_lshl_add_u32 v2, v3, 5, v2
    v_and_b32 v3, 3, v1
    v_lshl_add_u32 v2, v3, 3, v2
    s_lshl_b32 s3, s71, 1
    v_xor_b32 v11, s3, v11
    v_xor_b32 v3, 1, v11
    v_lshl_add_u32 v5, v3, 6, v2
    v_lshl_add_u32 v2, v11, 6, v2
    v_add_u32 v3, 0x10000, v2
    v_add_u32 v4, 0x20000, v2
    v_add_u32 v6, 0x10000, v5
    v_add_u32 v7, 0x20000, v5
    v_lshrrev_b32 v8, 5, v1
    v_lshlrev_b32 v8, 11, v8
    v_and_b32 v11, 31, v1
    v_lshl_add_u32 v8, v11, 4, v8
    s_lshl_b32 s3, s70, 10
    v_add_u32 v8, s3, v8
    v_add_u32 v9, 0x10000, v8
    v_add_u32 v10, 0x20000, v8
    v_lshrrev_b32 v15, 5, v1
    v_lshlrev_b32 v12, 4, v15
    s_lshl_b32 s3, s71, 8
    s_add_u32 s3, s3, 66560
    v_add_u32 v12, s3, v12
    v_mul_u32_u24 v14, 4096, v15
    v_lshl_add_u32 v14, v11, 4, v14
    s_lshl_b32 s77, s73, 1
    s_add_u32 s77, s77, s71
    s_mul_i32 s60, s77, 32768
    s_lshl_b32 s3, s70, 6
    s_add_u32 s3, s3, s72
    s_lshl_b32 s3, s3, 4
    s_add_u32 s60, s60, s3
    s_add_u32 s60, s60, 0
    v_lshlrev_b32 v13, 3, v11
    s_lshl_b32 s3, s70, 9
    s_add_u32 s3, s3, 65536
    v_add_u32 v13, s3, v13
    v_mov_b32 v16, -1.4426950408889634
    s_barrier
    ds_read_b128 v[28:31], v9 offset:32768
    ds_read_b64_tr_b16 v[20:21], v2 offset:0
    ds_read_b64_tr_b16 v[22:23], v2 offset:1024
    ds_read_b128 v[32:35], v9 offset:33280
    ds_read_b64_tr_b16 v[24:25], v5 offset:0
    ds_read_b64_tr_b16 v[26:27], v5 offset:1024
    s_waitcnt lgkmcnt(0)
    v_mfma_f32_32x32x16_bf16 v[100:115], v[20:23], v[28:31], 0
    ds_read_b128 v[44:47], v9 offset:36864
    ds_read_b64_tr_b16 v[36:37], v2 offset:4096
    ds_read_b64_tr_b16 v[38:39], v2 offset:5120
    v_mfma_f32_32x32x16_bf16 v[116:131], v[20:23], v[32:35], 0
    ds_read_b128 v[48:51], v9 offset:37376
    ds_read_b64_tr_b16 v[40:41], v5 offset:4096
    ds_read_b64_tr_b16 v[42:43], v5 offset:5120
    v_mfma_f32_32x32x16_bf16 v[132:147], v[24:27], v[28:31], 0
    v_mfma_f32_32x32x16_bf16 v[148:163], v[24:27], v[32:35], 0
    s_waitcnt lgkmcnt(0)
    v_mfma_f32_32x32x16_bf16 v[100:115], v[36:39], v[44:47], v[100:115]
    ds_read_b128 v[28:31], v9 offset:40960
    ds_read_b64_tr_b16 v[20:21], v2 offset:8192
    ds_read_b64_tr_b16 v[22:23], v2 offset:9216
    v_mfma_f32_32x32x16_bf16 v[116:131], v[36:39], v[48:51], v[116:131]
    ds_read_b128 v[32:35], v9 offset:41472
    ds_read_b64_tr_b16 v[24:25], v5 offset:8192
    ds_read_b64_tr_b16 v[26:27], v5 offset:9216
    v_mfma_f32_32x32x16_bf16 v[132:147], v[40:43], v[44:47], v[132:147]
    v_mfma_f32_32x32x16_bf16 v[148:163], v[40:43], v[48:51], v[148:163]
    s_waitcnt lgkmcnt(0)
    v_mfma_f32_32x32x16_bf16 v[100:115], v[20:23], v[28:31], v[100:115]
    ds_read_b128 v[44:47], v9 offset:45056
    ds_read_b64_tr_b16 v[36:37], v2 offset:12288
    ds_read_b64_tr_b16 v[38:39], v2 offset:13312
    v_mfma_f32_32x32x16_bf16 v[116:131], v[20:23], v[32:35], v[116:131]
    ds_read_b128 v[48:51], v9 offset:45568
    ds_read_b64_tr_b16 v[40:41], v5 offset:12288
    ds_read_b64_tr_b16 v[42:43], v5 offset:13312
    v_mfma_f32_32x32x16_bf16 v[132:147], v[24:27], v[28:31], v[132:147]
    v_mfma_f32_32x32x16_bf16 v[148:163], v[24:27], v[32:35], v[148:163]
    s_waitcnt lgkmcnt(0)
    v_mfma_f32_32x32x16_bf16 v[100:115], v[36:39], v[44:47], v[100:115]
    s_barrier
    ds_read_b128 v[28:31], v9 offset:49152
    ds_read_b64_tr_b16 v[20:21], v2 offset:16384
    ds_read_b64_tr_b16 v[22:23], v2 offset:17408
    v_mfma_f32_32x32x16_bf16 v[116:131], v[36:39], v[48:51], v[116:131]
    ds_read_b128 v[32:35], v9 offset:49664
    ds_read_b64_tr_b16 v[24:25], v5 offset:16384
    ds_read_b64_tr_b16 v[26:27], v5 offset:17408
    v_mfma_f32_32x32x16_bf16 v[132:147], v[40:43], v[44:47], v[132:147]
    v_mfma_f32_32x32x16_bf16 v[148:163], v[40:43], v[48:51], v[148:163]
    s_waitcnt lgkmcnt(0)
    v_mfma_f32_32x32x16_bf16 v[100:115], v[20:23], v[28:31], v[100:115]
    ds_read_b128 v[44:47], v9 offset:53248
    ds_read_b64_tr_b16 v[36:37], v2 offset:20480
    ds_read_b64_tr_b16 v[38:39], v2 offset:21504
    v_mfma_f32_32x32x16_bf16 v[116:131], v[20:23], v[32:35], v[116:131]
    ds_read_b128 v[48:51], v9 offset:53760
    ds_read_b64_tr_b16 v[40:41], v5 offset:20480
    ds_read_b64_tr_b16 v[42:43], v5 offset:21504
    v_mfma_f32_32x32x16_bf16 v[132:147], v[24:27], v[28:31], v[132:147]
    v_mfma_f32_32x32x16_bf16 v[148:163], v[24:27], v[32:35], v[148:163]
    s_waitcnt lgkmcnt(0)
    v_mfma_f32_32x32x16_bf16 v[100:115], v[36:39], v[44:47], v[100:115]
    ds_read_b128 v[28:31], v9 offset:57344
    ds_read_b64_tr_b16 v[20:21], v2 offset:24576
    ds_read_b64_tr_b16 v[22:23], v2 offset:25600
    v_mfma_f32_32x32x16_bf16 v[116:131], v[36:39], v[48:51], v[116:131]
    ds_read_b128 v[32:35], v9 offset:57856
    ds_read_b64_tr_b16 v[24:25], v5 offset:24576
    ds_read_b64_tr_b16 v[26:27], v5 offset:25600
    v_mfma_f32_32x32x16_bf16 v[132:147], v[40:43], v[44:47], v[132:147]
    v_mfma_f32_32x32x16_bf16 v[148:163], v[40:43], v[48:51], v[148:163]
    s_waitcnt lgkmcnt(0)
    v_mfma_f32_32x32x16_bf16 v[100:115], v[20:23], v[28:31], v[100:115]
    ds_read_b128 v[44:47], v9 offset:61440
    ds_read_b64_tr_b16 v[36:37], v2 offset:28672
    ds_read_b64_tr_b16 v[38:39], v2 offset:29696
    v_mfma_f32_32x32x16_bf16 v[116:131], v[20:23], v[32:35], v[116:131]
    ds_read_b128 v[48:51], v9 offset:61952
    ds_read_b64_tr_b16 v[40:41], v5 offset:28672
    ds_read_b64_tr_b16 v[42:43], v5 offset:29696
    v_mfma_f32_32x32x16_bf16 v[132:147], v[24:27], v[28:31], v[132:147]
    v_mfma_f32_32x32x16_bf16 v[148:163], v[24:27], v[32:35], v[148:163]
    s_waitcnt lgkmcnt(0)
    v_mfma_f32_32x32x16_bf16 v[100:115], v[36:39], v[44:47], v[100:115]
    s_barrier
    ds_read_b128 v[28:31], v10 offset:0
    ds_read_b64_tr_b16 v[20:21], v2 offset:32768
    ds_read_b64_tr_b16 v[22:23], v2 offset:33792
    v_mfma_f32_32x32x16_bf16 v[116:131], v[36:39], v[48:51], v[116:131]
    ds_read_b128 v[32:35], v10 offset:512
    ds_read_b64_tr_b16 v[24:25], v5 offset:32768
    ds_read_b64_tr_b16 v[26:27], v5 offset:33792
    v_mfma_f32_32x32x16_bf16 v[132:147], v[40:43], v[44:47], v[132:147]
    v_mfma_f32_32x32x16_bf16 v[148:163], v[40:43], v[48:51], v[148:163]
    s_waitcnt lgkmcnt(0)
    v_mfma_f32_32x32x16_bf16 v[100:115], v[20:23], v[28:31], v[100:115]
    ds_read_b128 v[44:47], v10 offset:4096
    ds_read_b64_tr_b16 v[36:37], v2 offset:36864
    ds_read_b64_tr_b16 v[38:39], v2 offset:37888
    v_mfma_f32_32x32x16_bf16 v[116:131], v[20:23], v[32:35], v[116:131]
    ds_read_b128 v[48:51], v10 offset:4608
    ds_read_b64_tr_b16 v[40:41], v5 offset:36864
    ds_read_b64_tr_b16 v[42:43], v5 offset:37888
    v_mfma_f32_32x32x16_bf16 v[132:147], v[24:27], v[28:31], v[132:147]
    v_mfma_f32_32x32x16_bf16 v[148:163], v[24:27], v[32:35], v[148:163]
    s_waitcnt lgkmcnt(0)
    v_mfma_f32_32x32x16_bf16 v[100:115], v[36:39], v[44:47], v[100:115]
    ds_read_b128 v[28:31], v10 offset:8192
    ds_read_b64_tr_b16 v[20:21], v2 offset:40960
    ds_read_b64_tr_b16 v[22:23], v2 offset:41984
    v_mfma_f32_32x32x16_bf16 v[116:131], v[36:39], v[48:51], v[116:131]
    ds_read_b128 v[32:35], v10 offset:8704
    ds_read_b64_tr_b16 v[24:25], v5 offset:40960
    ds_read_b64_tr_b16 v[26:27], v5 offset:41984
    v_mfma_f32_32x32x16_bf16 v[132:147], v[40:43], v[44:47], v[132:147]
    v_mfma_f32_32x32x16_bf16 v[148:163], v[40:43], v[48:51], v[148:163]
    s_waitcnt lgkmcnt(0)
    v_mfma_f32_32x32x16_bf16 v[100:115], v[20:23], v[28:31], v[100:115]
    ds_read_b128 v[44:47], v10 offset:12288
    ds_read_b64_tr_b16 v[36:37], v2 offset:45056
    ds_read_b64_tr_b16 v[38:39], v2 offset:46080
    v_mfma_f32_32x32x16_bf16 v[116:131], v[20:23], v[32:35], v[116:131]
    ds_read_b128 v[48:51], v10 offset:12800
    ds_read_b64_tr_b16 v[40:41], v5 offset:45056
    ds_read_b64_tr_b16 v[42:43], v5 offset:46080
    v_mfma_f32_32x32x16_bf16 v[132:147], v[24:27], v[28:31], v[132:147]
    v_mfma_f32_32x32x16_bf16 v[148:163], v[24:27], v[32:35], v[148:163]
    s_waitcnt lgkmcnt(0)
    v_mfma_f32_32x32x16_bf16 v[100:115], v[36:39], v[44:47], v[100:115]
    s_barrier
    ds_read_b128 v[28:31], v10 offset:16384
    ds_read_b64_tr_b16 v[20:21], v2 offset:49152
    ds_read_b64_tr_b16 v[22:23], v2 offset:50176
    v_mfma_f32_32x32x16_bf16 v[116:131], v[36:39], v[48:51], v[116:131]
    ds_read_b128 v[32:35], v10 offset:16896
    ds_read_b64_tr_b16 v[24:25], v5 offset:49152
    ds_read_b64_tr_b16 v[26:27], v5 offset:50176
    v_mfma_f32_32x32x16_bf16 v[132:147], v[40:43], v[44:47], v[132:147]
    v_mfma_f32_32x32x16_bf16 v[148:163], v[40:43], v[48:51], v[148:163]
    s_waitcnt lgkmcnt(0)
    v_mfma_f32_32x32x16_bf16 v[100:115], v[20:23], v[28:31], v[100:115]
    ds_read_b128 v[44:47], v10 offset:20480
    ds_read_b64_tr_b16 v[36:37], v2 offset:53248
    ds_read_b64_tr_b16 v[38:39], v2 offset:54272
    v_mfma_f32_32x32x16_bf16 v[116:131], v[20:23], v[32:35], v[116:131]
    ds_read_b128 v[48:51], v10 offset:20992
    ds_read_b64_tr_b16 v[40:41], v5 offset:53248
    ds_read_b64_tr_b16 v[42:43], v5 offset:54272
    v_mfma_f32_32x32x16_bf16 v[132:147], v[24:27], v[28:31], v[132:147]
    v_mfma_f32_32x32x16_bf16 v[148:163], v[24:27], v[32:35], v[148:163]
    s_waitcnt lgkmcnt(0)
    v_mfma_f32_32x32x16_bf16 v[100:115], v[36:39], v[44:47], v[100:115]
    ds_read_b128 v[28:31], v10 offset:24576
    ds_read_b64_tr_b16 v[20:21], v2 offset:57344
    ds_read_b64_tr_b16 v[22:23], v2 offset:58368
    v_mfma_f32_32x32x16_bf16 v[116:131], v[36:39], v[48:51], v[116:131]
    ds_read_b128 v[32:35], v10 offset:25088
    ds_read_b64_tr_b16 v[24:25], v5 offset:57344
    ds_read_b64_tr_b16 v[26:27], v5 offset:58368
    v_mfma_f32_32x32x16_bf16 v[132:147], v[40:43], v[44:47], v[132:147]
    v_mfma_f32_32x32x16_bf16 v[148:163], v[40:43], v[48:51], v[148:163]
    s_waitcnt lgkmcnt(0)
    v_mfma_f32_32x32x16_bf16 v[100:115], v[20:23], v[28:31], v[100:115]
    ds_read_b128 v[44:47], v10 offset:28672
    ds_read_b64_tr_b16 v[36:37], v2 offset:61440
    ds_read_b64_tr_b16 v[38:39], v2 offset:62464
    v_mfma_f32_32x32x16_bf16 v[116:131], v[20:23], v[32:35], v[116:131]
    ds_read_b128 v[48:51], v10 offset:29184
    ds_read_b64_tr_b16 v[40:41], v5 offset:61440
    ds_read_b64_tr_b16 v[42:43], v5 offset:62464
    v_mfma_f32_32x32x16_bf16 v[132:147], v[24:27], v[28:31], v[132:147]
    v_mfma_f32_32x32x16_bf16 v[148:163], v[24:27], v[32:35], v[148:163]
    s_waitcnt lgkmcnt(0)
    v_mfma_f32_32x32x16_bf16 v[100:115], v[36:39], v[44:47], v[100:115]
    s_barrier
    ds_read_b128 v[28:31], v9 offset:32768
    ds_read_b64_tr_b16 v[20:21], v3 offset:0
    ds_read_b64_tr_b16 v[22:23], v3 offset:1024
    v_mfma_f32_32x32x16_bf16 v[116:131], v[36:39], v[48:51], v[116:131]
    ds_read_b128 v[32:35], v9 offset:33280
    ds_read_b64_tr_b16 v[24:25], v6 offset:0
    ds_read_b64_tr_b16 v[26:27], v6 offset:1024
    v_mfma_f32_32x32x16_bf16 v[132:147], v[40:43], v[44:47], v[132:147]
    v_mfma_f32_32x32x16_bf16 v[148:163], v[40:43], v[48:51], v[148:163]
    s_waitcnt lgkmcnt(0)
    v_mfma_f32_32x32x16_bf16 v[100:115], v[20:23], v[28:31], v[100:115]
    ds_read_b128 v[44:47], v9 offset:36864
    ds_read_b64_tr_b16 v[36:37], v3 offset:4096
    ds_read_b64_tr_b16 v[38:39], v3 offset:5120
    v_mfma_f32_32x32x16_bf16 v[116:131], v[20:23], v[32:35], v[116:131]
    ds_read_b128 v[48:51], v9 offset:37376
    ds_read_b64_tr_b16 v[40:41], v6 offset:4096
    ds_read_b64_tr_b16 v[42:43], v6 offset:5120
    v_mfma_f32_32x32x16_bf16 v[132:147], v[24:27], v[28:31], v[132:147]
    v_mfma_f32_32x32x16_bf16 v[148:163], v[24:27], v[32:35], v[148:163]
    s_waitcnt lgkmcnt(0)
    v_mfma_f32_32x32x16_bf16 v[100:115], v[36:39], v[44:47], v[100:115]
    ds_read_b128 v[28:31], v9 offset:40960
    ds_read_b64_tr_b16 v[20:21], v3 offset:8192
    ds_read_b64_tr_b16 v[22:23], v3 offset:9216
    v_mfma_f32_32x32x16_bf16 v[116:131], v[36:39], v[48:51], v[116:131]
    ds_read_b128 v[32:35], v9 offset:41472
    ds_read_b64_tr_b16 v[24:25], v6 offset:8192
    ds_read_b64_tr_b16 v[26:27], v6 offset:9216
    v_mfma_f32_32x32x16_bf16 v[132:147], v[40:43], v[44:47], v[132:147]
    v_mfma_f32_32x32x16_bf16 v[148:163], v[40:43], v[48:51], v[148:163]
    s_waitcnt lgkmcnt(0)
    v_mfma_f32_32x32x16_bf16 v[100:115], v[20:23], v[28:31], v[100:115]
    ds_read_b128 v[44:47], v9 offset:45056
    ds_read_b64_tr_b16 v[36:37], v3 offset:12288
    ds_read_b64_tr_b16 v[38:39], v3 offset:13312
    v_mfma_f32_32x32x16_bf16 v[116:131], v[20:23], v[32:35], v[116:131]
    ds_read_b128 v[48:51], v9 offset:45568
    ds_read_b64_tr_b16 v[40:41], v6 offset:12288
    ds_read_b64_tr_b16 v[42:43], v6 offset:13312
    v_mfma_f32_32x32x16_bf16 v[132:147], v[24:27], v[28:31], v[132:147]
    v_mfma_f32_32x32x16_bf16 v[148:163], v[24:27], v[32:35], v[148:163]
    s_waitcnt lgkmcnt(0)
    v_mfma_f32_32x32x16_bf16 v[100:115], v[36:39], v[44:47], v[100:115]
    s_barrier
    ds_read_b128 v[28:31], v9 offset:49152
    ds_read_b64_tr_b16 v[20:21], v3 offset:16384
    ds_read_b64_tr_b16 v[22:23], v3 offset:17408
    v_mfma_f32_32x32x16_bf16 v[116:131], v[36:39], v[48:51], v[116:131]
    ds_read_b128 v[32:35], v9 offset:49664
    ds_read_b64_tr_b16 v[24:25], v6 offset:16384
    ds_read_b64_tr_b16 v[26:27], v6 offset:17408
    v_mfma_f32_32x32x16_bf16 v[132:147], v[40:43], v[44:47], v[132:147]
    v_mfma_f32_32x32x16_bf16 v[148:163], v[40:43], v[48:51], v[148:163]
    s_waitcnt lgkmcnt(0)
    v_mfma_f32_32x32x16_bf16 v[100:115], v[20:23], v[28:31], v[100:115]
    ds_read_b128 v[44:47], v9 offset:53248
    ds_read_b64_tr_b16 v[36:37], v3 offset:20480
    ds_read_b64_tr_b16 v[38:39], v3 offset:21504
    v_mfma_f32_32x32x16_bf16 v[116:131], v[20:23], v[32:35], v[116:131]
    ds_read_b128 v[48:51], v9 offset:53760
    ds_read_b64_tr_b16 v[40:41], v6 offset:20480
    ds_read_b64_tr_b16 v[42:43], v6 offset:21504
    v_mfma_f32_32x32x16_bf16 v[132:147], v[24:27], v[28:31], v[132:147]
    v_mfma_f32_32x32x16_bf16 v[148:163], v[24:27], v[32:35], v[148:163]
    s_waitcnt lgkmcnt(0)
    v_mfma_f32_32x32x16_bf16 v[100:115], v[36:39], v[44:47], v[100:115]
    ds_read_b128 v[28:31], v9 offset:57344
    ds_read_b64_tr_b16 v[20:21], v3 offset:24576
    ds_read_b64_tr_b16 v[22:23], v3 offset:25600
    v_mfma_f32_32x32x16_bf16 v[116:131], v[36:39], v[48:51], v[116:131]
    ds_read_b128 v[32:35], v9 offset:57856
    ds_read_b64_tr_b16 v[24:25], v6 offset:24576
    ds_read_b64_tr_b16 v[26:27], v6 offset:25600
    v_mfma_f32_32x32x16_bf16 v[132:147], v[40:43], v[44:47], v[132:147]
    v_mfma_f32_32x32x16_bf16 v[148:163], v[40:43], v[48:51], v[148:163]
    s_waitcnt lgkmcnt(0)
    v_mfma_f32_32x32x16_bf16 v[100:115], v[20:23], v[28:31], v[100:115]
    ds_read_b128 v[44:47], v9 offset:61440
    ds_read_b64_tr_b16 v[36:37], v3 offset:28672
    ds_read_b64_tr_b16 v[38:39], v3 offset:29696
    v_mfma_f32_32x32x16_bf16 v[116:131], v[20:23], v[32:35], v[116:131]
    ds_read_b128 v[48:51], v9 offset:61952
    ds_read_b64_tr_b16 v[40:41], v6 offset:28672
    ds_read_b64_tr_b16 v[42:43], v6 offset:29696
    v_mfma_f32_32x32x16_bf16 v[132:147], v[24:27], v[28:31], v[132:147]
    v_mfma_f32_32x32x16_bf16 v[148:163], v[24:27], v[32:35], v[148:163]
    s_waitcnt lgkmcnt(0)
    v_mfma_f32_32x32x16_bf16 v[100:115], v[36:39], v[44:47], v[100:115]
    s_barrier
    ds_read_b128 v[28:31], v10 offset:0
    ds_read_b64_tr_b16 v[20:21], v2 offset:0
    ds_read_b64_tr_b16 v[22:23], v2 offset:1024
    v_mfma_f32_32x32x16_bf16 v[116:131], v[36:39], v[48:51], v[116:131]
    ds_read_b128 v[32:35], v10 offset:512
    ds_read_b64_tr_b16 v[24:25], v5 offset:0
    ds_read_b64_tr_b16 v[26:27], v5 offset:1024
    v_mfma_f32_32x32x16_bf16 v[132:147], v[40:43], v[44:47], v[132:147]
    v_mfma_f32_32x32x16_bf16 v[148:163], v[40:43], v[48:51], v[148:163]
    s_waitcnt lgkmcnt(0)
    v_mfma_f32_32x32x16_bf16 v[100:115], v[20:23], v[28:31], v[100:115]
    ds_read_b128 v[44:47], v10 offset:4096
    ds_read_b64_tr_b16 v[36:37], v2 offset:4096
    ds_read_b64_tr_b16 v[38:39], v2 offset:5120
    v_mfma_f32_32x32x16_bf16 v[116:131], v[20:23], v[32:35], v[116:131]
    ds_read_b128 v[48:51], v10 offset:4608
    ds_read_b64_tr_b16 v[40:41], v5 offset:4096
    ds_read_b64_tr_b16 v[42:43], v5 offset:5120
    v_mfma_f32_32x32x16_bf16 v[132:147], v[24:27], v[28:31], v[132:147]
    v_mfma_f32_32x32x16_bf16 v[148:163], v[24:27], v[32:35], v[148:163]
    s_waitcnt lgkmcnt(0)
    v_mfma_f32_32x32x16_bf16 v[100:115], v[36:39], v[44:47], v[100:115]
    ds_read_b128 v[28:31], v10 offset:8192
    ds_read_b64_tr_b16 v[20:21], v2 offset:8192
    ds_read_b64_tr_b16 v[22:23], v2 offset:9216
    v_mfma_f32_32x32x16_bf16 v[116:131], v[36:39], v[48:51], v[116:131]
    ds_read_b128 v[32:35], v10 offset:8704
    ds_read_b64_tr_b16 v[24:25], v5 offset:8192
    ds_read_b64_tr_b16 v[26:27], v5 offset:9216
    v_mfma_f32_32x32x16_bf16 v[132:147], v[40:43], v[44:47], v[132:147]
    v_mfma_f32_32x32x16_bf16 v[148:163], v[40:43], v[48:51], v[148:163]
    s_waitcnt lgkmcnt(0)
    v_mfma_f32_32x32x16_bf16 v[100:115], v[20:23], v[28:31], v[100:115]
    ds_read_b128 v[44:47], v10 offset:12288
    ds_read_b64_tr_b16 v[36:37], v2 offset:12288
    ds_read_b64_tr_b16 v[38:39], v2 offset:13312
    v_mfma_f32_32x32x16_bf16 v[116:131], v[20:23], v[32:35], v[116:131]
    ds_read_b128 v[48:51], v10 offset:12800
    ds_read_b64_tr_b16 v[40:41], v5 offset:12288
    ds_read_b64_tr_b16 v[42:43], v5 offset:13312
    v_mfma_f32_32x32x16_bf16 v[132:147], v[24:27], v[28:31], v[132:147]
    v_mfma_f32_32x32x16_bf16 v[148:163], v[24:27], v[32:35], v[148:163]
    s_waitcnt lgkmcnt(0)
    v_mfma_f32_32x32x16_bf16 v[100:115], v[36:39], v[44:47], v[100:115]
    s_barrier
    ds_read_b128 v[28:31], v10 offset:16384
    ds_read_b64_tr_b16 v[20:21], v2 offset:16384
    ds_read_b64_tr_b16 v[22:23], v2 offset:17408
    v_mfma_f32_32x32x16_bf16 v[116:131], v[36:39], v[48:51], v[116:131]
    ds_read_b128 v[32:35], v10 offset:16896
    ds_read_b64_tr_b16 v[24:25], v5 offset:16384
    ds_read_b64_tr_b16 v[26:27], v5 offset:17408
    v_mfma_f32_32x32x16_bf16 v[132:147], v[40:43], v[44:47], v[132:147]
    v_mfma_f32_32x32x16_bf16 v[148:163], v[40:43], v[48:51], v[148:163]
    s_waitcnt lgkmcnt(0)
    v_mfma_f32_32x32x16_bf16 v[100:115], v[20:23], v[28:31], v[100:115]
    ds_read_b128 v[44:47], v10 offset:20480
    ds_read_b64_tr_b16 v[36:37], v2 offset:20480
    ds_read_b64_tr_b16 v[38:39], v2 offset:21504
    v_mfma_f32_32x32x16_bf16 v[116:131], v[20:23], v[32:35], v[116:131]
    ds_read_b128 v[48:51], v10 offset:20992
    ds_read_b64_tr_b16 v[40:41], v5 offset:20480
    ds_read_b64_tr_b16 v[42:43], v5 offset:21504
    v_mfma_f32_32x32x16_bf16 v[132:147], v[24:27], v[28:31], v[132:147]
    v_mfma_f32_32x32x16_bf16 v[148:163], v[24:27], v[32:35], v[148:163]
    s_waitcnt lgkmcnt(0)
    v_mfma_f32_32x32x16_bf16 v[100:115], v[36:39], v[44:47], v[100:115]
    ds_read_b128 v[28:31], v10 offset:24576
    ds_read_b64_tr_b16 v[20:21], v2 offset:24576
    ds_read_b64_tr_b16 v[22:23], v2 offset:25600
    v_mfma_f32_32x32x16_bf16 v[116:131], v[36:39], v[48:51], v[116:131]
    ds_read_b128 v[32:35], v10 offset:25088
    ds_read_b64_tr_b16 v[24:25], v5 offset:24576
    ds_read_b64_tr_b16 v[26:27], v5 offset:25600
    v_mfma_f32_32x32x16_bf16 v[132:147], v[40:43], v[44:47], v[132:147]
    v_mfma_f32_32x32x16_bf16 v[148:163], v[40:43], v[48:51], v[148:163]
    s_waitcnt lgkmcnt(0)
    v_mfma_f32_32x32x16_bf16 v[100:115], v[20:23], v[28:31], v[100:115]
    ds_read_b128 v[44:47], v10 offset:28672
    ds_read_b64_tr_b16 v[36:37], v2 offset:28672
    ds_read_b64_tr_b16 v[38:39], v2 offset:29696
    v_mfma_f32_32x32x16_bf16 v[116:131], v[20:23], v[32:35], v[116:131]
    ds_read_b128 v[48:51], v10 offset:29184
    ds_read_b64_tr_b16 v[40:41], v5 offset:28672
    ds_read_b64_tr_b16 v[42:43], v5 offset:29696
    v_mfma_f32_32x32x16_bf16 v[132:147], v[24:27], v[28:31], v[132:147]
    v_mfma_f32_32x32x16_bf16 v[148:163], v[24:27], v[32:35], v[148:163]
    s_waitcnt lgkmcnt(0)
    v_mfma_f32_32x32x16_bf16 v[100:115], v[36:39], v[44:47], v[100:115]
    s_barrier
    ds_read_b128 v[28:31], v9 offset:32768
    ds_read_b64_tr_b16 v[20:21], v2 offset:32768
    ds_read_b64_tr_b16 v[22:23], v2 offset:33792
    v_mfma_f32_32x32x16_bf16 v[116:131], v[36:39], v[48:51], v[116:131]
    ds_read_b128 v[32:35], v9 offset:33280
    ds_read_b64_tr_b16 v[24:25], v5 offset:32768
    ds_read_b64_tr_b16 v[26:27], v5 offset:33792
    v_mfma_f32_32x32x16_bf16 v[132:147], v[40:43], v[44:47], v[132:147]
    v_mfma_f32_32x32x16_bf16 v[148:163], v[40:43], v[48:51], v[148:163]
    s_waitcnt lgkmcnt(0)
    v_mfma_f32_32x32x16_bf16 v[100:115], v[20:23], v[28:31], v[100:115]
    ds_read_b128 v[44:47], v9 offset:36864
    ds_read_b64_tr_b16 v[36:37], v2 offset:36864
    ds_read_b64_tr_b16 v[38:39], v2 offset:37888
    v_mfma_f32_32x32x16_bf16 v[116:131], v[20:23], v[32:35], v[116:131]
    ds_read_b128 v[48:51], v9 offset:37376
    ds_read_b64_tr_b16 v[40:41], v5 offset:36864
    ds_read_b64_tr_b16 v[42:43], v5 offset:37888
    v_mfma_f32_32x32x16_bf16 v[132:147], v[24:27], v[28:31], v[132:147]
    v_mfma_f32_32x32x16_bf16 v[148:163], v[24:27], v[32:35], v[148:163]
    s_waitcnt lgkmcnt(0)
    v_mfma_f32_32x32x16_bf16 v[100:115], v[36:39], v[44:47], v[100:115]
    ds_read_b128 v[28:31], v9 offset:40960
    ds_read_b64_tr_b16 v[20:21], v2 offset:40960
    ds_read_b64_tr_b16 v[22:23], v2 offset:41984
    v_mfma_f32_32x32x16_bf16 v[116:131], v[36:39], v[48:51], v[116:131]
    ds_read_b128 v[32:35], v9 offset:41472
    ds_read_b64_tr_b16 v[24:25], v5 offset:40960
    ds_read_b64_tr_b16 v[26:27], v5 offset:41984
    v_mfma_f32_32x32x16_bf16 v[132:147], v[40:43], v[44:47], v[132:147]
    ds_read_b128 v[52:55], v12 offset:0
    ds_read_b128 v[68:71], v12 offset:128
    v_mfma_f32_32x32x16_bf16 v[148:163], v[40:43], v[48:51], v[148:163]
    s_waitcnt lgkmcnt(0)
    v_mfma_f32_32x32x16_bf16 v[100:115], v[20:23], v[28:31], v[100:115]
    ds_read_b128 v[44:47], v9 offset:45056
    ds_read_b64_tr_b16 v[36:37], v2 offset:45056
    ds_read_b64_tr_b16 v[38:39], v2 offset:46080
    v_mfma_f32_32x32x16_bf16 v[116:131], v[20:23], v[32:35], v[116:131]
    ds_read_b128 v[48:51], v9 offset:45568
    ds_read_b64_tr_b16 v[40:41], v5 offset:45056
    ds_read_b64_tr_b16 v[42:43], v5 offset:46080
    v_mfma_f32_32x32x16_bf16 v[132:147], v[24:27], v[28:31], v[132:147]
    ds_read_b128 v[56:59], v12 offset:32
    ds_read_b128 v[72:75], v12 offset:160
    v_mfma_f32_32x32x16_bf16 v[148:163], v[24:27], v[32:35], v[148:163]
    s_waitcnt lgkmcnt(0)
    v_mfma_f32_32x32x16_bf16 v[100:115], v[36:39], v[44:47], v[100:115]
    s_barrier
    ds_read_b128 v[28:31], v9 offset:49152
    ds_read_b64_tr_b16 v[20:21], v2 offset:49152
    ds_read_b64_tr_b16 v[22:23], v2 offset:50176
    v_mfma_f32_32x32x16_bf16 v[116:131], v[36:39], v[48:51], v[116:131]
    ds_read_b128 v[32:35], v9 offset:49664
    ds_read_b64_tr_b16 v[24:25], v5 offset:49152
    ds_read_b64_tr_b16 v[26:27], v5 offset:50176
    v_mfma_f32_32x32x16_bf16 v[132:147], v[40:43], v[44:47], v[132:147]
    v_mfma_f32_32x32x16_bf16 v[148:163], v[40:43], v[48:51], v[148:163]
    s_waitcnt lgkmcnt(0)
    ds_read_b64 v[84:85], v13 offset:0
    ds_read_b64 v[88:89], v13 offset:256
    v_mfma_f32_32x32x16_bf16 v[100:115], v[20:23], v[28:31], v[100:115]
    ds_read_b128 v[44:47], v9 offset:53248
    ds_read_b64_tr_b16 v[36:37], v2 offset:53248
    ds_read_b64_tr_b16 v[38:39], v2 offset:54272
    v_mfma_f32_32x32x16_bf16 v[116:131], v[20:23], v[32:35], v[116:131]
    ds_read_b128 v[48:51], v9 offset:53760
    ds_read_b64_tr_b16 v[40:41], v5 offset:53248
    ds_read_b64_tr_b16 v[42:43], v5 offset:54272
    v_mfma_f32_32x32x16_bf16 v[132:147], v[24:27], v[28:31], v[132:147]
    ds_read_b128 v[60:63], v12 offset:64
    ds_read_b128 v[76:79], v12 offset:192
    v_mfma_f32_32x32x16_bf16 v[148:163], v[24:27], v[32:35], v[148:163]
    s_waitcnt lgkmcnt(0)
    v_mfma_f32_32x32x16_bf16 v[100:115], v[36:39], v[44:47], v[100:115]
    ds_read_b128 v[28:31], v9 offset:57344
    ds_read_b64_tr_b16 v[20:21], v2 offset:57344
    ds_read_b64_tr_b16 v[22:23], v2 offset:58368
    v_mfma_f32_32x32x16_bf16 v[116:131], v[36:39], v[48:51], v[116:131]
    ds_read_b128 v[32:35], v9 offset:57856
    ds_read_b64_tr_b16 v[24:25], v5 offset:57344
    ds_read_b64_tr_b16 v[26:27], v5 offset:58368
    v_mfma_f32_32x32x16_bf16 v[132:147], v[40:43], v[44:47], v[132:147]
    ds_read_b128 v[64:67], v12 offset:96
    ds_read_b128 v[80:83], v12 offset:224
    v_mfma_f32_32x32x16_bf16 v[148:163], v[40:43], v[48:51], v[148:163]
    s_waitcnt lgkmcnt(0)
    v_mfma_f32_32x32x16_bf16 v[100:115], v[20:23], v[28:31], v[100:115]
    ds_read_b128 v[44:47], v9 offset:61440
    ds_read_b64_tr_b16 v[36:37], v2 offset:61440
    ds_read_b64_tr_b16 v[38:39], v2 offset:62464
    v_mfma_f32_32x32x16_bf16 v[116:131], v[20:23], v[32:35], v[116:131]
    ds_read_b128 v[48:51], v9 offset:61952
    ds_read_b64_tr_b16 v[40:41], v5 offset:61440
    ds_read_b64_tr_b16 v[42:43], v5 offset:62464
    v_mfma_f32_32x32x16_bf16 v[132:147], v[24:27], v[28:31], v[132:147]
    v_mfma_f32_32x32x16_bf16 v[148:163], v[24:27], v[32:35], v[148:163]
    s_waitcnt lgkmcnt(0)
    v_mfma_f32_32x32x16_bf16 v[100:115], v[36:39], v[44:47], v[100:115]
    s_barrier
    v_mfma_f32_32x32x16_bf16 v[116:131], v[36:39], v[48:51], v[116:131]
    v_mfma_f32_32x32x16_bf16 v[132:147], v[40:43], v[44:47], v[132:147]
    v_mfma_f32_32x32x16_bf16 v[148:163], v[40:43], v[48:51], v[148:163]
    s_waitcnt lgkmcnt(0)
    s_mov_b64 vcc, s[86:87]
    s_cmp_ge_u32 s77, 27
    s_cbranch_scc1 P3sig_51
    v_mul_f32 v86, -1.4426950408889634, v84
    v_mul_f32 v90, -1.4426950408889634, v88
    s_nop 1
    v_pk_fma_f32 v[100:101], v[52:53], v[84:85], v[100:101] op_sel:[0,1,0] op_sel_hi:[1,1,1] neg_lo:[0,1,0] neg_hi:[0,1,0]
    v_pk_fma_f32 v[102:103], v[54:55], v[84:85], v[102:103] op_sel:[0,1,0] op_sel_hi:[1,1,1] neg_lo:[0,1,0] neg_hi:[0,1,0]
    v_pk_fma_f32 v[104:105], v[56:57], v[84:85], v[104:105] op_sel:[0,1,0] op_sel_hi:[1,1,1] neg_lo:[0,1,0] neg_hi:[0,1,0]
    v_pk_fma_f32 v[106:107], v[58:59], v[84:85], v[106:107] op_sel:[0,1,0] op_sel_hi:[1,1,1] neg_lo:[0,1,0] neg_hi:[0,1,0]
    v_pk_mul_f32 v[100:101], v[100:101], v[86:87] op_sel_hi:[1,0]
    v_pk_mul_f32 v[102:103], v[102:103], v[86:87] op_sel_hi:[1,0]
    v_pk_mul_f32 v[104:105], v[104:105], v[86:87] op_sel_hi:[1,0]
    v_pk_mul_f32 v[106:107], v[106:107], v[86:87] op_sel_hi:[1,0]
    v_exp_f32 v164, v100
    v_pk_fma_f32 v[108:109], v[60:61], v[84:85], v[108:109] op_sel:[0,1,0] op_sel_hi:[1,1,1] neg_lo:[0,1,0] neg_hi:[0,1,0]
    v_exp_f32 v165, v101
    v_pk_fma_f32 v[110:111], v[62:63], v[84:85], v[110:111] op_sel:[0,1,0] op_sel_hi:[1,1,1] neg_lo:[0,1,0] neg_hi:[0,1,0]
    v_exp_f32 v166, v102
    v_pk_fma_f32 v[112:113], v[64:65], v[84:85], v[112:113] op_sel:[0,1,0] op_sel_hi:[1,1,1] neg_lo:[0,1,0] neg_hi:[0,1,0]
    v_exp_f32 v167, v103
    v_pk_fma_f32 v[114:115], v[66:67], v[84:85], v[114:115] op_sel:[0,1,0] op_sel_hi:[1,1,1] neg_lo:[0,1,0] neg_hi:[0,1,0]
    v_exp_f32 v168, v104
    v_pk_mul_f32 v[108:109], v[108:109], v[86:87] op_sel_hi:[1,0]
    v_exp_f32 v169, v105
    v_pk_mul_f32 v[110:111], v[110:111], v[86:87] op_sel_hi:[1,0]
    v_exp_f32 v170, v106
    v_pk_mul_f32 v[112:113], v[112:113], v[86:87] op_sel_hi:[1,0]
    v_exp_f32 v171, v107
    v_pk_mul_f32 v[114:115], v[114:115], v[86:87] op_sel_hi:[1,0]
    v_exp_f32 v172, v108
    v_pk_fma_f32 v[164:165], v[164:165], v[16:17], v[16:17] op_sel_hi:[1,0,0]
    v_exp_f32 v173, v109
    v_pk_fma_f32 v[166:167], v[166:167], v[16:17], v[16:17] op_sel_hi:[1,0,0]
    v_exp_f32 v174, v110
    v_pk_fma_f32 v[168:169], v[168:169], v[16:17], v[16:17] op_sel_hi:[1,0,0]
    v_exp_f32 v175, v111
    v_pk_fma_f32 v[170:171], v[170:171], v[16:17], v[16:17] op_sel_hi:[1,0,0]
    v_exp_f32 v176, v112
    v_pk_fma_f32 v[116:117], v[52:53], v[88:89], v[116:117] op_sel:[0,1,0] op_sel_hi:[1,1,1] neg_lo:[0,1,0] neg_hi:[0,1,0]
    v_exp_f32 v177, v113
    v_pk_fma_f32 v[118:119], v[54:55], v[88:89], v[118:119] op_sel:[0,1,0] op_sel_hi:[1,1,1] neg_lo:[0,1,0] neg_hi:[0,1,0]
    v_exp_f32 v178, v114
    v_pk_fma_f32 v[120:121], v[56:57], v[88:89], v[120:121] op_sel:[0,1,0] op_sel_hi:[1,1,1] neg_lo:[0,1,0] neg_hi:[0,1,0]
    v_exp_f32 v179, v115
    v_pk_fma_f32 v[122:123], v[58:59], v[88:89], v[122:123] op_sel:[0,1,0] op_sel_hi:[1,1,1] neg_lo:[0,1,0] neg_hi:[0,1,0]
    v_rcp_f32 v164, v164
    v_pk_mul_f32 v[116:117], v[116:117], v[90:91] op_sel_hi:[1,0]
    v_rcp_f32 v165, v165
    v_pk_mul_f32 v[118:119], v[118:119], v[90:91] op_sel_hi:[1,0]
    v_rcp_f32 v166, v166
    v_pk_mul_f32 v[120:121], v[120:121], v[90:91] op_sel_hi:[1,0]
    v_rcp_f32 v167, v167
    v_pk_mul_f32 v[122:123], v[122:123], v[90:91] op_sel_hi:[1,0]
    v_rcp_f32 v168, v168
    v_rcp_f32 v169, v169
    v_rcp_f32 v170, v170
    v_rcp_f32 v171, v171
    v_exp_f32 v180, v116
    v_pk_fma_f32 v[172:173], v[172:173], v[16:17], v[16:17] op_sel_hi:[1,0,0]
    v_pk_fma_f32 v[174:175], v[174:175], v[16:17], v[16:17] op_sel_hi:[1,0,0]
    v_exp_f32 v181, v117
    v_pk_fma_f32 v[176:177], v[176:177], v[16:17], v[16:17] op_sel_hi:[1,0,0]
    v_pk_fma_f32 v[178:179], v[178:179], v[16:17], v[16:17] op_sel_hi:[1,0,0]
    v_exp_f32 v182, v118
    v_pk_mul_f32 v[100:101], v[100:101], v[164:165]
    v_pk_mul_f32 v[102:103], v[102:103], v[166:167]
    v_exp_f32 v183, v119
    v_pk_mul_f32 v[104:105], v[104:105], v[168:169]
    v_pk_mul_f32 v[106:107], v[106:107], v[170:171]
    v_exp_f32 v184, v120
    v_cvt_pk_bf16_f32 v196, v100, v101
    v_cvt_pk_bf16_f32 v197, v102, v103
    v_exp_f32 v185, v121
    v_cvt_pk_bf16_f32 v198, v104, v105
    v_cvt_pk_bf16_f32 v199, v106, v107
    v_exp_f32 v186, v122
    v_permlane32_swap_b32 v196, v198
    v_permlane32_swap_b32 v197, v199
    v_exp_f32 v187, v123
    s_add_u32 s61, s60, 0
    s_cbranch_vccz slow_52
    buffer_store_dwordx4 v[196:199], v14, s[52:55], s61 offen
back_53:
    v_rcp_f32 v172, v172
    v_pk_fma_f32 v[124:125], v[60:61], v[88:89], v[124:125] op_sel:[0,1,0] op_sel_hi:[1,1,1] neg_lo:[0,1,0] neg_hi:[0,1,0]
    v_rcp_f32 v173, v173
    v_pk_fma_f32 v[126:127], v[62:63], v[88:89], v[126:127] op_sel:[0,1,0] op_sel_hi:[1,1,1] neg_lo:[0,1,0] neg_hi:[0,1,0]
    v_rcp_f32 v174, v174
    v_pk_fma_f32 v[128:129], v[64:65], v[88:89], v[128:129] op_sel:[0,1,0] op_sel_hi:[1,1,1] neg_lo:[0,1,0] neg_hi:[0,1,0]
    v_rcp_f32 v175, v175
    v_pk_fma_f32 v[130:131], v[66:67], v[88:89], v[130:131] op_sel:[0,1,0] op_sel_hi:[1,1,1] neg_lo:[0,1,0] neg_hi:[0,1,0]
    v_rcp_f32 v176, v176
    v_pk_mul_f32 v[124:125], v[124:125], v[90:91] op_sel_hi:[1,0]
    v_rcp_f32 v177, v177
    v_pk_mul_f32 v[126:127], v[126:127], v[90:91] op_sel_hi:[1,0]
    v_rcp_f32 v178, v178
    v_pk_mul_f32 v[128:129], v[128:129], v[90:91] op_sel_hi:[1,0]
    v_rcp_f32 v179, v179
    v_pk_mul_f32 v[130:131], v[130:131], v[90:91] op_sel_hi:[1,0]
    v_exp_f32 v164, v124
    v_pk_fma_f32 v[180:181], v[180:181], v[16:17], v[16:17] op_sel_hi:[1,0,0]
    v_pk_fma_f32 v[182:183], v[182:183], v[16:17], v[16:17] op_sel_hi:[1,0,0]
    v_exp_f32 v165, v125
    v_pk_fma_f32 v[184:185], v[184:185], v[16:17], v[16:17] op_sel_hi:[1,0,0]
    v_pk_fma_f32 v[186:187], v[186:187], v[16:17], v[16:17] op_sel_hi:[1,0,0]
    v_exp_f32 v166, v126
    v_pk_mul_f32 v[108:109], v[108:109], v[172:173]
    v_pk_mul_f32 v[110:111], v[110:111], v[174:175]
    v_exp_f32 v167, v127
    v_pk_mul_f32 v[112:113], v[112:113], v[176:177]
    v_pk_mul_f32 v[114:115], v[114:115], v[178:179]
    v_exp_f32 v168, v128
    v_cvt_pk_bf16_f32 v200, v108, v109
    v_cvt_pk_bf16_f32 v201, v110, v111
    v_exp_f32 v169, v129
    v_cvt_pk_bf16_f32 v202, v112, v113
    v_cvt_pk_bf16_f32 v203, v114, v115
    v_exp_f32 v170, v130
    v_permlane32_swap_b32 v200, v202
    v_permlane32_swap_b32 v201, v203
    v_exp_f32 v171, v131
    s_add_u32 s61, s60, 8192
    s_cbranch_vccz slow_54
    buffer_store_dwordx4 v[200:203], v14, s[52:55], s61 offen
back_55:
    v_rcp_f32 v180, v180
    v_pk_fma_f32 v[132:133], v[68:69], v[84:85], v[132:133] op_sel:[0,1,0] op_sel_hi:[1,1,1] neg_lo:[0,1,0] neg_hi:[0,1,0]
    v_rcp_f32 v181, v181
    v_pk_fma_f32 v[134:135], v[70:71], v[84:85], v[134:135] op_sel:[0,1,0] op_sel_hi:[1,1,1] neg_lo:[0,1,0] neg_hi:[0,1,0]
    v_rcp_f32 v182, v182
    v_pk_fma_f32 v[136:137], v[72:73], v[84:85], v[136:137] op_sel:[0,1,0] op_sel_hi:[1,1,1] neg_lo:[0,1,0] neg_hi:[0,1,0]
    v_rcp_f32 v183, v183
    v_pk_fma_f32 v[138:139], v[74:75], v[84:85], v[138:139] op_sel:[0,1,0] op_sel_hi:[1,1,1] neg_lo:[0,1,0] neg_hi:[0,1,0]
    v_rcp_f32 v184, v184
    v_pk_mul_f32 v[132:133], v[132:133], v[86:87] op_sel_hi:[1,0]
    v_rcp_f32 v185, v185
    v_pk_mul_f32 v[134:135], v[134:135], v[86:87] op_sel_hi:[1,0]
    v_rcp_f32 v186, v186
    v_pk_mul_f32 v[136:137], v[136:137], v[86:87] op_sel_hi:[1,0]
    v_rcp_f32 v187, v187
    v_pk_mul_f32 v[138:139], v[138:139], v[86:87] op_sel_hi:[1,0]
    v_exp_f32 v172, v132
    v_pk_fma_f32 v[164:165], v[164:165], v[16:17], v[16:17] op_sel_hi:[1,0,0]
    v_pk_fma_f32 v[166:167], v[166:167], v[16:17], v[16:17] op_sel_hi:[1,0,0]
    v_exp_f32 v173, v133
    v_pk_fma_f32 v[168:169], v[168:169], v[16:17], v[16:17] op_sel_hi:[1,0,0]
    v_pk_fma_f32 v[170:171], v[170:171], v[16:17], v[16:17] op_sel_hi:[1,0,0]
    v_exp_f32 v174, v134
    v_pk_mul_f32 v[116:117], v[116:117], v[180:181]
    v_pk_mul_f32 v[118:119], v[118:119], v[182:183]
    v_exp_f32 v175, v135
    v_pk_mul_f32 v[120:121], v[120:121], v[184:185]
    v_pk_mul_f32 v[122:123], v[122:123], v[186:187]
    v_exp_f32 v176, v136
    v_cvt_pk_bf16_f32 v196, v116, v117
    v_cvt_pk_bf16_f32 v197, v118, v119
    v_exp_f32 v177, v137
    v_cvt_pk_bf16_f32 v198, v120, v121
    v_cvt_pk_bf16_f32 v199, v122, v123
    v_exp_f32 v178, v138
    v_permlane32_swap_b32 v196, v198
    v_permlane32_swap_b32 v197, v199
    v_exp_f32 v179, v139
    s_add_u32 s61, s60, 512
    s_cbranch_vccz slow_56
    buffer_store_dwordx4 v[196:199], v14, s[52:55], s61 offen
back_57:
    v_rcp_f32 v164, v164
    v_pk_fma_f32 v[140:141], v[76:77], v[84:85], v[140:141] op_sel:[0,1,0] op_sel_hi:[1,1,1] neg_lo:[0,1,0] neg_hi:[0,1,0]
    v_rcp_f32 v165, v165
    v_pk_fma_f32 v[142:143], v[78:79], v[84:85], v[142:143] op_sel:[0,1,0] op_sel_hi:[1,1,1] neg_lo:[0,1,0] neg_hi:[0,1,0]
    v_rcp_f32 v166, v166
    v_pk_fma_f32 v[144:145], v[80:81], v[84:85], v[144:145] op_sel:[0,1,0] op_sel_hi:[1,1,1] neg_lo:[0,1,0] neg_hi:[0,1,0]
    v_rcp_f32 v167, v167
    v_pk_fma_f32 v[146:147], v[82:83], v[84:85], v[146:147] op_sel:[0,1,0] op_sel_hi:[1,1,1] neg_lo:[0,1,0] neg_hi:[0,1,0]
    v_rcp_f32 v168, v168
    v_pk_mul_f32 v[140:141], v[140:141], v[86:87] op_sel_hi:[1,0]
    v_rcp_f32 v169, v169
    v_pk_mul_f32 v[142:143], v[142:143], v[86:87] op_sel_hi:[1,0]
    v_rcp_f32 v170, v170
    v_pk_mul_f32 v[144:145], v[144:145], v[86:87] op_sel_hi:[1,0]
    v_rcp_f32 v171, v171
    v_pk_mul_f32 v[146:147], v[146:147], v[86:87] op_sel_hi:[1,0]
    v_exp_f32 v180, v140
    v_pk_fma_f32 v[172:173], v[172:173], v[16:17], v[16:17] op_sel_hi:[1,0,0]
    v_pk_fma_f32 v[174:175], v[174:175], v[16:17], v[16:17] op_sel_hi:[1,0,0]
    v_exp_f32 v181, v141
    v_pk_fma_f32 v[176:177], v[176:177], v[16:17], v[16:17] op_sel_hi:[1,0,0]
    v_pk_fma_f32 v[178:179], v[178:179], v[16:17], v[16:17] op_sel_hi:[1,0,0]
    v_exp_f32 v182, v142
    v_pk_mul_f32 v[124:125], v[124:125], v[164:165]
    v_pk_mul_f32 v[126:127], v[126:127], v[166:167]
    v_exp_f32 v183, v143
    v_pk_mul_f32 v[128:129], v[128:129], v[168:169]
    v_pk_mul_f32 v[130:131], v[130:131], v[170:171]
    v_exp_f32 v184, v144
    v_cvt_pk_bf16_f32 v200, v124, v125
    v_cvt_pk_bf16_f32 v201, v126, v127
    v_exp_f32 v185, v145
    v_cvt_pk_bf16_f32 v202, v128, v129
    v_cvt_pk_bf16_f32 v203, v130, v131
    v_exp_f32 v186, v146
    v_permlane32_swap_b32 v200, v202
    v_permlane32_swap_b32 v201, v203
    v_exp_f32 v187, v147
    s_add_u32 s61, s60, 8704
    s_cbranch_vccz slow_58
    buffer_store_dwordx4 v[200:203], v14, s[52:55], s61 offen
back_59:
    v_rcp_f32 v172, v172
    v_pk_fma_f32 v[148:149], v[68:69], v[88:89], v[148:149] op_sel:[0,1,0] op_sel_hi:[1,1,1] neg_lo:[0,1,0] neg_hi:[0,1,0]
    v_rcp_f32 v173, v173
    v_pk_fma_f32 v[150:151], v[70:71], v[88:89], v[150:151] op_sel:[0,1,0] op_sel_hi:[1,1,1] neg_lo:[0,1,0] neg_hi:[0,1,0]
    v_rcp_f32 v174, v174
    v_pk_fma_f32 v[152:153], v[72:73], v[88:89], v[152:153] op_sel:[0,1,0] op_sel_hi:[1,1,1] neg_lo:[0,1,0] neg_hi:[0,1,0]
    v_rcp_f32 v175, v175
    v_pk_fma_f32 v[154:155], v[74:75], v[88:89], v[154:155] op_sel:[0,1,0] op_sel_hi:[1,1,1] neg_lo:[0,1,0] neg_hi:[0,1,0]
    v_rcp_f32 v176, v176
    v_pk_mul_f32 v[148:149], v[148:149], v[90:91] op_sel_hi:[1,0]
    v_rcp_f32 v177, v177
    v_pk_mul_f32 v[150:151], v[150:151], v[90:91] op_sel_hi:[1,0]
    v_rcp_f32 v178, v178
    v_pk_mul_f32 v[152:153], v[152:153], v[90:91] op_sel_hi:[1,0]
    v_rcp_f32 v179, v179
    v_pk_mul_f32 v[154:155], v[154:155], v[90:91] op_sel_hi:[1,0]
    v_exp_f32 v164, v148
    v_pk_fma_f32 v[180:181], v[180:181], v[16:17], v[16:17] op_sel_hi:[1,0,0]
    v_pk_fma_f32 v[182:183], v[182:183], v[16:17], v[16:17] op_sel_hi:[1,0,0]
    v_exp_f32 v165, v149
    v_pk_fma_f32 v[184:185], v[184:185], v[16:17], v[16:17] op_sel_hi:[1,0,0]
    v_pk_fma_f32 v[186:187], v[186:187], v[16:17], v[16:17] op_sel_hi:[1,0,0]
    v_exp_f32 v166, v150
    v_pk_mul_f32 v[132:133], v[132:133], v[172:173]
    v_pk_mul_f32 v[134:135], v[134:135], v[174:175]
    v_exp_f32 v167, v151
    v_pk_mul_f32 v[136:137], v[136:137], v[176:177]
    v_pk_mul_f32 v[138:139], v[138:139], v[178:179]
    v_exp_f32 v168, v152
    v_cvt_pk_bf16_f32 v196, v132, v133
    v_cvt_pk_bf16_f32 v197, v134, v135
    v_exp_f32 v169, v153
    v_cvt_pk_bf16_f32 v198, v136, v137
    v_cvt_pk_bf16_f32 v199, v138, v139
    v_exp_f32 v170, v154
    v_permlane32_swap_b32 v196, v198
    v_permlane32_swap_b32 v197, v199
    v_exp_f32 v171, v155
    s_add_u32 s61, s60, 16384
    s_cbranch_vccz slow_60
    buffer_store_dwordx4 v[196:199], v14, s[52:55], s61 offen
back_61:
    v_rcp_f32 v180, v180
    v_pk_fma_f32 v[156:157], v[76:77], v[88:89], v[156:157] op_sel:[0,1,0] op_sel_hi:[1,1,1] neg_lo:[0,1,0] neg_hi:[0,1,0]
    v_rcp_f32 v181, v181
    v_pk_fma_f32 v[158:159], v[78:79], v[88:89], v[158:159] op_sel:[0,1,0] op_sel_hi:[1,1,1] neg_lo:[0,1,0] neg_hi:[0,1,0]
    v_rcp_f32 v182, v182
    v_pk_fma_f32 v[160:161], v[80:81], v[88:89], v[160:161] op_sel:[0,1,0] op_sel_hi:[1,1,1] neg_lo:[0,1,0] neg_hi:[0,1,0]
    v_rcp_f32 v183, v183
    v_pk_fma_f32 v[162:163], v[82:83], v[88:89], v[162:163] op_sel:[0,1,0] op_sel_hi:[1,1,1] neg_lo:[0,1,0] neg_hi:[0,1,0]
    v_rcp_f32 v184, v184
    v_pk_mul_f32 v[156:157], v[156:157], v[90:91] op_sel_hi:[1,0]
    v_rcp_f32 v185, v185
    v_pk_mul_f32 v[158:159], v[158:159], v[90:91] op_sel_hi:[1,0]
    v_rcp_f32 v186, v186
    v_pk_mul_f32 v[160:161], v[160:161], v[90:91] op_sel_hi:[1,0]
    v_rcp_f32 v187, v187
    v_pk_mul_f32 v[162:163], v[162:163], v[90:91] op_sel_hi:[1,0]
    v_exp_f32 v172, v156
    v_pk_fma_f32 v[164:165], v[164:165], v[16:17], v[16:17] op_sel_hi:[1,0,0]
    v_exp_f32 v173, v157
    v_pk_fma_f32 v[166:167], v[166:167], v[16:17], v[16:17] op_sel_hi:[1,0,0]
    v_exp_f32 v174, v158
    v_pk_fma_f32 v[168:169], v[168:169], v[16:17], v[16:17] op_sel_hi:[1,0,0]
    v_exp_f32 v175, v159
    v_pk_fma_f32 v[170:171], v[170:171], v[16:17], v[16:17] op_sel_hi:[1,0,0]
    v_exp_f32 v176, v160
    v_pk_mul_f32 v[140:141], v[140:141], v[180:181]
    v_exp_f32 v177, v161
    v_pk_mul_f32 v[142:143], v[142:143], v[182:183]
    v_exp_f32 v178, v162
    v_pk_mul_f32 v[144:145], v[144:145], v[184:185]
    v_exp_f32 v179, v163
    v_pk_mul_f32 v[146:147], v[146:147], v[186:187]
    v_rcp_f32 v164, v164
    v_cvt_pk_bf16_f32 v200, v140, v141
    v_rcp_f32 v165, v165
    v_cvt_pk_bf16_f32 v201, v142, v143
    v_rcp_f32 v166, v166
    v_cvt_pk_bf16_f32 v202, v144, v145
    v_rcp_f32 v167, v167
    v_cvt_pk_bf16_f32 v203, v146, v147
    v_rcp_f32 v168, v168
    v_permlane32_swap_b32 v200, v202
    v_rcp_f32 v169, v169
    v_permlane32_swap_b32 v201, v203
    v_rcp_f32 v170, v170
    s_add_u32 s61, s60, 24576
    s_cbranch_vccz slow_62
    buffer_store_dwordx4 v[200:203], v14, s[52:55], s61 offen
back_63:
    v_rcp_f32 v171, v171
    v_pk_fma_f32 v[172:173], v[172:173], v[16:17], v[16:17] op_sel_hi:[1,0,0]
    v_pk_fma_f32 v[174:175], v[174:175], v[16:17], v[16:17] op_sel_hi:[1,0,0]
    v_pk_fma_f32 v[176:177], v[176:177], v[16:17], v[16:17] op_sel_hi:[1,0,0]
    v_pk_fma_f32 v[178:179], v[178:179], v[16:17], v[16:17] op_sel_hi:[1,0,0]
    v_rcp_f32 v172, v172
    v_pk_mul_f32 v[148:149], v[148:149], v[164:165]
    v_pk_mul_f32 v[150:151], v[150:151], v[166:167]
    v_rcp_f32 v173, v173
    v_pk_mul_f32 v[152:153], v[152:153], v[168:169]
    v_pk_mul_f32 v[154:155], v[154:155], v[170:171]
    v_rcp_f32 v174, v174
    v_cvt_pk_bf16_f32 v196, v148, v149
    v_cvt_pk_bf16_f32 v197, v150, v151
    v_rcp_f32 v175, v175
    v_cvt_pk_bf16_f32 v198, v152, v153
    v_rcp_f32 v176, v176
    v_cvt_pk_bf16_f32 v199, v154, v155
    v_rcp_f32 v177, v177
    v_permlane32_swap_b32 v196, v198
    v_rcp_f32 v178, v178
    v_permlane32_swap_b32 v197, v199
    v_rcp_f32 v179, v179
    s_add_u32 s61, s60, 16896
    s_cbranch_vccz slow_64
    buffer_store_dwordx4 v[196:199], v14, s[52:55], s61 offen
back_65:
    v_pk_mul_f32 v[156:157], v[156:157], v[172:173]
    v_pk_mul_f32 v[158:159], v[158:159], v[174:175]
    v_pk_mul_f32 v[160:161], v[160:161], v[176:177]
    v_pk_mul_f32 v[162:163], v[162:163], v[178:179]
    v_cvt_pk_bf16_f32 v200, v156, v157
    v_cvt_pk_bf16_f32 v201, v158, v159
    v_cvt_pk_bf16_f32 v202, v160, v161
    v_cvt_pk_bf16_f32 v203, v162, v163
    s_nop 0
    v_permlane32_swap_b32 v200, v202
    v_permlane32_swap_b32 v201, v203
    s_add_u32 s61, s60, 25088
    s_cbranch_vccz slow_66
    buffer_store_dwordx4 v[200:203], v14, s[52:55], s61 offen
back_67:
P3sig_51:
    s_mul_i32 s61, s57, 64
    s_lshl_b32 s3, s23, 2
    s_add_u32 s61, s61, s3
    s_add_u32 s61, s61, 1646592
    v_mov_b32 v3, 1
    s_waitcnt vmcnt(0)
    s_mov_b64 exec, 1
    s_cbranch_vccz slow_68
    buffer_store_dword v3, off, s[52:55], s61
back_69:
    s_mov_b64 exec, -1
Lskip3c:
    s_lshr_b32 s70, s23, 1
    s_and_b32 s71, s23, 1
    v_lshrrev_b32 v11, 3, v1
    v_and_b32 v11, 3, v11
    s_lshl_b32 s3, s71, 1
    v_xor_b32 v11, s3, v11
    v_lshrrev_b32 v2, 2, v1
    v_lshlrev_b32 v2, 7, v2
    v_and_b32 v3, 3, v1
    v_lshl_add_u32 v2, v3, 3, v2
    v_xor_b32 v3, 1, v11
    v_lshl_add_u32 v5, v3, 5, v2
    v_lshl_add_u32 v2, v11, 5, v2
    v_add_u32 v3, 0x10000, v2
    v_add_u32 v4, 0x20000, v2
    v_add_u32 v6, 0x10000, v5
    v_add_u32 v7, 0x20000, v5
    v_lshrrev_b32 v8, 4, v1
    v_mul_u32_u24 v8, 1536, v8
    v_and_b32 v11, 15, v1
    v_lshl_add_u32 v8, v11, 4, v8
    s_mul_i32 s3, s70, 768
    v_add_u32 v8, s3, v8
    v_add_u32 v9, 0x10000, v8
    v_add_u32 v10, 0x20000, v8
    v_and_b32 v12, 15, v1
    s_mul_i32 s3, s70, 48
    v_add_u32 v12, s3, v12
    v_lshrrev_b32 v13, 4, v1
    v_and_b32 v14, 1, v13
    v_lshlrev_b32 v14, 1, v14
    v_lshrrev_b32 v11, 1, v13
    v_add_u32 v14, v14, v11
    s_lshl_b32 s3, s71, 2
    v_add_u32 v14, s3, v14
    v_add_u32 v11, 0, v12
    v_cmp_gt_u32 vcc, s69, v11
    v_add_u32 v11, s68, v11
    v_mul_u32_u24 v11, 1280, v11
    v_lshl_add_u32 v11, v14, 4, v11
    s_lshl_b32 s3, s67, 7
    v_add_u32 v11, s3, v11
    v_mov_b32 v16, 2147483648
    v_cndmask_b32 v16, v16, v11, vcc
    v_add_u32 v11, 16, v12
    v_cmp_gt_u32 vcc, s69, v11
    v_add_u32 v11, s68, v11
    v_mul_u32_u24 v11, 1280, v11
    v_lshl_add_u32 v11, v14, 4, v11
    s_lshl_b32 s3, s67, 7
    v_add_u32 v11, s3, v11
    v_mov_b32 v17, 2147483648
    v_cndmask_b32 v17, v17, v11, vcc
    v_add_u32 v11, 32, v12
    v_cmp_gt_u32 vcc, s69, v11
    v_add_u32 v11, s68, v11
    v_mul_u32_u24 v11, 1280, v11
    v_lshl_add_u32 v11, v14, 4, v11
    s_lshl_b32 s3, s67, 7
    v_add_u32 v11, s3, v11
    v_mov_b32 v18, 2147483648
    v_cndmask_b32 v18, v18, v11, vcc
    s_waitcnt vmcnt(0)
    v_lshlrev_b32 v100, 16, v240
    v_and_b32 v101, 0xffff0000, v240
    v_lshlrev_b32 v102, 16, v241
    v_and_b32 v103, 0xffff0000, v241
    v_lshlrev_b32 v104, 16, v242
    v_and_b32 v105, 0xffff0000, v242
    v_lshlrev_b32 v106, 16, v243
    v_and_b32 v107, 0xffff0000, v243
    v_permlane16_swap_b32 v100, v104
    v_permlane16_swap_b32 v101, v105
    v_permlane16_swap_b32 v102, v106
    v_permlane16_swap_b32 v103, v107
    v_lshlrev_b32 v108, 16, v244
    v_and_b32 v109, 0xffff0000, v244
    v_lshlrev_b32 v110, 16, v245
    v_and_b32 v111, 0xffff0000, v245
    v_lshlrev_b32 v112, 16, v246
    v_and_b32 v113, 0xffff0000, v246
    v_lshlrev_b32 v114, 16, v247
    v_and_b32 v115, 0xffff0000, v247
    v_permlane16_swap_b32 v108, v112
    v_permlane16_swap_b32 v109, v113
    v_permlane16_swap_b32 v110, v114
    v_permlane16_swap_b32 v111, v115
    v_lshlrev_b32 v116, 16, v248
    v_and_b32 v117, 0xffff0000, v248
    v_lshlrev_b32 v118, 16, v249
    v_and_b32 v119, 0xffff0000, v249
    v_lshlrev_b32 v120, 16, v250
    v_and_b32 v121, 0xffff0000, v250
    v_lshlrev_b32 v122, 16, v251
    v_and_b32 v123, 0xffff0000, v251
    v_permlane16_swap_b32 v116, v120
    v_permlane16_swap_b32 v117, v121
    v_permlane16_swap_b32 v118, v122
    v_permlane16_swap_b32 v119, v123
    s_barrier
    ds_read_b64_tr_b16 v[20:21], v3 offset:8192
    ds_read_b128 v[28:31], v9 offset:36864
    ds_read_b64_tr_b16 v[22:23], v3 offset:10240
    ds_read_b128 v[32:35], v9 offset:37120
    ds_read_b64_tr_b16 v[24:25], v6 offset:8192
    ds_read_b64_tr_b16 v[26:27], v6 offset:10240
    ds_read_b128 v[36:39], v9 offset:37376
    ds_read_b64_tr_b16 v[40:41], v3 offset:12288
    ds_read_b128 v[48:51], v9 offset:43008
    ds_read_b64_tr_b16 v[42:43], v3 offset:14336
    ds_read_b128 v[52:55], v9 offset:43264
    ds_read_b64_tr_b16 v[44:45], v6 offset:12288
    ds_read_b64_tr_b16 v[46:47], v6 offset:14336
    ds_read_b128 v[56:59], v9 offset:43520
    s_barrier
    s_waitcnt lgkmcnt(7)
    v_mfma_f32_16x16x32_bf16 v[100:103], v[20:23], v[28:31], v[100:103]
    ds_read_b64_tr_b16 v[60:61], v3 offset:16384
    v_mfma_f32_16x16x32_bf16 v[108:111], v[20:23], v[32:35], v[108:111]
    ds_read_b128 v[68:71], v9 offset:49152
    v_mfma_f32_16x16x32_bf16 v[116:119], v[20:23], v[36:39], v[116:119]
    ds_read_b64_tr_b16 v[62:63], v3 offset:18432
    v_mfma_f32_16x16x32_bf16 v[104:107], v[24:27], v[28:31], v[104:107]
    ds_read_b128 v[72:75], v9 offset:49408
    v_mfma_f32_16x16x32_bf16 v[112:115], v[24:27], v[32:35], v[112:115]
    ds_read_b64_tr_b16 v[64:65], v6 offset:16384
    v_mfma_f32_16x16x32_bf16 v[120:123], v[24:27], v[36:39], v[120:123]
    ds_read_b64_tr_b16 v[66:67], v6 offset:18432
    ds_read_b128 v[76:79], v9 offset:49664
    s_waitcnt lgkmcnt(7)
    v_mfma_f32_16x16x32_bf16 v[100:103], v[40:43], v[48:51], v[100:103]
    ds_read_b64_tr_b16 v[80:81], v3 offset:20480
    v_mfma_f32_16x16x32_bf16 v[108:111], v[40:43], v[52:55], v[108:111]
    ds_read_b128 v[88:91], v9 offset:55296
    v_mfma_f32_16x16x32_bf16 v[116:119], v[40:43], v[56:59], v[116:119]
    ds_read_b64_tr_b16 v[82:83], v3 offset:22528
    v_mfma_f32_16x16x32_bf16 v[104:107], v[44:47], v[48:51], v[104:107]
    ds_read_b128 v[92:95], v9 offset:55552
    v_mfma_f32_16x16x32_bf16 v[112:115], v[44:47], v[52:55], v[112:115]
    ds_read_b64_tr_b16 v[84:85], v6 offset:20480
    v_mfma_f32_16x16x32_bf16 v[120:123], v[44:47], v[56:59], v[120:123]
    ds_read_b64_tr_b16 v[86:87], v6 offset:22528
    ds_read_b128 v[96:99], v9 offset:55808
    s_barrier
    s_waitcnt lgkmcnt(7)
    v_mfma_f32_16x16x32_bf16 v[100:103], v[60:63], v[68:71], v[100:103]
    ds_read_b64_tr_b16 v[20:21], v3 offset:24576
    v_mfma_f32_16x16x32_bf16 v[108:111], v[60:63], v[72:75], v[108:111]
    ds_read_b128 v[28:31], v9 offset:61440
    v_mfma_f32_16x16x32_bf16 v[116:119], v[60:63], v[76:79], v[116:119]
    ds_read_b64_tr_b16 v[22:23], v3 offset:26624
    v_mfma_f32_16x16x32_bf16 v[104:107], v[64:67], v[68:71], v[104:107]
    ds_read_b128 v[32:35], v9 offset:61696
    v_mfma_f32_16x16x32_bf16 v[112:115], v[64:67], v[72:75], v[112:115]
    ds_read_b64_tr_b16 v[24:25], v6 offset:24576
    v_mfma_f32_16x16x32_bf16 v[120:123], v[64:67], v[76:79], v[120:123]
    ds_read_b64_tr_b16 v[26:27], v6 offset:26624
    ds_read_b128 v[36:39], v9 offset:61952
    s_waitcnt lgkmcnt(7)
    v_mfma_f32_16x16x32_bf16 v[100:103], v[80:83], v[88:91], v[100:103]
    ds_read_b64_tr_b16 v[40:41], v3 offset:28672
    v_mfma_f32_16x16x32_bf16 v[108:111], v[80:83], v[92:95], v[108:111]
    ds_read_b128 v[48:51], v10 offset:2048
    v_mfma_f32_16x16x32_bf16 v[116:119], v[80:83], v[96:99], v[116:119]
    ds_read_b64_tr_b16 v[42:43], v3 offset:30720
    v_mfma_f32_16x16x32_bf16 v[104:107], v[84:87], v[88:91], v[104:107]
    ds_read_b128 v[52:55], v10 offset:2304
    v_mfma_f32_16x16x32_bf16 v[112:115], v[84:87], v[92:95], v[112:115]
    ds_read_b64_tr_b16 v[44:45], v6 offset:28672
    v_mfma_f32_16x16x32_bf16 v[120:123], v[84:87], v[96:99], v[120:123]
    ds_read_b64_tr_b16 v[46:47], v6 offset:30720
    ds_read_b128 v[56:59], v10 offset:2560
    s_barrier
    s_waitcnt lgkmcnt(7)
    v_mfma_f32_16x16x32_bf16 v[100:103], v[20:23], v[28:31], v[100:103]
    ds_read_b64_tr_b16 v[60:61], v2 offset:0
    v_mfma_f32_16x16x32_bf16 v[108:111], v[20:23], v[32:35], v[108:111]
    ds_read_b128 v[68:71], v10 offset:8192
    v_mfma_f32_16x16x32_bf16 v[116:119], v[20:23], v[36:39], v[116:119]
    ds_read_b64_tr_b16 v[62:63], v2 offset:2048
    v_mfma_f32_16x16x32_bf16 v[104:107], v[24:27], v[28:31], v[104:107]
    ds_read_b128 v[72:75], v10 offset:8448
    v_mfma_f32_16x16x32_bf16 v[112:115], v[24:27], v[32:35], v[112:115]
    ds_read_b64_tr_b16 v[64:65], v5 offset:0
    v_mfma_f32_16x16x32_bf16 v[120:123], v[24:27], v[36:39], v[120:123]
    ds_read_b64_tr_b16 v[66:67], v5 offset:2048
    ds_read_b128 v[76:79], v10 offset:8704
    s_waitcnt lgkmcnt(7)
    v_mfma_f32_16x16x32_bf16 v[100:103], v[40:43], v[48:51], v[100:103]
    ds_read_b64_tr_b16 v[80:81], v2 offset:4096
    v_mfma_f32_16x16x32_bf16 v[108:111], v[40:43], v[52:55], v[108:111]
    ds_read_b128 v[88:91], v10 offset:14336
    v_mfma_f32_16x16x32_bf16 v[116:119], v[40:43], v[56:59], v[116:119]
    ds_read_b64_tr_b16 v[82:83], v2 offset:6144
    v_mfma_f32_16x16x32_bf16 v[104:107], v[44:47], v[48:51], v[104:107]
    ds_read_b128 v[92:95], v10 offset:14592
    v_mfma_f32_16x16x32_bf16 v[112:115], v[44:47], v[52:55], v[112:115]
    ds_read_b64_tr_b16 v[84:85], v5 offset:4096
    v_mfma_f32_16x16x32_bf16 v[120:123], v[44:47], v[56:59], v[120:123]
    ds_read_b64_tr_b16 v[86:87], v5 offset:6144
    ds_read_b128 v[96:99], v10 offset:14848
    s_barrier
    s_waitcnt lgkmcnt(7)
    v_mfma_f32_16x16x32_bf16 v[100:103], v[60:63], v[68:71], v[100:103]
    ds_read_b64_tr_b16 v[20:21], v2 offset:8192
    v_mfma_f32_16x16x32_bf16 v[108:111], v[60:63], v[72:75], v[108:111]
    ds_read_b128 v[28:31], v10 offset:20480
    v_mfma_f32_16x16x32_bf16 v[116:119], v[60:63], v[76:79], v[116:119]
    ds_read_b64_tr_b16 v[22:23], v2 offset:10240
    v_mfma_f32_16x16x32_bf16 v[104:107], v[64:67], v[68:71], v[104:107]
    ds_read_b128 v[32:35], v10 offset:20736
    v_mfma_f32_16x16x32_bf16 v[112:115], v[64:67], v[72:75], v[112:115]
    ds_read_b64_tr_b16 v[24:25], v5 offset:8192
    v_mfma_f32_16x16x32_bf16 v[120:123], v[64:67], v[76:79], v[120:123]
    ds_read_b64_tr_b16 v[26:27], v5 offset:10240
    ds_read_b128 v[36:39], v10 offset:20992
    s_waitcnt lgkmcnt(7)
    v_mfma_f32_16x16x32_bf16 v[100:103], v[80:83], v[88:91], v[100:103]
    ds_read_b64_tr_b16 v[40:41], v2 offset:12288
    v_mfma_f32_16x16x32_bf16 v[108:111], v[80:83], v[92:95], v[108:111]
    ds_read_b128 v[48:51], v10 offset:26624
    v_mfma_f32_16x16x32_bf16 v[116:119], v[80:83], v[96:99], v[116:119]
    ds_read_b64_tr_b16 v[42:43], v2 offset:14336
    v_mfma_f32_16x16x32_bf16 v[104:107], v[84:87], v[88:91], v[104:107]
    ds_read_b128 v[52:55], v10 offset:26880
    v_mfma_f32_16x16x32_bf16 v[112:115], v[84:87], v[92:95], v[112:115]
    ds_read_b64_tr_b16 v[44:45], v5 offset:12288
    v_mfma_f32_16x16x32_bf16 v[120:123], v[84:87], v[96:99], v[120:123]
    ds_read_b64_tr_b16 v[46:47], v5 offset:14336
    ds_read_b128 v[56:59], v10 offset:27136
    s_barrier
    s_waitcnt lgkmcnt(7)
    v_mfma_f32_16x16x32_bf16 v[100:103], v[20:23], v[28:31], v[100:103]
    ds_read_b64_tr_b16 v[60:61], v2 offset:16384
    v_mfma_f32_16x16x32_bf16 v[108:111], v[20:23], v[32:35], v[108:111]
    ds_read_b128 v[68:71], v9 offset:36864
    v_mfma_f32_16x16x32_bf16 v[116:119], v[20:23], v[36:39], v[116:119]
    ds_read_b64_tr_b16 v[62:63], v2 offset:18432
    v_mfma_f32_16x16x32_bf16 v[104:107], v[24:27], v[28:31], v[104:107]
    ds_read_b128 v[72:75], v9 offset:37120
    v_mfma_f32_16x16x32_bf16 v[112:115], v[24:27], v[32:35], v[112:115]
    ds_read_b64_tr_b16 v[64:65], v5 offset:16384
    v_mfma_f32_16x16x32_bf16 v[120:123], v[24:27], v[36:39], v[120:123]
    ds_read_b64_tr_b16 v[66:67], v5 offset:18432
    ds_read_b128 v[76:79], v9 offset:37376
    s_waitcnt lgkmcnt(7)
    v_mfma_f32_16x16x32_bf16 v[100:103], v[40:43], v[48:51], v[100:103]
    ds_read_b64_tr_b16 v[80:81], v2 offset:20480
    v_mfma_f32_16x16x32_bf16 v[108:111], v[40:43], v[52:55], v[108:111]
    ds_read_b128 v[88:91], v9 offset:43008
    v_mfma_f32_16x16x32_bf16 v[116:119], v[40:43], v[56:59], v[116:119]
    ds_read_b64_tr_b16 v[82:83], v2 offset:22528
    v_mfma_f32_16x16x32_bf16 v[104:107], v[44:47], v[48:51], v[104:107]
    ds_read_b128 v[92:95], v9 offset:43264
    v_mfma_f32_16x16x32_bf16 v[112:115], v[44:47], v[52:55], v[112:115]
    ds_read_b64_tr_b16 v[84:85], v5 offset:20480
    v_mfma_f32_16x16x32_bf16 v[120:123], v[44:47], v[56:59], v[120:123]
    ds_read_b64_tr_b16 v[86:87], v5 offset:22528
    ds_read_b128 v[96:99], v9 offset:43520
    s_barrier
    s_waitcnt lgkmcnt(7)
    v_mfma_f32_16x16x32_bf16 v[100:103], v[60:63], v[68:71], v[100:103]
    ds_read_b64_tr_b16 v[20:21], v2 offset:24576
    v_mfma_f32_16x16x32_bf16 v[108:111], v[60:63], v[72:75], v[108:111]
    ds_read_b128 v[28:31], v9 offset:49152
    v_mfma_f32_16x16x32_bf16 v[116:119], v[60:63], v[76:79], v[116:119]
    ds_read_b64_tr_b16 v[22:23], v2 offset:26624
    v_mfma_f32_16x16x32_bf16 v[104:107], v[64:67], v[68:71], v[104:107]
    ds_read_b128 v[32:35], v9 offset:49408
    v_mfma_f32_16x16x32_bf16 v[112:115], v[64:67], v[72:75], v[112:115]
    ds_read_b64_tr_b16 v[24:25], v5 offset:24576
    v_mfma_f32_16x16x32_bf16 v[120:123], v[64:67], v[76:79], v[120:123]
    ds_read_b64_tr_b16 v[26:27], v5 offset:26624
    ds_read_b128 v[36:39], v9 offset:49664
    s_waitcnt lgkmcnt(7)
    v_mfma_f32_16x16x32_bf16 v[100:103], v[80:83], v[88:91], v[100:103]
    ds_read_b64_tr_b16 v[40:41], v2 offset:28672
    v_mfma_f32_16x16x32_bf16 v[108:111], v[80:83], v[92:95], v[108:111]
    ds_read_b128 v[48:51], v9 offset:55296
    v_mfma_f32_16x16x32_bf16 v[116:119], v[80:83], v[96:99], v[116:119]
    ds_read_b64_tr_b16 v[42:43], v2 offset:30720
    v_mfma_f32_16x16x32_bf16 v[104:107], v[84:87], v[88:91], v[104:107]
    ds_read_b128 v[52:55], v9 offset:55552
    v_mfma_f32_16x16x32_bf16 v[112:115], v[84:87], v[92:95], v[112:115]
    ds_read_b64_tr_b16 v[44:45], v5 offset:28672
    v_mfma_f32_16x16x32_bf16 v[120:123], v[84:87], v[96:99], v[120:123]
    ds_read_b64_tr_b16 v[46:47], v5 offset:30720
    ds_read_b128 v[56:59], v9 offset:55808
    s_barrier
    s_waitcnt lgkmcnt(7)
    v_mfma_f32_16x16x32_bf16 v[100:103], v[20:23], v[28:31], v[100:103]
    ds_read_b64_tr_b16 v[60:61], v2 offset:32768
    v_mfma_f32_16x16x32_bf16 v[108:111], v[20:23], v[32:35], v[108:111]
    ds_read_b128 v[68:71], v9 offset:61440
    v_mfma_f32_16x16x32_bf16 v[116:119], v[20:23], v[36:39], v[116:119]
    ds_read_b64_tr_b16 v[62:63], v2 offset:34816
    v_mfma_f32_16x16x32_bf16 v[104:107], v[24:27], v[28:31], v[104:107]
    ds_read_b128 v[72:75], v9 offset:61696
    v_mfma_f32_16x16x32_bf16 v[112:115], v[24:27], v[32:35], v[112:115]
    ds_read_b64_tr_b16 v[64:65], v5 offset:32768
    v_mfma_f32_16x16x32_bf16 v[120:123], v[24:27], v[36:39], v[120:123]
    ds_read_b64_tr_b16 v[66:67], v5 offset:34816
    ds_read_b128 v[76:79], v9 offset:61952
    s_waitcnt lgkmcnt(7)
    v_mfma_f32_16x16x32_bf16 v[100:103], v[40:43], v[48:51], v[100:103]
    ds_read_b64_tr_b16 v[80:81], v2 offset:36864
    v_mfma_f32_16x16x32_bf16 v[108:111], v[40:43], v[52:55], v[108:111]
    ds_read_b128 v[88:91], v10 offset:2048
    v_mfma_f32_16x16x32_bf16 v[116:119], v[40:43], v[56:59], v[116:119]
    ds_read_b64_tr_b16 v[82:83], v2 offset:38912
    v_mfma_f32_16x16x32_bf16 v[104:107], v[44:47], v[48:51], v[104:107]
    ds_read_b128 v[92:95], v10 offset:2304
    v_mfma_f32_16x16x32_bf16 v[112:115], v[44:47], v[52:55], v[112:115]
    ds_read_b64_tr_b16 v[84:85], v5 offset:36864
    v_mfma_f32_16x16x32_bf16 v[120:123], v[44:47], v[56:59], v[120:123]
    ds_read_b64_tr_b16 v[86:87], v5 offset:38912
    ds_read_b128 v[96:99], v10 offset:2560
    s_barrier
    s_waitcnt lgkmcnt(7)
    v_mfma_f32_16x16x32_bf16 v[100:103], v[60:63], v[68:71], v[100:103]
    ds_read_b64_tr_b16 v[20:21], v2 offset:40960
    v_mfma_f32_16x16x32_bf16 v[108:111], v[60:63], v[72:75], v[108:111]
    ds_read_b128 v[28:31], v10 offset:8192
    v_mfma_f32_16x16x32_bf16 v[116:119], v[60:63], v[76:79], v[116:119]
    ds_read_b64_tr_b16 v[22:23], v2 offset:43008
    v_mfma_f32_16x16x32_bf16 v[104:107], v[64:67], v[68:71], v[104:107]
    ds_read_b128 v[32:35], v10 offset:8448
    v_mfma_f32_16x16x32_bf16 v[112:115], v[64:67], v[72:75], v[112:115]
    ds_read_b64_tr_b16 v[24:25], v5 offset:40960
    v_mfma_f32_16x16x32_bf16 v[120:123], v[64:67], v[76:79], v[120:123]
    ds_read_b64_tr_b16 v[26:27], v5 offset:43008
    ds_read_b128 v[36:39], v10 offset:8704
    s_waitcnt lgkmcnt(7)
    v_mfma_f32_16x16x32_bf16 v[100:103], v[80:83], v[88:91], v[100:103]
    ds_read_b64_tr_b16 v[40:41], v2 offset:45056
    v_mfma_f32_16x16x32_bf16 v[108:111], v[80:83], v[92:95], v[108:111]
    ds_read_b128 v[48:51], v10 offset:14336
    v_mfma_f32_16x16x32_bf16 v[116:119], v[80:83], v[96:99], v[116:119]
    ds_read_b64_tr_b16 v[42:43], v2 offset:47104
    v_mfma_f32_16x16x32_bf16 v[104:107], v[84:87], v[88:91], v[104:107]
    ds_read_b128 v[52:55], v10 offset:14592
    v_mfma_f32_16x16x32_bf16 v[112:115], v[84:87], v[92:95], v[112:115]
    ds_read_b64_tr_b16 v[44:45], v5 offset:45056
    v_mfma_f32_16x16x32_bf16 v[120:123], v[84:87], v[96:99], v[120:123]
    ds_read_b64_tr_b16 v[46:47], v5 offset:47104
    ds_read_b128 v[56:59], v10 offset:14848
    s_barrier
    s_waitcnt lgkmcnt(7)
    v_mfma_f32_16x16x32_bf16 v[100:103], v[20:23], v[28:31], v[100:103]
    ds_read_b64_tr_b16 v[60:61], v2 offset:49152
    v_mfma_f32_16x16x32_bf16 v[108:111], v[20:23], v[32:35], v[108:111]
    ds_read_b128 v[68:71], v10 offset:20480
    v_mfma_f32_16x16x32_bf16 v[116:119], v[20:23], v[36:39], v[116:119]
    ds_read_b64_tr_b16 v[62:63], v2 offset:51200
    v_mfma_f32_16x16x32_bf16 v[104:107], v[24:27], v[28:31], v[104:107]
    ds_read_b128 v[72:75], v10 offset:20736
    v_mfma_f32_16x16x32_bf16 v[112:115], v[24:27], v[32:35], v[112:115]
    ds_read_b64_tr_b16 v[64:65], v5 offset:49152
    v_mfma_f32_16x16x32_bf16 v[120:123], v[24:27], v[36:39], v[120:123]
    ds_read_b64_tr_b16 v[66:67], v5 offset:51200
    ds_read_b128 v[76:79], v10 offset:20992
    s_waitcnt lgkmcnt(7)
    v_mfma_f32_16x16x32_bf16 v[100:103], v[40:43], v[48:51], v[100:103]
    ds_read_b64_tr_b16 v[80:81], v2 offset:53248
    v_mfma_f32_16x16x32_bf16 v[108:111], v[40:43], v[52:55], v[108:111]
    ds_read_b128 v[88:91], v10 offset:26624
    v_mfma_f32_16x16x32_bf16 v[116:119], v[40:43], v[56:59], v[116:119]
    ds_read_b64_tr_b16 v[82:83], v2 offset:55296
    v_mfma_f32_16x16x32_bf16 v[104:107], v[44:47], v[48:51], v[104:107]
    ds_read_b128 v[92:95], v10 offset:26880
    v_mfma_f32_16x16x32_bf16 v[112:115], v[44:47], v[52:55], v[112:115]
    ds_read_b64_tr_b16 v[84:85], v5 offset:53248
    v_mfma_f32_16x16x32_bf16 v[120:123], v[44:47], v[56:59], v[120:123]
    ds_read_b64_tr_b16 v[86:87], v5 offset:55296
    ds_read_b128 v[96:99], v10 offset:27136
    s_barrier
    s_waitcnt lgkmcnt(7)
    v_mfma_f32_16x16x32_bf16 v[100:103], v[60:63], v[68:71], v[100:103]
    ds_read_b64_tr_b16 v[20:21], v2 offset:57344
    v_mfma_f32_16x16x32_bf16 v[108:111], v[60:63], v[72:75], v[108:111]
    ds_read_b128 v[28:31], v9 offset:36864
    v_mfma_f32_16x16x32_bf16 v[116:119], v[60:63], v[76:79], v[116:119]
    ds_read_b64_tr_b16 v[22:23], v2 offset:59392
    v_mfma_f32_16x16x32_bf16 v[104:107], v[64:67], v[68:71], v[104:107]
    ds_read_b128 v[32:35], v9 offset:37120
    v_mfma_f32_16x16x32_bf16 v[112:115], v[64:67], v[72:75], v[112:115]
    ds_read_b64_tr_b16 v[24:25], v5 offset:57344
    v_mfma_f32_16x16x32_bf16 v[120:123], v[64:67], v[76:79], v[120:123]
    ds_read_b64_tr_b16 v[26:27], v5 offset:59392
    ds_read_b128 v[36:39], v9 offset:37376
    s_waitcnt lgkmcnt(7)
    v_mfma_f32_16x16x32_bf16 v[100:103], v[80:83], v[88:91], v[100:103]
    ds_read_b64_tr_b16 v[40:41], v2 offset:61440
    v_mfma_f32_16x16x32_bf16 v[108:111], v[80:83], v[92:95], v[108:111]
    ds_read_b128 v[48:51], v9 offset:43008
    v_mfma_f32_16x16x32_bf16 v[116:119], v[80:83], v[96:99], v[116:119]
    ds_read_b64_tr_b16 v[42:43], v2 offset:63488
    v_mfma_f32_16x16x32_bf16 v[104:107], v[84:87], v[88:91], v[104:107]
    ds_read_b128 v[52:55], v9 offset:43264
    v_mfma_f32_16x16x32_bf16 v[112:115], v[84:87], v[92:95], v[112:115]
    ds_read_b64_tr_b16 v[44:45], v5 offset:61440
    v_mfma_f32_16x16x32_bf16 v[120:123], v[84:87], v[96:99], v[120:123]
    ds_read_b64_tr_b16 v[46:47], v5 offset:63488
    ds_read_b128 v[56:59], v9 offset:43520
    s_barrier
    s_waitcnt lgkmcnt(7)
    v_mfma_f32_16x16x32_bf16 v[100:103], v[20:23], v[28:31], v[100:103]
    ds_read_b64_tr_b16 v[60:61], v3 offset:0
    v_mfma_f32_16x16x32_bf16 v[108:111], v[20:23], v[32:35], v[108:111]
    ds_read_b128 v[68:71], v9 offset:49152
    v_mfma_f32_16x16x32_bf16 v[116:119], v[20:23], v[36:39], v[116:119]
    ds_read_b64_tr_b16 v[62:63], v3 offset:2048
    v_mfma_f32_16x16x32_bf16 v[104:107], v[24:27], v[28:31], v[104:107]
    ds_read_b128 v[72:75], v9 offset:49408
    v_mfma_f32_16x16x32_bf16 v[112:115], v[24:27], v[32:35], v[112:115]
    ds_read_b64_tr_b16 v[64:65], v6 offset:0
    v_mfma_f32_16x16x32_bf16 v[120:123], v[24:27], v[36:39], v[120:123]
    ds_read_b64_tr_b16 v[66:67], v6 offset:2048
    ds_read_b128 v[76:79], v9 offset:49664
    s_waitcnt lgkmcnt(7)
    v_mfma_f32_16x16x32_bf16 v[100:103], v[40:43], v[48:51], v[100:103]
    ds_read_b64_tr_b16 v[80:81], v3 offset:4096
    v_mfma_f32_16x16x32_bf16 v[108:111], v[40:43], v[52:55], v[108:111]
    ds_read_b128 v[88:91], v9 offset:55296
    v_mfma_f32_16x16x32_bf16 v[116:119], v[40:43], v[56:59], v[116:119]
    ds_read_b64_tr_b16 v[82:83], v3 offset:6144
    v_mfma_f32_16x16x32_bf16 v[104:107], v[44:47], v[48:51], v[104:107]
    ds_read_b128 v[92:95], v9 offset:55552
    v_mfma_f32_16x16x32_bf16 v[112:115], v[44:47], v[52:55], v[112:115]
    ds_read_b64_tr_b16 v[84:85], v6 offset:4096
    v_mfma_f32_16x16x32_bf16 v[120:123], v[44:47], v[56:59], v[120:123]
    ds_read_b64_tr_b16 v[86:87], v6 offset:6144
    ds_read_b128 v[96:99], v9 offset:55808
    s_barrier
    s_waitcnt lgkmcnt(7)
    v_mfma_f32_16x16x32_bf16 v[100:103], v[60:63], v[68:71], v[100:103]
    ds_read_b64_tr_b16 v[20:21], v3 offset:8192
    v_mfma_f32_16x16x32_bf16 v[108:111], v[60:63], v[72:75], v[108:111]
    ds_read_b128 v[28:31], v9 offset:61440
    v_mfma_f32_16x16x32_bf16 v[116:119], v[60:63], v[76:79], v[116:119]
    ds_read_b64_tr_b16 v[22:23], v3 offset:10240
    v_mfma_f32_16x16x32_bf16 v[104:107], v[64:67], v[68:71], v[104:107]
    ds_read_b128 v[32:35], v9 offset:61696
    v_mfma_f32_16x16x32_bf16 v[112:115], v[64:67], v[72:75], v[112:115]
    ds_read_b64_tr_b16 v[24:25], v6 offset:8192
    v_mfma_f32_16x16x32_bf16 v[120:123], v[64:67], v[76:79], v[120:123]
    ds_read_b64_tr_b16 v[26:27], v6 offset:10240
    ds_read_b128 v[36:39], v9 offset:61952
    s_waitcnt lgkmcnt(7)
    v_mfma_f32_16x16x32_bf16 v[100:103], v[80:83], v[88:91], v[100:103]
    ds_read_b64_tr_b16 v[40:41], v3 offset:12288
    v_mfma_f32_16x16x32_bf16 v[108:111], v[80:83], v[92:95], v[108:111]
    ds_read_b128 v[48:51], v10 offset:2048
    v_mfma_f32_16x16x32_bf16 v[116:119], v[80:83], v[96:99], v[116:119]
    ds_read_b64_tr_b16 v[42:43], v3 offset:14336
    v_mfma_f32_16x16x32_bf16 v[104:107], v[84:87], v[88:91], v[104:107]
    ds_read_b128 v[52:55], v10 offset:2304
    v_mfma_f32_16x16x32_bf16 v[112:115], v[84:87], v[92:95], v[112:115]
    ds_read_b64_tr_b16 v[44:45], v6 offset:12288
    v_mfma_f32_16x16x32_bf16 v[120:123], v[84:87], v[96:99], v[120:123]
    ds_read_b64_tr_b16 v[46:47], v6 offset:14336
    ds_read_b128 v[56:59], v10 offset:2560
    s_barrier
    s_waitcnt lgkmcnt(7)
    v_mfma_f32_16x16x32_bf16 v[100:103], v[20:23], v[28:31], v[100:103]
    ds_read_b64_tr_b16 v[60:61], v3 offset:16384
    v_mfma_f32_16x16x32_bf16 v[108:111], v[20:23], v[32:35], v[108:111]
    ds_read_b128 v[68:71], v10 offset:8192
    v_mfma_f32_16x16x32_bf16 v[116:119], v[20:23], v[36:39], v[116:119]
    ds_read_b64_tr_b16 v[62:63], v3 offset:18432
    v_mfma_f32_16x16x32_bf16 v[104:107], v[24:27], v[28:31], v[104:107]
    ds_read_b128 v[72:75], v10 offset:8448
    v_mfma_f32_16x16x32_bf16 v[112:115], v[24:27], v[32:35], v[112:115]
    ds_read_b64_tr_b16 v[64:65], v6 offset:16384
    v_mfma_f32_16x16x32_bf16 v[120:123], v[24:27], v[36:39], v[120:123]
    ds_read_b64_tr_b16 v[66:67], v6 offset:18432
    ds_read_b128 v[76:79], v10 offset:8704
    s_waitcnt lgkmcnt(7)
    v_mfma_f32_16x16x32_bf16 v[100:103], v[40:43], v[48:51], v[100:103]
    ds_read_b64_tr_b16 v[80:81], v3 offset:20480
    v_mfma_f32_16x16x32_bf16 v[108:111], v[40:43], v[52:55], v[108:111]
    ds_read_b128 v[88:91], v10 offset:14336
    v_mfma_f32_16x16x32_bf16 v[116:119], v[40:43], v[56:59], v[116:119]
    ds_read_b64_tr_b16 v[82:83], v3 offset:22528
    v_mfma_f32_16x16x32_bf16 v[104:107], v[44:47], v[48:51], v[104:107]
    ds_read_b128 v[92:95], v10 offset:14592
    v_mfma_f32_16x16x32_bf16 v[112:115], v[44:47], v[52:55], v[112:115]
    ds_read_b64_tr_b16 v[84:85], v6 offset:20480
    v_mfma_f32_16x16x32_bf16 v[120:123], v[44:47], v[56:59], v[120:123]
    ds_read_b64_tr_b16 v[86:87], v6 offset:22528
    ds_read_b128 v[96:99], v10 offset:14848
    s_barrier
    s_waitcnt lgkmcnt(7)
    v_mfma_f32_16x16x32_bf16 v[100:103], v[60:63], v[68:71], v[100:103]
    ds_read_b64_tr_b16 v[20:21], v3 offset:24576
    v_mfma_f32_16x16x32_bf16 v[108:111], v[60:63], v[72:75], v[108:111]
    ds_read_b128 v[28:31], v10 offset:20480
    v_mfma_f32_16x16x32_bf16 v[116:119], v[60:63], v[76:79], v[116:119]
    ds_read_b64_tr_b16 v[22:23], v3 offset:26624
    v_mfma_f32_16x16x32_bf16 v[104:107], v[64:67], v[68:71], v[104:107]
    ds_read_b128 v[32:35], v10 offset:20736
    v_mfma_f32_16x16x32_bf16 v[112:115], v[64:67], v[72:75], v[112:115]
    ds_read_b64_tr_b16 v[24:25], v6 offset:24576
    v_mfma_f32_16x16x32_bf16 v[120:123], v[64:67], v[76:79], v[120:123]
    ds_read_b64_tr_b16 v[26:27], v6 offset:26624
    ds_read_b128 v[36:39], v10 offset:20992
    s_waitcnt lgkmcnt(7)
    v_mfma_f32_16x16x32_bf16 v[100:103], v[80:83], v[88:91], v[100:103]
    ds_read_b64_tr_b16 v[40:41], v3 offset:28672
    v_mfma_f32_16x16x32_bf16 v[108:111], v[80:83], v[92:95], v[108:111]
    ds_read_b128 v[48:51], v10 offset:26624
    v_mfma_f32_16x16x32_bf16 v[116:119], v[80:83], v[96:99], v[116:119]
    ds_read_b64_tr_b16 v[42:43], v3 offset:30720
    v_mfma_f32_16x16x32_bf16 v[104:107], v[84:87], v[88:91], v[104:107]
    ds_read_b128 v[52:55], v10 offset:26880
    v_mfma_f32_16x16x32_bf16 v[112:115], v[84:87], v[92:95], v[112:115]
    ds_read_b64_tr_b16 v[44:45], v6 offset:28672
    v_mfma_f32_16x16x32_bf16 v[120:123], v[84:87], v[96:99], v[120:123]
    ds_read_b64_tr_b16 v[46:47], v6 offset:30720
    ds_read_b128 v[56:59], v10 offset:27136
    s_barrier
    s_waitcnt lgkmcnt(7)
    v_mfma_f32_16x16x32_bf16 v[100:103], v[20:23], v[28:31], v[100:103]
    ds_read_b64_tr_b16 v[60:61], v2 offset:0
    v_mfma_f32_16x16x32_bf16 v[108:111], v[20:23], v[32:35], v[108:111]
    ds_read_b128 v[68:71], v9 offset:36864
    v_mfma_f32_16x16x32_bf16 v[116:119], v[20:23], v[36:39], v[116:119]
    ds_read_b64_tr_b16 v[62:63], v2 offset:2048
    v_mfma_f32_16x16x32_bf16 v[104:107], v[24:27], v[28:31], v[104:107]
    ds_read_b128 v[72:75], v9 offset:37120
    v_mfma_f32_16x16x32_bf16 v[112:115], v[24:27], v[32:35], v[112:115]
    ds_read_b64_tr_b16 v[64:65], v5 offset:0
    v_mfma_f32_16x16x32_bf16 v[120:123], v[24:27], v[36:39], v[120:123]
    ds_read_b64_tr_b16 v[66:67], v5 offset:2048
    ds_read_b128 v[76:79], v9 offset:37376
    s_waitcnt lgkmcnt(7)
    v_mfma_f32_16x16x32_bf16 v[100:103], v[40:43], v[48:51], v[100:103]
    ds_read_b64_tr_b16 v[80:81], v2 offset:4096
    v_mfma_f32_16x16x32_bf16 v[108:111], v[40:43], v[52:55], v[108:111]
    ds_read_b128 v[88:91], v9 offset:43008
    v_mfma_f32_16x16x32_bf16 v[116:119], v[40:43], v[56:59], v[116:119]
    ds_read_b64_tr_b16 v[82:83], v2 offset:6144
    v_mfma_f32_16x16x32_bf16 v[104:107], v[44:47], v[48:51], v[104:107]
    ds_read_b128 v[92:95], v9 offset:43264
    v_mfma_f32_16x16x32_bf16 v[112:115], v[44:47], v[52:55], v[112:115]
    ds_read_b64_tr_b16 v[84:85], v5 offset:4096
    v_mfma_f32_16x16x32_bf16 v[120:123], v[44:47], v[56:59], v[120:123]
    ds_read_b64_tr_b16 v[86:87], v5 offset:6144
    ds_read_b128 v[96:99], v9 offset:43520
    s_barrier
    s_waitcnt lgkmcnt(7)
    v_mfma_f32_16x16x32_bf16 v[100:103], v[60:63], v[68:71], v[100:103]
    ds_read_b64_tr_b16 v[20:21], v2 offset:8192
    v_mfma_f32_16x16x32_bf16 v[108:111], v[60:63], v[72:75], v[108:111]
    ds_read_b128 v[28:31], v9 offset:49152
    v_mfma_f32_16x16x32_bf16 v[116:119], v[60:63], v[76:79], v[116:119]
    ds_read_b64_tr_b16 v[22:23], v2 offset:10240
    v_mfma_f32_16x16x32_bf16 v[104:107], v[64:67], v[68:71], v[104:107]
    ds_read_b128 v[32:35], v9 offset:49408
    v_mfma_f32_16x16x32_bf16 v[112:115], v[64:67], v[72:75], v[112:115]
    ds_read_b64_tr_b16 v[24:25], v5 offset:8192
    v_mfma_f32_16x16x32_bf16 v[120:123], v[64:67], v[76:79], v[120:123]
    ds_read_b64_tr_b16 v[26:27], v5 offset:10240
    ds_read_b128 v[36:39], v9 offset:49664
    s_waitcnt lgkmcnt(7)
    v_mfma_f32_16x16x32_bf16 v[100:103], v[80:83], v[88:91], v[100:103]
    ds_read_b64_tr_b16 v[40:41], v2 offset:12288
    v_mfma_f32_16x16x32_bf16 v[108:111], v[80:83], v[92:95], v[108:111]
    ds_read_b128 v[48:51], v9 offset:55296
    v_mfma_f32_16x16x32_bf16 v[116:119], v[80:83], v[96:99], v[116:119]
    ds_read_b64_tr_b16 v[42:43], v2 offset:14336
    v_mfma_f32_16x16x32_bf16 v[104:107], v[84:87], v[88:91], v[104:107]
    ds_read_b128 v[52:55], v9 offset:55552
    v_mfma_f32_16x16x32_bf16 v[112:115], v[84:87], v[92:95], v[112:115]
    ds_read_b64_tr_b16 v[44:45], v5 offset:12288
    v_mfma_f32_16x16x32_bf16 v[120:123], v[84:87], v[96:99], v[120:123]
    ds_read_b64_tr_b16 v[46:47], v5 offset:14336
    ds_read_b128 v[56:59], v9 offset:55808
    s_barrier
    s_waitcnt lgkmcnt(7)
    v_mfma_f32_16x16x32_bf16 v[100:103], v[20:23], v[28:31], v[100:103]
    ds_read_b64_tr_b16 v[60:61], v2 offset:16384
    v_mfma_f32_16x16x32_bf16 v[108:111], v[20:23], v[32:35], v[108:111]
    ds_read_b128 v[68:71], v9 offset:61440
    v_mfma_f32_16x16x32_bf16 v[116:119], v[20:23], v[36:39], v[116:119]
    ds_read_b64_tr_b16 v[62:63], v2 offset:18432
    v_mfma_f32_16x16x32_bf16 v[104:107], v[24:27], v[28:31], v[104:107]
    ds_read_b128 v[72:75], v9 offset:61696
    v_mfma_f32_16x16x32_bf16 v[112:115], v[24:27], v[32:35], v[112:115]
    ds_read_b64_tr_b16 v[64:65], v5 offset:16384
    v_mfma_f32_16x16x32_bf16 v[120:123], v[24:27], v[36:39], v[120:123]
    ds_read_b64_tr_b16 v[66:67], v5 offset:18432
    ds_read_b128 v[76:79], v9 offset:61952
    s_waitcnt lgkmcnt(7)
    v_mfma_f32_16x16x32_bf16 v[100:103], v[40:43], v[48:51], v[100:103]
    ds_read_b64_tr_b16 v[80:81], v2 offset:20480
    v_mfma_f32_16x16x32_bf16 v[108:111], v[40:43], v[52:55], v[108:111]
    ds_read_b128 v[88:91], v10 offset:2048
    v_mfma_f32_16x16x32_bf16 v[116:119], v[40:43], v[56:59], v[116:119]
    ds_read_b64_tr_b16 v[82:83], v2 offset:22528
    v_mfma_f32_16x16x32_bf16 v[104:107], v[44:47], v[48:51], v[104:107]
    ds_read_b128 v[92:95], v10 offset:2304
    v_mfma_f32_16x16x32_bf16 v[112:115], v[44:47], v[52:55], v[112:115]
    ds_read_b64_tr_b16 v[84:85], v5 offset:20480
    v_mfma_f32_16x16x32_bf16 v[120:123], v[44:47], v[56:59], v[120:123]
    ds_read_b64_tr_b16 v[86:87], v5 offset:22528
    ds_read_b128 v[96:99], v10 offset:2560
    s_barrier
    s_waitcnt lgkmcnt(7)
    v_mfma_f32_16x16x32_bf16 v[100:103], v[60:63], v[68:71], v[100:103]
    ds_read_b64_tr_b16 v[20:21], v2 offset:24576
    v_mfma_f32_16x16x32_bf16 v[108:111], v[60:63], v[72:75], v[108:111]
    ds_read_b128 v[28:31], v10 offset:8192
    v_mfma_f32_16x16x32_bf16 v[116:119], v[60:63], v[76:79], v[116:119]
    ds_read_b64_tr_b16 v[22:23], v2 offset:26624
    v_mfma_f32_16x16x32_bf16 v[104:107], v[64:67], v[68:71], v[104:107]
    ds_read_b128 v[32:35], v10 offset:8448
    v_mfma_f32_16x16x32_bf16 v[112:115], v[64:67], v[72:75], v[112:115]
    ds_read_b64_tr_b16 v[24:25], v5 offset:24576
    v_mfma_f32_16x16x32_bf16 v[120:123], v[64:67], v[76:79], v[120:123]
    ds_read_b64_tr_b16 v[26:27], v5 offset:26624
    ds_read_b128 v[36:39], v10 offset:8704
    s_waitcnt lgkmcnt(7)
    v_mfma_f32_16x16x32_bf16 v[100:103], v[80:83], v[88:91], v[100:103]
    ds_read_b64_tr_b16 v[40:41], v2 offset:28672
    v_mfma_f32_16x16x32_bf16 v[108:111], v[80:83], v[92:95], v[108:111]
    ds_read_b128 v[48:51], v10 offset:14336
    v_mfma_f32_16x16x32_bf16 v[116:119], v[80:83], v[96:99], v[116:119]
    ds_read_b64_tr_b16 v[42:43], v2 offset:30720
    v_mfma_f32_16x16x32_bf16 v[104:107], v[84:87], v[88:91], v[104:107]
    ds_read_b128 v[52:55], v10 offset:14592
    v_mfma_f32_16x16x32_bf16 v[112:115], v[84:87], v[92:95], v[112:115]
    ds_read_b64_tr_b16 v[44:45], v5 offset:28672
    v_mfma_f32_16x16x32_bf16 v[120:123], v[84:87], v[96:99], v[120:123]
    ds_read_b64_tr_b16 v[46:47], v5 offset:30720
    ds_read_b128 v[56:59], v10 offset:14848
    s_barrier
    s_waitcnt lgkmcnt(7)
    v_mfma_f32_16x16x32_bf16 v[100:103], v[20:23], v[28:31], v[100:103]
    ds_read_b64_tr_b16 v[60:61], v2 offset:32768
    v_mfma_f32_16x16x32_bf16 v[108:111], v[20:23], v[32:35], v[108:111]
    ds_read_b128 v[68:71], v10 offset:20480
    v_mfma_f32_16x16x32_bf16 v[116:119], v[20:23], v[36:39], v[116:119]
    ds_read_b64_tr_b16 v[62:63], v2 offset:34816
    v_mfma_f32_16x16x32_bf16 v[104:107], v[24:27], v[28:31], v[104:107]
    ds_read_b128 v[72:75], v10 offset:20736
    v_mfma_f32_16x16x32_bf16 v[112:115], v[24:27], v[32:35], v[112:115]
    ds_read_b64_tr_b16 v[64:65], v5 offset:32768
    v_mfma_f32_16x16x32_bf16 v[120:123], v[24:27], v[36:39], v[120:123]
    ds_read_b64_tr_b16 v[66:67], v5 offset:34816
    ds_read_b128 v[76:79], v10 offset:20992
    s_waitcnt lgkmcnt(7)
    v_mfma_f32_16x16x32_bf16 v[100:103], v[40:43], v[48:51], v[100:103]
    ds_read_b64_tr_b16 v[80:81], v2 offset:36864
    v_mfma_f32_16x16x32_bf16 v[108:111], v[40:43], v[52:55], v[108:111]
    ds_read_b128 v[88:91], v10 offset:26624
    v_mfma_f32_16x16x32_bf16 v[116:119], v[40:43], v[56:59], v[116:119]
    ds_read_b64_tr_b16 v[82:83], v2 offset:38912
    v_mfma_f32_16x16x32_bf16 v[104:107], v[44:47], v[48:51], v[104:107]
    ds_read_b128 v[92:95], v10 offset:26880
    v_mfma_f32_16x16x32_bf16 v[112:115], v[44:47], v[52:55], v[112:115]
    ds_read_b64_tr_b16 v[84:85], v5 offset:36864
    v_mfma_f32_16x16x32_bf16 v[120:123], v[44:47], v[56:59], v[120:123]
    ds_read_b64_tr_b16 v[86:87], v5 offset:38912
    ds_read_b128 v[96:99], v10 offset:27136
    s_barrier
    s_waitcnt lgkmcnt(7)
    v_mfma_f32_16x16x32_bf16 v[100:103], v[60:63], v[68:71], v[100:103]
    ds_read_b64_tr_b16 v[20:21], v2 offset:40960
    v_mfma_f32_16x16x32_bf16 v[108:111], v[60:63], v[72:75], v[108:111]
    ds_read_b128 v[28:31], v9 offset:36864
    v_mfma_f32_16x16x32_bf16 v[116:119], v[60:63], v[76:79], v[116:119]
    ds_read_b64_tr_b16 v[22:23], v2 offset:43008
    v_mfma_f32_16x16x32_bf16 v[104:107], v[64:67], v[68:71], v[104:107]
    ds_read_b128 v[32:35], v9 offset:37120
    v_mfma_f32_16x16x32_bf16 v[112:115], v[64:67], v[72:75], v[112:115]
    ds_read_b64_tr_b16 v[24:25], v5 offset:40960
    v_mfma_f32_16x16x32_bf16 v[120:123], v[64:67], v[76:79], v[120:123]
    ds_read_b64_tr_b16 v[26:27], v5 offset:43008
    ds_read_b128 v[36:39], v9 offset:37376
    s_waitcnt lgkmcnt(7)
    v_mfma_f32_16x16x32_bf16 v[100:103], v[80:83], v[88:91], v[100:103]
    ds_read_b64_tr_b16 v[40:41], v2 offset:45056
    v_mfma_f32_16x16x32_bf16 v[108:111], v[80:83], v[92:95], v[108:111]
    ds_read_b128 v[48:51], v9 offset:43008
    v_mfma_f32_16x16x32_bf16 v[116:119], v[80:83], v[96:99], v[116:119]
    ds_read_b64_tr_b16 v[42:43], v2 offset:47104
    v_mfma_f32_16x16x32_bf16 v[104:107], v[84:87], v[88:91], v[104:107]
    ds_read_b128 v[52:55], v9 offset:43264
    v_mfma_f32_16x16x32_bf16 v[112:115], v[84:87], v[92:95], v[112:115]
    ds_read_b64_tr_b16 v[44:45], v5 offset:45056
    v_mfma_f32_16x16x32_bf16 v[120:123], v[84:87], v[96:99], v[120:123]
    ds_read_b64_tr_b16 v[46:47], v5 offset:47104
    ds_read_b128 v[56:59], v9 offset:43520
    s_barrier
    s_waitcnt lgkmcnt(7)
    v_mfma_f32_16x16x32_bf16 v[100:103], v[20:23], v[28:31], v[100:103]
    ds_read_b64_tr_b16 v[60:61], v2 offset:49152
    v_mfma_f32_16x16x32_bf16 v[108:111], v[20:23], v[32:35], v[108:111]
    ds_read_b128 v[68:71], v9 offset:49152
    v_mfma_f32_16x16x32_bf16 v[116:119], v[20:23], v[36:39], v[116:119]
    ds_read_b64_tr_b16 v[62:63], v2 offset:51200
    v_mfma_f32_16x16x32_bf16 v[104:107], v[24:27], v[28:31], v[104:107]
    ds_read_b128 v[72:75], v9 offset:49408
    v_mfma_f32_16x16x32_bf16 v[112:115], v[24:27], v[32:35], v[112:115]
    ds_read_b64_tr_b16 v[64:65], v5 offset:49152
    v_mfma_f32_16x16x32_bf16 v[120:123], v[24:27], v[36:39], v[120:123]
    ds_read_b64_tr_b16 v[66:67], v5 offset:51200
    ds_read_b128 v[76:79], v9 offset:49664
    s_waitcnt lgkmcnt(7)
    v_mfma_f32_16x16x32_bf16 v[100:103], v[40:43], v[48:51], v[100:103]
    ds_read_b64_tr_b16 v[80:81], v2 offset:53248
    v_mfma_f32_16x16x32_bf16 v[108:111], v[40:43], v[52:55], v[108:111]
    ds_read_b128 v[88:91], v9 offset:55296
    v_mfma_f32_16x16x32_bf16 v[116:119], v[40:43], v[56:59], v[116:119]
    ds_read_b64_tr_b16 v[82:83], v2 offset:55296
    v_mfma_f32_16x16x32_bf16 v[104:107], v[44:47], v[48:51], v[104:107]
    ds_read_b128 v[92:95], v9 offset:55552
    v_mfma_f32_16x16x32_bf16 v[112:115], v[44:47], v[52:55], v[112:115]
    ds_read_b64_tr_b16 v[84:85], v5 offset:53248
    v_mfma_f32_16x16x32_bf16 v[120:123], v[44:47], v[56:59], v[120:123]
    ds_read_b64_tr_b16 v[86:87], v5 offset:55296
    ds_read_b128 v[96:99], v9 offset:55808
    s_barrier
    s_waitcnt lgkmcnt(7)
    v_mfma_f32_16x16x32_bf16 v[100:103], v[60:63], v[68:71], v[100:103]
    ds_read_b64_tr_b16 v[20:21], v2 offset:57344
    v_mfma_f32_16x16x32_bf16 v[108:111], v[60:63], v[72:75], v[108:111]
    ds_read_b128 v[28:31], v9 offset:61440
    v_mfma_f32_16x16x32_bf16 v[116:119], v[60:63], v[76:79], v[116:119]
    ds_read_b64_tr_b16 v[22:23], v2 offset:59392
    v_mfma_f32_16x16x32_bf16 v[104:107], v[64:67], v[68:71], v[104:107]
    ds_read_b128 v[32:35], v9 offset:61696
    v_mfma_f32_16x16x32_bf16 v[112:115], v[64:67], v[72:75], v[112:115]
    ds_read_b64_tr_b16 v[24:25], v5 offset:57344
    v_mfma_f32_16x16x32_bf16 v[120:123], v[64:67], v[76:79], v[120:123]
    ds_read_b64_tr_b16 v[26:27], v5 offset:59392
    ds_read_b128 v[36:39], v9 offset:61952
    s_waitcnt lgkmcnt(7)
    v_mfma_f32_16x16x32_bf16 v[100:103], v[80:83], v[88:91], v[100:103]
    ds_read_b64_tr_b16 v[40:41], v2 offset:61440
    v_mfma_f32_16x16x32_bf16 v[108:111], v[80:83], v[92:95], v[108:111]
    ds_read_b128 v[48:51], v10 offset:2048
    v_mfma_f32_16x16x32_bf16 v[116:119], v[80:83], v[96:99], v[116:119]
    ds_read_b64_tr_b16 v[42:43], v2 offset:63488
    v_mfma_f32_16x16x32_bf16 v[104:107], v[84:87], v[88:91], v[104:107]
    ds_read_b128 v[52:55], v10 offset:2304
    v_mfma_f32_16x16x32_bf16 v[112:115], v[84:87], v[92:95], v[112:115]
    ds_read_b64_tr_b16 v[44:45], v5 offset:61440
    v_mfma_f32_16x16x32_bf16 v[120:123], v[84:87], v[96:99], v[120:123]
    ds_read_b64_tr_b16 v[46:47], v5 offset:63488
    ds_read_b128 v[56:59], v10 offset:2560
    s_barrier
    s_waitcnt lgkmcnt(7)
    v_mfma_f32_16x16x32_bf16 v[100:103], v[20:23], v[28:31], v[100:103]
    ds_read_b64_tr_b16 v[60:61], v3 offset:0
    v_mfma_f32_16x16x32_bf16 v[108:111], v[20:23], v[32:35], v[108:111]
    ds_read_b128 v[68:71], v10 offset:8192
    v_mfma_f32_16x16x32_bf16 v[116:119], v[20:23], v[36:39], v[116:119]
    ds_read_b64_tr_b16 v[62:63], v3 offset:2048
    v_mfma_f32_16x16x32_bf16 v[104:107], v[24:27], v[28:31], v[104:107]
    ds_read_b128 v[72:75], v10 offset:8448
    v_mfma_f32_16x16x32_bf16 v[112:115], v[24:27], v[32:35], v[112:115]
    ds_read_b64_tr_b16 v[64:65], v6 offset:0
    v_mfma_f32_16x16x32_bf16 v[120:123], v[24:27], v[36:39], v[120:123]
    ds_read_b64_tr_b16 v[66:67], v6 offset:2048
    ds_read_b128 v[76:79], v10 offset:8704
    s_waitcnt lgkmcnt(7)
    v_mfma_f32_16x16x32_bf16 v[100:103], v[40:43], v[48:51], v[100:103]
    ds_read_b64_tr_b16 v[80:81], v3 offset:4096
    v_mfma_f32_16x16x32_bf16 v[108:111], v[40:43], v[52:55], v[108:111]
    ds_read_b128 v[88:91], v10 offset:14336
    v_mfma_f32_16x16x32_bf16 v[116:119], v[40:43], v[56:59], v[116:119]
    ds_read_b64_tr_b16 v[82:83], v3 offset:6144
    v_mfma_f32_16x16x32_bf16 v[104:107], v[44:47], v[48:51], v[104:107]
    ds_read_b128 v[92:95], v10 offset:14592
    v_mfma_f32_16x16x32_bf16 v[112:115], v[44:47], v[52:55], v[112:115]
    ds_read_b64_tr_b16 v[84:85], v6 offset:4096
    v_mfma_f32_16x16x32_bf16 v[120:123], v[44:47], v[56:59], v[120:123]
    ds_read_b64_tr_b16 v[86:87], v6 offset:6144
    ds_read_b128 v[96:99], v10 offset:14848
    s_barrier
    s_waitcnt lgkmcnt(7)
    v_mfma_f32_16x16x32_bf16 v[100:103], v[60:63], v[68:71], v[100:103]
    ds_read_b64_tr_b16 v[20:21], v3 offset:8192
    v_mfma_f32_16x16x32_bf16 v[108:111], v[60:63], v[72:75], v[108:111]
    ds_read_b128 v[28:31], v10 offset:20480
    v_mfma_f32_16x16x32_bf16 v[116:119], v[60:63], v[76:79], v[116:119]
    ds_read_b64_tr_b16 v[22:23], v3 offset:10240
    v_mfma_f32_16x16x32_bf16 v[104:107], v[64:67], v[68:71], v[104:107]
    ds_read_b128 v[32:35], v10 offset:20736
    v_mfma_f32_16x16x32_bf16 v[112:115], v[64:67], v[72:75], v[112:115]
    ds_read_b64_tr_b16 v[24:25], v6 offset:8192
    v_mfma_f32_16x16x32_bf16 v[120:123], v[64:67], v[76:79], v[120:123]
    ds_read_b64_tr_b16 v[26:27], v6 offset:10240
    ds_read_b128 v[36:39], v10 offset:20992
    s_waitcnt lgkmcnt(7)
    v_mfma_f32_16x16x32_bf16 v[100:103], v[80:83], v[88:91], v[100:103]
    ds_read_b64_tr_b16 v[40:41], v3 offset:12288
    v_mfma_f32_16x16x32_bf16 v[108:111], v[80:83], v[92:95], v[108:111]
    ds_read_b128 v[48:51], v10 offset:26624
    v_mfma_f32_16x16x32_bf16 v[116:119], v[80:83], v[96:99], v[116:119]
    ds_read_b64_tr_b16 v[42:43], v3 offset:14336
    v_mfma_f32_16x16x32_bf16 v[104:107], v[84:87], v[88:91], v[104:107]
    ds_read_b128 v[52:55], v10 offset:26880
    v_mfma_f32_16x16x32_bf16 v[112:115], v[84:87], v[92:95], v[112:115]
    ds_read_b64_tr_b16 v[44:45], v6 offset:12288
    v_mfma_f32_16x16x32_bf16 v[120:123], v[84:87], v[96:99], v[120:123]
    ds_read_b64_tr_b16 v[46:47], v6 offset:14336
    ds_read_b128 v[56:59], v10 offset:27136
    s_barrier
    s_waitcnt lgkmcnt(7)
    v_mfma_f32_16x16x32_bf16 v[100:103], v[20:23], v[28:31], v[100:103]
    ds_read_b64_tr_b16 v[60:61], v3 offset:16384
    v_mfma_f32_16x16x32_bf16 v[108:111], v[20:23], v[32:35], v[108:111]
    ds_read_b128 v[68:71], v9 offset:36864
    v_mfma_f32_16x16x32_bf16 v[116:119], v[20:23], v[36:39], v[116:119]
    ds_read_b64_tr_b16 v[62:63], v3 offset:18432
    v_mfma_f32_16x16x32_bf16 v[104:107], v[24:27], v[28:31], v[104:107]
    ds_read_b128 v[72:75], v9 offset:37120
    v_mfma_f32_16x16x32_bf16 v[112:115], v[24:27], v[32:35], v[112:115]
    ds_read_b64_tr_b16 v[64:65], v6 offset:16384
    v_mfma_f32_16x16x32_bf16 v[120:123], v[24:27], v[36:39], v[120:123]
    ds_read_b64_tr_b16 v[66:67], v6 offset:18432
    ds_read_b128 v[76:79], v9 offset:37376
    s_waitcnt lgkmcnt(7)
    v_mfma_f32_16x16x32_bf16 v[100:103], v[40:43], v[48:51], v[100:103]
    ds_read_b64_tr_b16 v[80:81], v3 offset:20480
    v_mfma_f32_16x16x32_bf16 v[108:111], v[40:43], v[52:55], v[108:111]
    ds_read_b128 v[88:91], v9 offset:43008
    v_mfma_f32_16x16x32_bf16 v[116:119], v[40:43], v[56:59], v[116:119]
    ds_read_b64_tr_b16 v[82:83], v3 offset:22528
    v_mfma_f32_16x16x32_bf16 v[104:107], v[44:47], v[48:51], v[104:107]
    ds_read_b128 v[92:95], v9 offset:43264
    v_mfma_f32_16x16x32_bf16 v[112:115], v[44:47], v[52:55], v[112:115]
    ds_read_b64_tr_b16 v[84:85], v6 offset:20480
    v_mfma_f32_16x16x32_bf16 v[120:123], v[44:47], v[56:59], v[120:123]
    ds_read_b64_tr_b16 v[86:87], v6 offset:22528
    ds_read_b128 v[96:99], v9 offset:43520
    s_barrier
    s_waitcnt lgkmcnt(7)
    v_mfma_f32_16x16x32_bf16 v[100:103], v[60:63], v[68:71], v[100:103]
    ds_read_b64_tr_b16 v[20:21], v3 offset:24576
    v_mfma_f32_16x16x32_bf16 v[108:111], v[60:63], v[72:75], v[108:111]
    ds_read_b128 v[28:31], v9 offset:49152
    v_mfma_f32_16x16x32_bf16 v[116:119], v[60:63], v[76:79], v[116:119]
    ds_read_b64_tr_b16 v[22:23], v3 offset:26624
    v_mfma_f32_16x16x32_bf16 v[104:107], v[64:67], v[68:71], v[104:107]
    ds_read_b128 v[32:35], v9 offset:49408
    v_mfma_f32_16x16x32_bf16 v[112:115], v[64:67], v[72:75], v[112:115]
    ds_read_b64_tr_b16 v[24:25], v6 offset:24576
    v_mfma_f32_16x16x32_bf16 v[120:123], v[64:67], v[76:79], v[120:123]
    ds_read_b64_tr_b16 v[26:27], v6 offset:26624
    ds_read_b128 v[36:39], v9 offset:49664
    s_waitcnt lgkmcnt(7)
    v_mfma_f32_16x16x32_bf16 v[100:103], v[80:83], v[88:91], v[100:103]
    ds_read_b64_tr_b16 v[40:41], v3 offset:28672
    v_mfma_f32_16x16x32_bf16 v[108:111], v[80:83], v[92:95], v[108:111]
    ds_read_b128 v[48:51], v9 offset:55296
    v_mfma_f32_16x16x32_bf16 v[116:119], v[80:83], v[96:99], v[116:119]
    ds_read_b64_tr_b16 v[42:43], v3 offset:30720
    v_mfma_f32_16x16x32_bf16 v[104:107], v[84:87], v[88:91], v[104:107]
    ds_read_b128 v[52:55], v9 offset:55552
    v_mfma_f32_16x16x32_bf16 v[112:115], v[84:87], v[92:95], v[112:115]
    ds_read_b64_tr_b16 v[44:45], v6 offset:28672
    v_mfma_f32_16x16x32_bf16 v[120:123], v[84:87], v[96:99], v[120:123]
    ds_read_b64_tr_b16 v[46:47], v6 offset:30720
    ds_read_b128 v[56:59], v9 offset:55808
    s_waitcnt lgkmcnt(7)
    v_mfma_f32_16x16x32_bf16 v[100:103], v[20:23], v[28:31], v[100:103]
    v_mfma_f32_16x16x32_bf16 v[108:111], v[20:23], v[32:35], v[108:111]
    v_mfma_f32_16x16x32_bf16 v[116:119], v[20:23], v[36:39], v[116:119]
    v_mfma_f32_16x16x32_bf16 v[104:107], v[24:27], v[28:31], v[104:107]
    v_mfma_f32_16x16x32_bf16 v[112:115], v[24:27], v[32:35], v[112:115]
    v_mfma_f32_16x16x32_bf16 v[120:123], v[24:27], v[36:39], v[120:123]
    s_waitcnt lgkmcnt(0)
    s_barrier
    v_mfma_f32_16x16x32_bf16 v[100:103], v[40:43], v[48:51], v[100:103]
    v_mfma_f32_16x16x32_bf16 v[108:111], v[40:43], v[52:55], v[108:111]
    v_mfma_f32_16x16x32_bf16 v[104:107], v[44:47], v[48:51], v[104:107]
    v_mfma_f32_16x16x32_bf16 v[116:119], v[40:43], v[56:59], v[116:119]
    v_mfma_f32_16x16x32_bf16 v[112:115], v[44:47], v[52:55], v[112:115]
    v_mfma_f32_16x16x32_bf16 v[120:123], v[44:47], v[56:59], v[120:123]
    s_nop 4
    v_permlane16_swap_b32 v100, v104
    v_permlane16_swap_b32 v101, v105
    v_permlane16_swap_b32 v102, v106
    v_permlane16_swap_b32 v103, v107
    v_cvt_pk_bf16_f32 v40, v100, v101
    v_cvt_pk_bf16_f32 v41, v102, v103
    v_cvt_pk_bf16_f32 v42, v104, v105
    v_cvt_pk_bf16_f32 v43, v106, v107
    buffer_store_dwordx4 v[40:43], v16, s[44:47], 0 offen sc1
    v_permlane16_swap_b32 v108, v112
    v_permlane16_swap_b32 v109, v113
    v_permlane16_swap_b32 v110, v114
    v_permlane16_swap_b32 v111, v115
    v_cvt_pk_bf16_f32 v44, v108, v109
    v_cvt_pk_bf16_f32 v45, v110, v111
    v_cvt_pk_bf16_f32 v46, v112, v113
    v_cvt_pk_bf16_f32 v47, v114, v115
    buffer_store_dwordx4 v[44:47], v17, s[44:47], 0 offen sc1
    v_permlane16_swap_b32 v116, v120
    v_permlane16_swap_b32 v117, v121
    v_permlane16_swap_b32 v118, v122
    v_permlane16_swap_b32 v119, v123
    v_cvt_pk_bf16_f32 v48, v116, v117
    v_cvt_pk_bf16_f32 v49, v118, v119
    v_cvt_pk_bf16_f32 v50, v120, v121
    v_cvt_pk_bf16_f32 v51, v122, v123
    buffer_store_dwordx4 v[48:51], v18, s[44:47], 0 offen sc1
    s_endpgm
Lcsum:
    s_sub_u32 s60, s57, 30
    s_lshl_b32 s60, s60, 3
    s_add_u32 s60, s60, s56
    v_lshrrev_b32 v2, 4, v1
    v_and_b32 v3, 15, v1
    v_mul_u32_u24 v4, 3456, v2
    v_lshl_add_u32 v4, v3, 4, v4
    s_mul_i32 s91, s22, 276480
    s_lshl_b32 s3, s60, 8
    s_add_u32 s91, s91, s3
    s_cmp_ge_u32 s60, 14
    s_cselect_b32 s3, 2147483648, 0
    v_or_b32 v4, s3, v4
    buffer_load_dwordx4 v[60:63], v4, s[36:39], s91 offen
    s_add_u32 s91, s91, 13824
    buffer_load_dwordx4 v[64:67], v4, s[36:39], s91 offen
    s_add_u32 s91, s91, 13824
    buffer_load_dwordx4 v[68:71], v4, s[36:39], s91 offen
    s_add_u32 s91, s91, 13824
    buffer_load_dwordx4 v[72:75], v4, s[36:39], s91 offen
    s_add_u32 s91, s91, 13824
    buffer_load_dwordx4 v[76:79], v4, s[36:39], s91 offen
    s_add_u32 s91, s91, 13824
    buffer_load_dwordx4 v[80:83], v4, s[36:39], s91 offen
    s_add_u32 s91, s91, 13824
    buffer_load_dwordx4 v[84:87], v4, s[36:39], s91 offen
    s_add_u32 s91, s91, 13824
    buffer_load_dwordx4 v[88:91], v4, s[36:39], s91 offen
    s_add_u32 s91, s91, 13824
    buffer_load_dwordx4 v[92:95], v4, s[36:39], s91 offen
    s_add_u32 s91, s91, 13824
    buffer_load_dwordx4 v[96:99], v4, s[36:39], s91 offen
    s_add_u32 s91, s91, 13824
    buffer_load_dwordx4 v[100:103], v4, s[36:39], s91 offen
    s_add_u32 s91, s91, 13824
    buffer_load_dwordx4 v[104:107], v4, s[36:39], s91 offen
    s_add_u32 s91, s91, 13824
    buffer_load_dwordx4 v[108:111], v4, s[36:39], s91 offen
    s_add_u32 s91, s91, 13824
    buffer_load_dwordx4 v[112:115], v4, s[36:39], s91 offen
    s_add_u32 s91, s91, 13824
    buffer_load_dwordx4 v[116:119], v4, s[36:39], s91 offen
    s_add_u32 s91, s91, 13824
    buffer_load_dwordx4 v[120:123], v4, s[36:39], s91 offen
    s_add_u32 s91, s91, 13824
    buffer_load_dwordx4 v[124:127], v4, s[36:39], s91 offen
    s_add_u32 s91, s91, 13824
    buffer_load_dwordx4 v[128:131], v4, s[36:39], s91 offen
    s_add_u32 s91, s91, 13824
    buffer_load_dwordx4 v[132:135], v4, s[36:39], s91 offen
    s_add_u32 s91, s91, 13824
    buffer_load_dwordx4 v[136:139], v4, s[36:39], s91 offen
    s_add_u32 s91, s91, 13824
    v_mov_b32 v5, 0
    ds_write_b32 v5, v5 offset:20480
    s_waitcnt lgkmcnt(0)
    s_barrier
Lcsum2:
    v_lshrrev_b32 v2, 4, v1
    v_and_b32 v3, 15, v1
    v_mov_b32 v10, 0
    v_mov_b32 v11, 0
    v_mov_b32 v12, 0
    v_mov_b32 v13, 0
    v_mov_b32 v14, 0
    v_mov_b32 v15, 0
    v_mov_b32 v16, 0
    v_mov_b32 v17, 0
    v_mov_b32 v8, 0x00003f80
    v_mov_b32 v9, 0x3f800000
    s_waitcnt vmcnt(19)
    v_dot2c_f32_bf16 v10, v60, v8
    v_dot2c_f32_bf16 v11, v60, v9
    v_dot2c_f32_bf16 v12, v61, v8
    v_dot2c_f32_bf16 v13, v61, v9
    v_dot2c_f32_bf16 v14, v62, v8
    v_dot2c_f32_bf16 v15, v62, v9
    v_dot2c_f32_bf16 v16, v63, v8
    v_dot2c_f32_bf16 v17, v63, v9
    s_waitcnt vmcnt(18)
    v_dot2c_f32_bf16 v10, v64, v8
    v_dot2c_f32_bf16 v11, v64, v9
    v_dot2c_f32_bf16 v12, v65, v8
    v_dot2c_f32_bf16 v13, v65, v9
    v_dot2c_f32_bf16 v14, v66, v8
    v_dot2c_f32_bf16 v15, v66, v9
    v_dot2c_f32_bf16 v16, v67, v8
    v_dot2c_f32_bf16 v17, v67, v9
    s_waitcnt vmcnt(17)
    v_dot2c_f32_bf16 v10, v68, v8
    v_dot2c_f32_bf16 v11, v68, v9
    v_dot2c_f32_bf16 v12, v69, v8
    v_dot2c_f32_bf16 v13, v69, v9
    v_dot2c_f32_bf16 v14, v70, v8
    v_dot2c_f32_bf16 v15, v70, v9
    v_dot2c_f32_bf16 v16, v71, v8
    v_dot2c_f32_bf16 v17, v71, v9
    s_waitcnt vmcnt(16)
    v_dot2c_f32_bf16 v10, v72, v8
    v_dot2c_f32_bf16 v11, v72, v9
    v_dot2c_f32_bf16 v12, v73, v8
    v_dot2c_f32_bf16 v13, v73, v9
    v_dot2c_f32_bf16 v14, v74, v8
    v_dot2c_f32_bf16 v15, v74, v9
    v_dot2c_f32_bf16 v16, v75, v8
    v_dot2c_f32_bf16 v17, v75, v9
    s_waitcnt vmcnt(15)
    v_dot2c_f32_bf16 v10, v76, v8
    v_dot2c_f32_bf16 v11, v76, v9
    v_dot2c_f32_bf16 v12, v77, v8
    v_dot2c_f32_bf16 v13, v77, v9
    v_dot2c_f32_bf16 v14, v78, v8
    v_dot2c_f32_bf16 v15, v78, v9
    v_dot2c_f32_bf16 v16, v79, v8
    v_dot2c_f32_bf16 v17, v79, v9
    s_waitcnt vmcnt(14)
    v_dot2c_f32_bf16 v10, v80, v8
    v_dot2c_f32_bf16 v11, v80, v9
    v_dot2c_f32_bf16 v12, v81, v8
    v_dot2c_f32_bf16 v13, v81, v9
    v_dot2c_f32_bf16 v14, v82, v8
    v_dot2c_f32_bf16 v15, v82, v9
    v_dot2c_f32_bf16 v16, v83, v8
    v_dot2c_f32_bf16 v17, v83, v9
    s_waitcnt vmcnt(13)
    v_dot2c_f32_bf16 v10, v84, v8
    v_dot2c_f32_bf16 v11, v84, v9
    v_dot2c_f32_bf16 v12, v85, v8
    v_dot2c_f32_bf16 v13, v85, v9
    v_dot2c_f32_bf16 v14, v86, v8
    v_dot2c_f32_bf16 v15, v86, v9
    v_dot2c_f32_bf16 v16, v87, v8
    v_dot2c_f32_bf16 v17, v87, v9
    s_waitcnt vmcnt(12)
    v_dot2c_f32_bf16 v10, v88, v8
    v_dot2c_f32_bf16 v11, v88, v9
    v_dot2c_f32_bf16 v12, v89, v8
    v_dot2c_f32_bf16 v13, v89, v9
    v_dot2c_f32_bf16 v14, v90, v8
    v_dot2c_f32_bf16 v15, v90, v9
    v_dot2c_f32_bf16 v16, v91, v8
    v_dot2c_f32_bf16 v17, v91, v9
    s_waitcnt vmcnt(11)
    v_dot2c_f32_bf16 v10, v92, v8
    v_dot2c_f32_bf16 v11, v92, v9
    v_dot2c_f32_bf16 v12, v93, v8
    v_dot2c_f32_bf16 v13, v93, v9
    v_dot2c_f32_bf16 v14, v94, v8
    v_dot2c_f32_bf16 v15, v94, v9
    v_dot2c_f32_bf16 v16, v95, v8
    v_dot2c_f32_bf16 v17, v95, v9
    s_waitcnt vmcnt(10)
    v_dot2c_f32_bf16 v10, v96, v8
    v_dot2c_f32_bf16 v11, v96, v9
    v_dot2c_f32_bf16 v12, v97, v8
    v_dot2c_f32_bf16 v13, v97, v9
    v_dot2c_f32_bf16 v14, v98, v8
    v_dot2c_f32_bf16 v15, v98, v9
    v_dot2c_f32_bf16 v16, v99, v8
    v_dot2c_f32_bf16 v17, v99, v9
    s_waitcnt vmcnt(9)
    v_dot2c_f32_bf16 v10, v100, v8
    v_dot2c_f32_bf16 v11, v100, v9
    v_dot2c_f32_bf16 v12, v101, v8
    v_dot2c_f32_bf16 v13, v101, v9
    v_dot2c_f32_bf16 v14, v102, v8
    v_dot2c_f32_bf16 v15, v102, v9
    v_dot2c_f32_bf16 v16, v103, v8
    v_dot2c_f32_bf16 v17, v103, v9
    s_waitcnt vmcnt(8)
    v_dot2c_f32_bf16 v10, v104, v8
    v_dot2c_f32_bf16 v11, v104, v9
    v_dot2c_f32_bf16 v12, v105, v8
    v_dot2c_f32_bf16 v13, v105, v9
    v_dot2c_f32_bf16 v14, v106, v8
    v_dot2c_f32_bf16 v15, v106, v9
    v_dot2c_f32_bf16 v16, v107, v8
    v_dot2c_f32_bf16 v17, v107, v9
    s_waitcnt vmcnt(7)
    v_dot2c_f32_bf16 v10, v108, v8
    v_dot2c_f32_bf16 v11, v108, v9
    v_dot2c_f32_bf16 v12, v109, v8
    v_dot2c_f32_bf16 v13, v109, v9
    v_dot2c_f32_bf16 v14, v110, v8
    v_dot2c_f32_bf16 v15, v110, v9
    v_dot2c_f32_bf16 v16, v111, v8
    v_dot2c_f32_bf16 v17, v111, v9
    s_waitcnt vmcnt(6)
    v_dot2c_f32_bf16 v10, v112, v8
    v_dot2c_f32_bf16 v11, v112, v9
    v_dot2c_f32_bf16 v12, v113, v8
    v_dot2c_f32_bf16 v13, v113, v9
    v_dot2c_f32_bf16 v14, v114, v8
    v_dot2c_f32_bf16 v15, v114, v9
    v_dot2c_f32_bf16 v16, v115, v8
    v_dot2c_f32_bf16 v17, v115, v9
    s_waitcnt vmcnt(5)
    v_dot2c_f32_bf16 v10, v116, v8
    v_dot2c_f32_bf16 v11, v116, v9
    v_dot2c_f32_bf16 v12, v117, v8
    v_dot2c_f32_bf16 v13, v117, v9
    v_dot2c_f32_bf16 v14, v118, v8
    v_dot2c_f32_bf16 v15, v118, v9
    v_dot2c_f32_bf16 v16, v119, v8
    v_dot2c_f32_bf16 v17, v119, v9
    s_waitcnt vmcnt(4)
    v_dot2c_f32_bf16 v10, v120, v8
    v_dot2c_f32_bf16 v11, v120, v9
    v_dot2c_f32_bf16 v12, v121, v8
    v_dot2c_f32_bf16 v13, v121, v9
    v_dot2c_f32_bf16 v14, v122, v8
    v_dot2c_f32_bf16 v15, v122, v9
    v_dot2c_f32_bf16 v16, v123, v8
    v_dot2c_f32_bf16 v17, v123, v9
    s_waitcnt vmcnt(3)
    v_dot2c_f32_bf16 v10, v124, v8
    v_dot2c_f32_bf16 v11, v124, v9
    v_dot2c_f32_bf16 v12, v125, v8
    v_dot2c_f32_bf16 v13, v125, v9
    v_dot2c_f32_bf16 v14, v126, v8
    v_dot2c_f32_bf16 v15, v126, v9
    v_dot2c_f32_bf16 v16, v127, v8
    v_dot2c_f32_bf16 v17, v127, v9
    s_waitcnt vmcnt(2)
    v_dot2c_f32_bf16 v10, v128, v8
    v_dot2c_f32_bf16 v11, v128, v9
    v_dot2c_f32_bf16 v12, v129, v8
    v_dot2c_f32_bf16 v13, v129, v9
    v_dot2c_f32_bf16 v14, v130, v8
    v_dot2c_f32_bf16 v15, v130, v9
    v_dot2c_f32_bf16 v16, v131, v8
    v_dot2c_f32_bf16 v17, v131, v9
    s_waitcnt vmcnt(1)
    v_dot2c_f32_bf16 v10, v132, v8
    v_dot2c_f32_bf16 v11, v132, v9
    v_dot2c_f32_bf16 v12, v133, v8
    v_dot2c_f32_bf16 v13, v133, v9
    v_dot2c_f32_bf16 v14, v134, v8
    v_dot2c_f32_bf16 v15, v134, v9
    v_dot2c_f32_bf16 v16, v135, v8
    v_dot2c_f32_bf16 v17, v135, v9
    s_waitcnt vmcnt(0)
    v_dot2c_f32_bf16 v10, v136, v8
    v_dot2c_f32_bf16 v11, v136, v9
    v_dot2c_f32_bf16 v12, v137, v8
    v_dot2c_f32_bf16 v13, v137, v9
    v_dot2c_f32_bf16 v14, v138, v8
    v_dot2c_f32_bf16 v15, v138, v9
    v_dot2c_f32_bf16 v16, v139, v8
    v_dot2c_f32_bf16 v17, v139, v9
    v_permlane32_swap_b32 v10, v14
    v_permlane32_swap_b32 v11, v15
    v_permlane32_swap_b32 v12, v16
    v_permlane32_swap_b32 v13, v17
    v_add_f32 v10, v10, v14
    v_add_f32 v11, v11, v15
    v_add_f32 v12, v12, v16
    v_add_f32 v13, v13, v17
    s_nop 0
    v_permlane16_swap_b32 v10, v12
    v_permlane16_swap_b32 v11, v13
    v_add_f32 v10, v10, v12
    v_add_f32 v11, v11, v13
    v_lshlrev_b32 v3, 5, v3
    v_lshl_add_u32 v3, v2, 3, v3
    s_lshl_b32 s3, s22, 9
    v_add_u32 v3, s3, v3
    ds_write_b64 v3, v[10:11] offset:16384
    s_waitcnt lgkmcnt(0)
    s_cmp_ge_u32 s22, 4
    s_cbranch_scc1 Lcspf
    v_mov_b32 v4, 1
    ds_add_u32 v5, v4 offset:20480
    s_waitcnt lgkmcnt(0)
    s_cmp_lg_u32 s22, 0
    s_cbranch_scc1 Lcsx
    s_cmp_ge_u32 s60, 14
    s_cbranch_scc1 Lcsx
    s_mov_b32 s61, 0x100000
Lcsw:
    ds_read_b32 v4, v5 offset:20480
    s_waitcnt lgkmcnt(0)
    v_readfirstlane_b32 s3, v4
    s_sub_u32 s61, s61, 1
    s_cbranch_scc1 Lcsv
    s_cmp_lg_u32 s3, 256
    s_cbranch_scc1 Lcsw
Lcsv:
    v_lshlrev_b32 v3, 3, v1
    ds_read_b64 v[20:21], v3 offset:16384
    ds_read_b64 v[22:23], v3 offset:16896
    ds_read_b64 v[24:25], v3 offset:17408
    ds_read_b64 v[26:27], v3 offset:17920
    ds_read_b64 v[28:29], v3 offset:18432
    ds_read_b64 v[30:31], v3 offset:18944
    ds_read_b64 v[32:33], v3 offset:19456
    ds_read_b64 v[34:35], v3 offset:19968
    s_waitcnt lgkmcnt(0)
    v_pk_add_f32 v[20:21], v[20:21], v[22:23]
    v_pk_add_f32 v[20:21], v[20:21], v[24:25]
    v_pk_add_f32 v[20:21], v[20:21], v[26:27]
    v_pk_add_f32 v[20:21], v[20:21], v[28:29]
    v_pk_add_f32 v[20:21], v[20:21], v[30:31]
    v_pk_add_f32 v[20:21], v[20:21], v[32:33]
    v_pk_add_f32 v[20:21], v[20:21], v[34:35]
    s_waitcnt lgkmcnt(0)
    s_mov_b32 s92, s20
    s_mov_b32 s93, s21
    s_mov_b32 s94, 25165824
    s_mov_b32 s95, 0x00020000
    s_lshl_b32 s61, s60, 9
    s_add_u32 s61, s61, 1654784
    buffer_store_dwordx2 v[20:21], v3, s[92:95], s61 offen sc1
    s_add_u32 s61, s61, 2097152
    buffer_store_dwordx2 v[20:21], v3, s[92:95], s61 offen sc1
    s_add_u32 s61, s61, 2097152
    buffer_store_dwordx2 v[20:21], v3, s[92:95], s61 offen sc1
    s_add_u32 s61, s61, 2097152
    buffer_store_dwordx2 v[20:21], v3, s[92:95], s61 offen sc1
    s_add_u32 s61, s61, 2097152
    buffer_store_dwordx2 v[20:21], v3, s[92:95], s61 offen sc1
    s_add_u32 s61, s61, 2097152
    buffer_store_dwordx2 v[20:21], v3, s[92:95], s61 offen sc1
    s_add_u32 s61, s61, 2097152
    buffer_store_dwordx2 v[20:21], v3, s[92:95], s61 offen sc1
    s_add_u32 s61, s61, 2097152
    buffer_store_dwordx2 v[20:21], v3, s[92:95], s61 offen sc1
    s_add_u32 s61, s61, 2097152
    s_mul_i32 s61, s60, 64
    s_add_u32 s61, s61, 1644544
    v_mov_b32 v4, 1
    v_lshrrev_b32 v3, 2, v1
    v_lshlrev_b32 v3, 21, v3
    v_and_b32 v5, 3, v1
    v_lshl_add_u32 v3, v5, 2, v3
    s_waitcnt vmcnt(0)
    s_mov_b32 exec_hi, 0
    buffer_store_dword v4, v3, s[92:95], s61 offen sc1
    s_mov_b64 exec, -1
    s_waitcnt vmcnt(0)
    s_branch Lcsx
Lcspf:
    s_barrier
    s_sub_u32 s60, s57, 30
    s_lshl_b32 s60, s60, 2
    s_add_u32 s60, s60, s23
    s_lshl_b32 s60, s60, 13
    v_lshl_add_u32 v4, v1, 7, s60
    s_waitcnt vmcnt(0)
Lcsx:
    s_barrier
    s_sub_u32 s60, s57, 30
    s_lshl_b32 s60, s60, 2
    s_add_u32 s60, s60, s23
    s_lshl_b32 s60, s60, 13
    s_lshr_b32 s3, s22, 2
    s_lshl_b32 s3, s3, 16
    s_add_u32 s60, s60, s3
    v_lshl_add_u32 v4, v1, 7, s60
    v_add_u32 v6, 0, v4
    buffer_load_dword v7, v6, s[40:43], 0 offen
    s_waitcnt vmcnt(1)
    v_add_u32 v6, 131072, v4
    buffer_load_dword v7, v6, s[40:43], 0 offen
    s_waitcnt vmcnt(1)
    v_add_u32 v6, 262144, v4
    buffer_load_dword v7, v6, s[40:43], 0 offen
    s_waitcnt vmcnt(1)
    v_add_u32 v6, 917504, v4
    buffer_load_dword v7, v6, s[40:43], 0 offen
    s_waitcnt vmcnt(1)
    v_add_u32 v6, 1048576, v4
    buffer_load_dword v7, v6, s[40:43], 0 offen
    s_waitcnt vmcnt(1)
    v_add_u32 v6, 1179648, v4
    buffer_load_dword v7, v6, s[40:43], 0 offen
    s_waitcnt vmcnt(1)
    v_add_u32 v6, 1310720, v4
    buffer_load_dword v7, v6, s[40:43], 0 offen
    s_waitcnt vmcnt(1)
    v_add_u32 v6, 1441792, v4
    buffer_load_dword v7, v6, s[40:43], 0 offen
    s_waitcnt vmcnt(1)
    s_waitcnt vmcnt(0)
    s_endpgm
csl_3:
    buffer_load_dwordx4 v[60:63], v46, s[36:39], s91 offen
    s_add_u32 s91, s91, 13824
    buffer_load_dwordx4 v[64:67], v46, s[36:39], s91 offen
    s_add_u32 s91, s91, 13824
    buffer_load_dwordx4 v[68:71], v46, s[36:39], s91 offen
    s_add_u32 s91, s91, 13824
    buffer_load_dwordx4 v[72:75], v46, s[36:39], s91 offen
    s_add_u32 s91, s91, 13824
    s_branch csb_4
csl_5:
    buffer_load_dwordx4 v[76:79], v46, s[36:39], s91 offen
    s_add_u32 s91, s91, 13824
    buffer_load_dwordx4 v[80:83], v46, s[36:39], s91 offen
    s_add_u32 s91, s91, 13824
    buffer_load_dwordx4 v[84:87], v46, s[36:39], s91 offen
    s_add_u32 s91, s91, 13824
    buffer_load_dwordx4 v[88:91], v46, s[36:39], s91 offen
    s_add_u32 s91, s91, 13824
    s_branch csb_6
csl_7:
    buffer_load_dwordx4 v[92:95], v46, s[36:39], s91 offen
    s_add_u32 s91, s91, 13824
    buffer_load_dwordx4 v[96:99], v46, s[36:39], s91 offen
    s_add_u32 s91, s91, 13824
    buffer_load_dwordx4 v[100:103], v46, s[36:39], s91 offen
    s_add_u32 s91, s91, 13824
    buffer_load_dwordx4 v[104:107], v46, s[36:39], s91 offen
    s_add_u32 s91, s91, 13824
    s_branch csb_8
csl_9:
    buffer_load_dwordx4 v[108:111], v46, s[36:39], s91 offen
    s_add_u32 s91, s91, 13824
    buffer_load_dwordx4 v[112:115], v46, s[36:39], s91 offen
    s_add_u32 s91, s91, 13824
    buffer_load_dwordx4 v[116:119], v46, s[36:39], s91 offen
    s_add_u32 s91, s91, 13824
    buffer_load_dwordx4 v[120:123], v46, s[36:39], s91 offen
    s_add_u32 s91, s91, 13824
    s_branch csb_10
csl_11:
    buffer_load_dwordx4 v[124:127], v46, s[36:39], s91 offen
    s_add_u32 s91, s91, 13824
    buffer_load_dwordx4 v[128:131], v46, s[36:39], s91 offen
    s_add_u32 s91, s91, 13824
    buffer_load_dwordx4 v[132:135], v46, s[36:39], s91 offen
    s_add_u32 s91, s91, 13824
    buffer_load_dwordx4 v[136:139], v46, s[36:39], s91 offen
    s_add_u32 s91, s91, 13824
    s_branch csb_12
sfre_19:
    buffer_load_dwordx4 v[4:7], v2, s[52:55], s62 offen offset:16 sc1
    s_waitcnt vmcnt(0)
    s_sub_u32 s60, s60, 1
    s_cbranch_scc0 sfchk_17
    s_branch sfok_18
slow_25:
    s_nop 7
    buffer_store_dwordx2 v[100:101], v19, s[52:55], s89 offen offset:0 sc1
    s_branch back_26
slow_27:
    s_nop 7
    buffer_store_dwordx2 v[112:113], v19, s[52:55], s89 offen offset:256 sc1
    s_branch back_28
slow_29:
    s_nop 7
    buffer_store_dwordx2 v[124:125], v19, s[52:55], s89 offen offset:512 sc1
    s_branch back_30
slow_31:
    s_nop 7
    buffer_store_dwordx2 v[136:137], v19, s[52:55], s89 offen offset:768 sc1
    s_branch back_32
slow_33:
    s_nop 7
    buffer_store_dwordx2 v[150:151], v98, s[52:55], s90 offen sc1
    s_branch back_34
slow_35:
    s_nop 7
    buffer_store_dword v3, off, s[52:55], s61 sc1
    s_branch back_36
slow_37:
    s_nop 7
    buffer_store_dwordx4 v[240:243], v16, s[52:55], s61 offen sc1
    s_branch back_38
slow_39:
    s_nop 7
    buffer_store_dwordx4 v[244:247], v17, s[52:55], s61 offen sc1
    s_branch back_40
slow_41:
    s_nop 7
    buffer_store_dwordx4 v[248:251], v18, s[52:55], s61 offen sc1
    s_branch back_42
slow_43:
    s_nop 7
    buffer_store_dword v3, off, s[52:55], s61 sc1
    s_branch back_44
slow_45:
    s_nop 7
    buffer_store_dword v20, v232, s[52:55], s60 offen sc1
    s_branch back_46
slow_47:
    s_nop 7
    buffer_store_dword v24, v233, s[52:55], s60 offen sc1
    s_branch back_48
slow_49:
    s_nop 7
    buffer_store_dword v3, off, s[52:55], s61 offset:16 sc1
    s_branch back_50
Lskip3b:
    s_barrier
    s_sub_u32 s60, s57, 28
    s_lshl_b32 s60, s60, 2
    s_add_u32 s60, s60, s23
    s_lshl_b32 s60, s60, 13
    s_lshr_b32 s3, s22, 2
    s_lshl_b32 s3, s3, 16
    s_add_u32 s60, s60, s3
    v_lshl_add_u32 v4, v1, 7, s60
    v_add_u32 v6, 393216, v4
    buffer_load_dword v7, v6, s[40:43], 0 offen
    s_waitcnt vmcnt(1)
    v_add_u32 v6, 524288, v4
    buffer_load_dword v7, v6, s[40:43], 0 offen
    s_waitcnt vmcnt(1)
    v_add_u32 v6, 655360, v4
    buffer_load_dword v7, v6, s[40:43], 0 offen
    s_waitcnt vmcnt(1)
    v_add_u32 v6, 786432, v4
    buffer_load_dword v7, v6, s[40:43], 0 offen
    s_waitcnt vmcnt(1)
    s_waitcnt vmcnt(0)
    s_branch Lskip3c
slow_52:
    s_nop 7
    buffer_store_dwordx4 v[196:199], v14, s[52:55], s61 offen sc1
    s_branch back_53
slow_54:
    s_nop 7
    buffer_store_dwordx4 v[200:203], v14, s[52:55], s61 offen sc1
    s_branch back_55
slow_56:
    s_nop 7
    buffer_store_dwordx4 v[196:199], v14, s[52:55], s61 offen sc1
    s_branch back_57
slow_58:
    s_nop 7
    buffer_store_dwordx4 v[200:203], v14, s[52:55], s61 offen sc1
    s_branch back_59
slow_60:
    s_nop 7
    buffer_store_dwordx4 v[196:199], v14, s[52:55], s61 offen sc1
    s_branch back_61
slow_62:
    s_nop 7
    buffer_store_dwordx4 v[200:203], v14, s[52:55], s61 offen sc1
    s_branch back_63
slow_64:
    s_nop 7
    buffer_store_dwordx4 v[196:199], v14, s[52:55], s61 offen sc1
    s_branch back_65
slow_66:
    s_nop 7
    buffer_store_dwordx4 v[200:203], v14, s[52:55], s61 offen sc1
    s_branch back_67
slow_68:
    s_nop 7
    buffer_store_dword v3, off, s[52:55], s61 sc1
    s_branch back_69
Lend:
    s_endpgm

.section .rodata,"a"
.p2align 6
.amdhsa_kernel sequential_preLN__sliding_local_dilated__dense_activation_silu__prompt_kernel
  .amdhsa_next_free_vgpr 256
  .amdhsa_next_free_sgpr 102
  .amdhsa_accum_offset 256
  .amdhsa_group_segment_fixed_size 0
  .amdhsa_kernarg_size 72
  .amdhsa_user_sgpr_count 2
  .amdhsa_user_sgpr_kernarg_segment_ptr 1
  .amdhsa_system_sgpr_workgroup_id_x 1
  .amdhsa_float_denorm_mode_32 3
.end_amdhsa_kernel
```
